```python
import torch

def _softmax(x, axis=-1):
    return torch.softmax(x, dim=axis)
def _gelu(x):
    return torch.nn.functional.gelu(x, approximate="tanh")
def _silu(x):
    return torch.nn.functional.silu(x)
def _sigmoid(x):
    return torch.sigmoid(x)
def _layernorm(x, axis=-1, eps=1e-5):
    m = x.mean(dim=axis, keepdim=True)
    v = x.var(dim=axis, keepdim=True, unbiased=False)
    return (x - m) / torch.sqrt(v + eps)
def _scatter_add(tgt, idx, src, axis=0):
    return tgt.clone().index_add_(axis, idx, src)
def _segment_sum(src, seg, n):
    out = torch.zeros((n,) + src.shape[1:], dtype=src.dtype)
    return out.index_add_(0, seg, src)
def _pad(x, pw):
    flat = tuple(v for pair in reversed(pw) for v in pair)
    return torch.nn.functional.pad(x, flat)

kernel_name = 'standalone__hybrid_graph_tf_graphgps__graph'

def setup_inputs():

    _w = (lambda a: (lambda t: t.to(torch.bfloat16) if t.is_floating_point() else t)(torch.as_tensor(a)))
    N, deg, D = 10000, 32, 128
    E = N * deg
    src = (lambda lo, hi, *s: torch.randint(lo, hi, s))(0, N, E).to(torch.int64)
    dst = (lambda lo, hi, *s: torch.randint(lo, hi, s))(0, N, E).to(torch.int64)
    deg_cnt = torch.bincount(dst, minlength=N).to(float) + 1.0
    sc = 1.0 / float(D) ** 0.5
    return {
        "x": _w((lambda *s: torch.randn(*s, dtype=torch.bfloat16) * 0.05)(N, D)),
        "src": _w(src),
        "dst": _w(dst),
        "deg_inv": _w((1.0 / deg_cnt).to(float)),
        "w_msg": _w((lambda *s: torch.randn(*s, dtype=torch.bfloat16) * 0.2)(D, D) * sc),
        "wq": _w((lambda *s: torch.randn(*s, dtype=torch.bfloat16) * 1.6)(D, D) * sc),
        "wk": _w((lambda *s: torch.randn(*s, dtype=torch.bfloat16) * 1.6)(D, D) * sc),
        "wv": _w((lambda *s: torch.randn(*s, dtype=torch.bfloat16) * 0.2)(D, D) * sc),
        "w_out": _w((lambda *s: torch.randn(*s, dtype=torch.bfloat16) * 0.2)(D, D) * sc),
    }

def reference(x, src, dst, deg_inv, w_msg, wq, wk, wv, w_out):
    N, D = x.shape[0], x.shape[1]
    h = _layernorm(x, axis=-1)
    m_e = torch.einsum('nd,de->ne', h, w_msg)
    h_local = _segment_sum(m_e[src], dst, N) * deg_inv[:, None]
    q = torch.einsum('nd,de->ne', h, wq)
    k = torch.einsum('nd,de->ne', h, wk)
    v = torch.einsum('nd,de->ne', h, wv)
    logits = torch.einsum('id,jd->ij', q, k) / (float(D) ** 0.5)
    attn = _softmax(logits, axis=-1)
    h_global = torch.einsum('ij,jd->id', attn, v)
    y = torch.einsum('nd,de->ne', h_local + h_global, w_out)
    return x + y
```

```asm
; @launch kernel=gps_prep_kernel grid=(248,1,1) block=(256,1,1) lds=66560
; @launch kernel=gps_attn_kernel grid=(256,1,1) block=(256,1,1) lds=158976
.amdgcn_target "amdgcn-amd-amdhsa--gfx950"
.text
.globl gps_prep_kernel
.p2align 8
.type gps_prep_kernel,@function
gps_prep_kernel:
    s_load_dwordx4 s[4:7], s[0:1], 0
    s_load_dwordx2 s[8:9], s[0:1], 16
    s_load_dwordx8 s[12:19], s[0:1], 32
    s_load_dwordx2 s[20:21], s[0:1], 64
    s_load_dwordx2 s[22:23], s[0:1], 88
    s_getpc_b64 s[52:53]
K1_PC0:
    v_lshlrev_b32 v44, 4, v0
    v_mov_b32 v47, s53
    v_add_co_u32 v46, vcc, s52, v44
    v_add_u32 v45, 8192, v44
    v_min_u32 v45, K1_END - K1_PC0 - 16, v45
    v_addc_co_u32 v47, vcc, 0, v47, vcc
    global_load_dwordx4 v[252:255], v[46:47], off
    global_load_dwordx4 v[252:255], v[46:47], off offset:4080
    v_mov_b32 v49, s53
    v_add_co_u32 v48, vcc, s52, v45
    s_nop 1
    v_addc_co_u32 v49, vcc, 0, v49, vcc
    global_load_dwordx4 v[252:255], v[48:49], off
    s_cmp_ge_u32 s2, 248
    s_cbranch_scc1 K1_END
    v_and_b32 v1, 63, v0
    v_lshrrev_b32 v2, 6, v0
    v_lshrrev_b32 v6, 5, v1
    v_readfirstlane_b32 s3, v2
    s_sub_u32 s44, s2, 8
    s_cmp_lt_u32 s44, 79
    s_cbranch_scc1 K1_BIN
    s_cmp_eq_u32 s44, 79
    s_cbranch_scc1 K1_END
    v_lshrrev_b32 v4, 4, v1
    v_and_b32 v5, 15, v1
    v_lshlrev_b32 v7, 2, v4
    v_xor_b32 v5, v5, v7
    v_lshlrev_b32 v5, 4, v5
    v_lshl_add_u32 v4, v4, 8, v5
    s_mul_i32 s45, s3, 8320
    s_lshl_b32 s46, s3, 13
    s_cmp_lt_u32 s2, 8
    s_cbranch_scc1 K1_WROLE
    s_sub_u32 s44, s2, 88
    s_and_b32 s47, s44, 7
    s_lshr_b32 s44, s44, 3
    s_mul_i32 s47, s47, 20
    s_add_u32 s44, s44, s47
    s_cmp_ge_u32 s44, 157
    s_cbranch_scc1 K1_END
    s_lshl_b32 s44, s44, 14
    v_and_b32 v5, 15, v1
    v_lshrrev_b32 v7, 4, v1
    s_lshl_b32 s48, s3, 12
    s_add_u32 s48, s48, s44
    v_lshlrev_b32 v3, 8, v5
    v_lshl_add_u32 v3, v7, 4, v3
    v_add_u32 v3, s48, v3
    s_waitcnt lgkmcnt(0)
    s_mov_b32 s24, s4
    s_mov_b32 s25, s5
    s_mov_b32 s26, 0x271000
    s_mov_b32 s27, 0x00020000
    buffer_load_dwordx4 v[8:11], v3, s[24:27], 0 offen offset:0
    buffer_load_dwordx4 v[12:15], v3, s[24:27], 0 offen offset:64
    buffer_load_dwordx4 v[16:19], v3, s[24:27], 0 offen offset:128
    buffer_load_dwordx4 v[20:23], v3, s[24:27], 0 offen offset:192
    s_mov_b32 s28, s14
    s_mov_b32 s29, s15
    s_mov_b32 s30, 0x8000
    s_mov_b32 s31, 0x00020000
    s_add_u32 m0, s45, 0
    s_mov_b32 s47, s46
    buffer_load_dwordx4 v4, s[28:31], s47 offen lds
    s_add_u32 m0, m0, 1040
    s_add_u32 s47, s47, 1024
    buffer_load_dwordx4 v4, s[28:31], s47 offen lds
    s_add_u32 m0, m0, 1040
    s_add_u32 s47, s47, 1024
    buffer_load_dwordx4 v4, s[28:31], s47 offen lds
    s_add_u32 m0, m0, 1040
    s_add_u32 s47, s47, 1024
    buffer_load_dwordx4 v4, s[28:31], s47 offen lds
    s_add_u32 m0, m0, 1040
    s_add_u32 s47, s47, 1024
    buffer_load_dwordx4 v4, s[28:31], s47 offen lds
    s_add_u32 m0, m0, 1040
    s_add_u32 s47, s47, 1024
    buffer_load_dwordx4 v4, s[28:31], s47 offen lds
    s_add_u32 m0, m0, 1040
    s_add_u32 s47, s47, 1024
    buffer_load_dwordx4 v4, s[28:31], s47 offen lds
    s_add_u32 m0, m0, 1040
    s_add_u32 s47, s47, 1024
    buffer_load_dwordx4 v4, s[28:31], s47 offen lds
    s_mov_b32 s32, s16
    s_mov_b32 s33, s17
    s_mov_b32 s34, 0x8000
    s_mov_b32 s35, 0x00020000
    s_add_u32 m0, s45, 33280
    s_mov_b32 s47, s46
    buffer_load_dwordx4 v4, s[32:35], s47 offen lds
    s_add_u32 m0, m0, 1040
    s_add_u32 s47, s47, 1024
    buffer_load_dwordx4 v4, s[32:35], s47 offen lds
    s_add_u32 m0, m0, 1040
    s_add_u32 s47, s47, 1024
    buffer_load_dwordx4 v4, s[32:35], s47 offen lds
    s_add_u32 m0, m0, 1040
    s_add_u32 s47, s47, 1024
    buffer_load_dwordx4 v4, s[32:35], s47 offen lds
    s_add_u32 m0, m0, 1040
    s_add_u32 s47, s47, 1024
    buffer_load_dwordx4 v4, s[32:35], s47 offen lds
    s_add_u32 m0, m0, 1040
    s_add_u32 s47, s47, 1024
    buffer_load_dwordx4 v4, s[32:35], s47 offen lds
    s_add_u32 m0, m0, 1040
    s_add_u32 s47, s47, 1024
    buffer_load_dwordx4 v4, s[32:35], s47 offen lds
    s_add_u32 m0, m0, 1040
    s_add_u32 s47, s47, 1024
    buffer_load_dwordx4 v4, s[32:35], s47 offen lds
    s_add_u32 s36, s22, 0x1000
    s_addc_u32 s37, s23, 0
    s_mov_b32 s38, 0x274000
    s_mov_b32 s39, 0x00020000
    s_add_u32 s40, s22, 0x278000
    s_addc_u32 s41, s23, 0
    s_mov_b32 s42, 0x274000
    s_mov_b32 s43, 0x00020000
    s_add_u32 s52, s22, 0x501000
    s_addc_u32 s53, s23, 0
    s_mov_b32 s54, 0x94000
    s_mov_b32 s55, 0x00020000
    s_lshr_b32 s49, s44, 2
    v_lshl_add_u32 v24, v0, 4, s49
    v_mov_b32 v28, 0
    v_mov_b32 v29, 0
    v_mov_b32 v30, 0
    v_mov_b32 v31, 0
    buffer_store_dwordx4 v[28:31], v24, s[52:55], 0 offen sc1
    v_lshrrev_b32 v25, 2, v5
    v_and_b32 v26, 3, v5
    v_mul_u32_u24 v27, 2080, v7
    v_lshl_add_u32 v27, v25, 8, v27
    v_lshl_add_u32 v27, v26, 4, v27
    v_xor_b32 v24, 0, v25
    v_lshl_add_u32 v32, v24, 6, v27
    v_xor_b32 v24, 1, v25
    v_lshl_add_u32 v33, v24, 6, v27
    v_xor_b32 v24, 2, v25
    v_lshl_add_u32 v34, v24, 6, v27
    v_xor_b32 v24, 3, v25
    v_lshl_add_u32 v35, v24, 6, v27
    v_mul_u32_u24 v27, 2080, v25
    v_lshl_add_u32 v27, v26, 8, v27
    v_lshl_add_u32 v27, v7, 4, v27
    v_add_u32 v27, 33280, v27
    v_xor_b32 v24, 0, v26
    v_lshl_add_u32 v36, v24, 6, v27
    v_xor_b32 v24, 1, v26
    v_lshl_add_u32 v37, v24, 6, v27
    v_xor_b32 v24, 2, v26
    v_lshl_add_u32 v38, v24, 6, v27
    v_xor_b32 v24, 3, v26
    v_lshl_add_u32 v39, v24, 6, v27
    v_lshlrev_b32 v40, 4, v7
    v_add_u32 v40, 66288, v40
    v_lshl_add_u32 v41, v1, 4, s48
    s_lshr_b32 s49, s48, 8
    v_add_u32 v24, s49, v5
    v_cmp_gt_u32 vcc, 10000, v24
    v_cmp_eq_u32 s[50:51], 3, v7
    s_mov_b32 s47, 0x3e0293ee
    s_nop 0
    s_and_b64 s[50:51], s[50:51], vcc
    s_waitcnt vmcnt(20)
    v_lshlrev_b32 v64, 16, v8
    v_and_b32 v65, 0xffff0000, v8
    v_lshlrev_b32 v66, 16, v9
    v_and_b32 v67, 0xffff0000, v9
    v_lshlrev_b32 v68, 16, v10
    v_and_b32 v69, 0xffff0000, v10
    v_lshlrev_b32 v70, 16, v11
    v_and_b32 v71, 0xffff0000, v11
    v_pk_add_f32 v[96:97], v[64:65], v[66:67]
    v_pk_add_f32 v[98:99], v[68:69], v[70:71]
    s_waitcnt vmcnt(19)
    v_lshlrev_b32 v72, 16, v12
    v_and_b32 v73, 0xffff0000, v12
    v_lshlrev_b32 v74, 16, v13
    v_and_b32 v75, 0xffff0000, v13
    v_lshlrev_b32 v76, 16, v14
    v_and_b32 v77, 0xffff0000, v14
    v_lshlrev_b32 v78, 16, v15
    v_and_b32 v79, 0xffff0000, v15
    v_pk_add_f32 v[100:101], v[72:73], v[74:75]
    v_pk_add_f32 v[102:103], v[76:77], v[78:79]
    s_waitcnt vmcnt(18)
    v_lshlrev_b32 v80, 16, v16
    v_and_b32 v81, 0xffff0000, v16
    v_lshlrev_b32 v82, 16, v17
    v_and_b32 v83, 0xffff0000, v17
    v_lshlrev_b32 v84, 16, v18
    v_and_b32 v85, 0xffff0000, v18
    v_lshlrev_b32 v86, 16, v19
    v_and_b32 v87, 0xffff0000, v19
    v_pk_add_f32 v[104:105], v[80:81], v[82:83]
    v_pk_add_f32 v[106:107], v[84:85], v[86:87]
    s_waitcnt vmcnt(17)
    v_lshlrev_b32 v88, 16, v20
    v_and_b32 v89, 0xffff0000, v20
    v_lshlrev_b32 v90, 16, v21
    v_and_b32 v91, 0xffff0000, v21
    v_lshlrev_b32 v92, 16, v22
    v_and_b32 v93, 0xffff0000, v22
    v_lshlrev_b32 v94, 16, v23
    v_and_b32 v95, 0xffff0000, v23
    v_pk_add_f32 v[108:109], v[88:89], v[90:91]
    v_pk_add_f32 v[110:111], v[92:93], v[94:95]
    v_pk_add_f32 v[96:97], v[96:97], v[104:105]
    v_pk_add_f32 v[98:99], v[98:99], v[106:107]
    v_pk_add_f32 v[100:101], v[100:101], v[108:109]
    v_pk_add_f32 v[102:103], v[102:103], v[110:111]
    v_pk_add_f32 v[96:97], v[96:97], v[100:101]
    v_pk_add_f32 v[98:99], v[98:99], v[102:103]
    v_pk_add_f32 v[96:97], v[96:97], v[98:99]
    v_add_f32 v96, v96, v97
    v_mov_b32 v97, v96
    s_nop 1
    v_permlane32_swap_b32 v96, v97
    s_nop 1
    v_add_f32 v96, v96, v97
    v_mov_b32 v97, v96
    s_nop 1
    v_permlane16_swap_b32 v96, v97
    s_nop 1
    v_add_f32 v96, v96, v97
    v_mul_f32 v96, 0xbc000000, v96
    v_pk_add_f32 v[64:65], v[64:65], v[96:97] op_sel_hi:[1,0]
    v_pk_add_f32 v[66:67], v[66:67], v[96:97] op_sel_hi:[1,0]
    v_pk_add_f32 v[68:69], v[68:69], v[96:97] op_sel_hi:[1,0]
    v_pk_add_f32 v[70:71], v[70:71], v[96:97] op_sel_hi:[1,0]
    v_pk_add_f32 v[72:73], v[72:73], v[96:97] op_sel_hi:[1,0]
    v_pk_add_f32 v[74:75], v[74:75], v[96:97] op_sel_hi:[1,0]
    v_pk_add_f32 v[76:77], v[76:77], v[96:97] op_sel_hi:[1,0]
    v_pk_add_f32 v[78:79], v[78:79], v[96:97] op_sel_hi:[1,0]
    v_pk_add_f32 v[80:81], v[80:81], v[96:97] op_sel_hi:[1,0]
    v_pk_add_f32 v[82:83], v[82:83], v[96:97] op_sel_hi:[1,0]
    v_pk_add_f32 v[84:85], v[84:85], v[96:97] op_sel_hi:[1,0]
    v_pk_add_f32 v[86:87], v[86:87], v[96:97] op_sel_hi:[1,0]
    v_pk_add_f32 v[88:89], v[88:89], v[96:97] op_sel_hi:[1,0]
    v_pk_add_f32 v[90:91], v[90:91], v[96:97] op_sel_hi:[1,0]
    v_pk_add_f32 v[92:93], v[92:93], v[96:97] op_sel_hi:[1,0]
    v_pk_add_f32 v[94:95], v[94:95], v[96:97] op_sel_hi:[1,0]
    v_pk_mul_f32 v[100:101], v[64:65], v[64:65]
    v_pk_mul_f32 v[102:103], v[66:67], v[66:67]
    v_pk_mul_f32 v[104:105], v[68:69], v[68:69]
    v_pk_mul_f32 v[106:107], v[70:71], v[70:71]
    v_pk_fma_f32 v[100:101], v[72:73], v[72:73], v[100:101]
    v_pk_fma_f32 v[102:103], v[74:75], v[74:75], v[102:103]
    v_pk_fma_f32 v[104:105], v[76:77], v[76:77], v[104:105]
    v_pk_fma_f32 v[106:107], v[78:79], v[78:79], v[106:107]
    v_pk_fma_f32 v[100:101], v[80:81], v[80:81], v[100:101]
    v_pk_fma_f32 v[102:103], v[82:83], v[82:83], v[102:103]
    v_pk_fma_f32 v[104:105], v[84:85], v[84:85], v[104:105]
    v_pk_fma_f32 v[106:107], v[86:87], v[86:87], v[106:107]
    v_pk_fma_f32 v[100:101], v[88:89], v[88:89], v[100:101]
    v_pk_fma_f32 v[102:103], v[90:91], v[90:91], v[102:103]
    v_pk_fma_f32 v[104:105], v[92:93], v[92:93], v[104:105]
    v_pk_fma_f32 v[106:107], v[94:95], v[94:95], v[106:107]
    v_pk_add_f32 v[100:101], v[100:101], v[104:105]
    v_pk_add_f32 v[102:103], v[102:103], v[106:107]
    v_pk_add_f32 v[100:101], v[100:101], v[102:103]
    v_add_f32 v96, v100, v101
    v_mov_b32 v97, v96
    s_nop 1
    v_permlane32_swap_b32 v96, v97
    s_nop 1
    v_add_f32 v96, v96, v97
    v_mov_b32 v97, v96
    s_nop 1
    v_permlane16_swap_b32 v96, v97
    s_nop 1
    v_add_f32 v96, v96, v97
    v_mul_f32 v96, 0x3c000000, v96
    v_cvt_pk_bf16_f32 v96, v96, v96
    v_and_b32 v96, 0xffff0000, v96
    v_add_f32 v96, 0x3727c5ac, v96
    v_cvt_pk_bf16_f32 v96, v96, v96
    v_and_b32 v96, 0xffff0000, v96
    v_sqrt_f32 v96, v96
    s_nop 0
    v_cvt_pk_bf16_f32 v96, v96, v96
    v_and_b32 v96, 0xffff0000, v96
    v_rcp_f32 v96, v96
    s_nop 0
    v_pk_mul_f32 v[64:65], v[64:65], v[96:97] op_sel_hi:[1,0]
    v_pk_mul_f32 v[66:67], v[66:67], v[96:97] op_sel_hi:[1,0]
    v_pk_mul_f32 v[68:69], v[68:69], v[96:97] op_sel_hi:[1,0]
    v_pk_mul_f32 v[70:71], v[70:71], v[96:97] op_sel_hi:[1,0]
    v_pk_mul_f32 v[72:73], v[72:73], v[96:97] op_sel_hi:[1,0]
    v_pk_mul_f32 v[74:75], v[74:75], v[96:97] op_sel_hi:[1,0]
    v_pk_mul_f32 v[76:77], v[76:77], v[96:97] op_sel_hi:[1,0]
    v_pk_mul_f32 v[78:79], v[78:79], v[96:97] op_sel_hi:[1,0]
    v_pk_mul_f32 v[80:81], v[80:81], v[96:97] op_sel_hi:[1,0]
    v_pk_mul_f32 v[82:83], v[82:83], v[96:97] op_sel_hi:[1,0]
    v_pk_mul_f32 v[84:85], v[84:85], v[96:97] op_sel_hi:[1,0]
    v_pk_mul_f32 v[86:87], v[86:87], v[96:97] op_sel_hi:[1,0]
    v_pk_mul_f32 v[88:89], v[88:89], v[96:97] op_sel_hi:[1,0]
    v_pk_mul_f32 v[90:91], v[90:91], v[96:97] op_sel_hi:[1,0]
    v_pk_mul_f32 v[92:93], v[92:93], v[96:97] op_sel_hi:[1,0]
    v_pk_mul_f32 v[94:95], v[94:95], v[96:97] op_sel_hi:[1,0]
    v_cvt_pk_bf16_f32 v8, v64, v65
    v_cvt_pk_bf16_f32 v9, v66, v67
    v_cvt_pk_bf16_f32 v10, v68, v69
    v_cvt_pk_bf16_f32 v11, v70, v71
    v_cvt_pk_bf16_f32 v12, v72, v73
    v_cvt_pk_bf16_f32 v13, v74, v75
    v_cvt_pk_bf16_f32 v14, v76, v77
    v_cvt_pk_bf16_f32 v15, v78, v79
    v_cvt_pk_bf16_f32 v16, v80, v81
    v_cvt_pk_bf16_f32 v17, v82, v83
    v_cvt_pk_bf16_f32 v18, v84, v85
    v_cvt_pk_bf16_f32 v19, v86, v87
    v_cvt_pk_bf16_f32 v20, v88, v89
    v_cvt_pk_bf16_f32 v21, v90, v91
    v_cvt_pk_bf16_f32 v22, v92, v93
    v_cvt_pk_bf16_f32 v23, v94, v95
    s_waitcnt vmcnt(1)
    s_barrier
    buffer_store_dwordx4 v[8:11], v3, s[36:39], 0 offen offset:0 sc1
    buffer_store_dwordx4 v[12:15], v3, s[36:39], 0 offen offset:64 sc1
    buffer_store_dwordx4 v[16:19], v3, s[36:39], 0 offen offset:128 sc1
    v_and_b32 v24, 0xffff, v23
    v_or_b32 v24, 0x3f800000, v24
    v_mov_b32 v28, v20
    v_mov_b32 v29, v21
    v_mov_b32 v30, v22
    v_cndmask_b32 v31, v23, v24, s[50:51]
    buffer_store_dwordx4 v[28:31], v3, s[36:39], 0 offen offset:192 sc1
    ds_read_b64_tr_b16 v[64:65], v32 offset:0
    ds_read_b64_tr_b16 v[66:67], v32 offset:1040
    ds_read_b64_tr_b16 v[68:69], v32 offset:8320
    ds_read_b64_tr_b16 v[70:71], v32 offset:9360
    ds_read_b64_tr_b16 v[72:73], v32 offset:16640
    ds_read_b64_tr_b16 v[74:75], v32 offset:17680
    ds_read_b64_tr_b16 v[76:77], v32 offset:24960
    ds_read_b64_tr_b16 v[78:79], v32 offset:26000
    ds_read_b64_tr_b16 v[80:81], v32 offset:8
    ds_read_b64_tr_b16 v[82:83], v32 offset:1048
    ds_read_b64_tr_b16 v[84:85], v32 offset:8328
    ds_read_b64_tr_b16 v[86:87], v32 offset:9368
    ds_read_b64_tr_b16 v[88:89], v32 offset:16648
    ds_read_b64_tr_b16 v[90:91], v32 offset:17688
    s_waitcnt lgkmcnt(12)
    v_mfma_f32_16x16x32_bf16 v[192:195], v[64:67], v[8:11], 0
    ds_read_b64_tr_b16 v[92:93], v32 offset:24968
    ds_read_b64_tr_b16 v[94:95], v32 offset:26008
    s_waitcnt lgkmcnt(12)
    v_mfma_f32_16x16x32_bf16 v[192:195], v[68:71], v[12:15], v[192:195]
    ds_read_b64_tr_b16 v[96:97], v33 offset:0
    ds_read_b64_tr_b16 v[98:99], v33 offset:1040
    s_waitcnt lgkmcnt(12)
    v_mfma_f32_16x16x32_bf16 v[192:195], v[72:75], v[16:19], v[192:195]
    ds_read_b64_tr_b16 v[100:101], v33 offset:8320
    ds_read_b64_tr_b16 v[102:103], v33 offset:9360
    s_waitcnt lgkmcnt(12)
    v_mfma_f32_16x16x32_bf16 v[192:195], v[76:79], v[20:23], v[192:195]
    ds_read_b64_tr_b16 v[104:105], v33 offset:16640
    ds_read_b64_tr_b16 v[106:107], v33 offset:17680
    s_waitcnt lgkmcnt(12)
    v_mfma_f32_16x16x32_bf16 v[196:199], v[80:83], v[8:11], 0
    ds_read_b64_tr_b16 v[108:109], v33 offset:24960
    ds_read_b64_tr_b16 v[110:111], v33 offset:26000
    s_waitcnt lgkmcnt(12)
    v_mfma_f32_16x16x32_bf16 v[196:199], v[84:87], v[12:15], v[196:199]
    ds_read_b64_tr_b16 v[112:113], v33 offset:8
    ds_read_b64_tr_b16 v[114:115], v33 offset:1048
    s_waitcnt lgkmcnt(12)
    v_mfma_f32_16x16x32_bf16 v[196:199], v[88:91], v[16:19], v[196:199]
    ds_read_b64_tr_b16 v[116:117], v33 offset:8328
    ds_read_b64_tr_b16 v[118:119], v33 offset:9368
    s_waitcnt lgkmcnt(12)
    v_mfma_f32_16x16x32_bf16 v[196:199], v[92:95], v[20:23], v[196:199]
    ds_read_b64_tr_b16 v[120:121], v33 offset:16648
    ds_read_b64_tr_b16 v[122:123], v33 offset:17688
    s_waitcnt lgkmcnt(12)
    v_mfma_f32_16x16x32_bf16 v[200:203], v[96:99], v[8:11], 0
    ds_read_b64_tr_b16 v[124:125], v33 offset:24968
    ds_read_b64_tr_b16 v[126:127], v33 offset:26008
    s_waitcnt lgkmcnt(12)
    v_mfma_f32_16x16x32_bf16 v[200:203], v[100:103], v[12:15], v[200:203]
    ds_read_b64_tr_b16 v[64:65], v34 offset:0
    ds_read_b64_tr_b16 v[66:67], v34 offset:1040
    s_waitcnt lgkmcnt(12)
    v_mfma_f32_16x16x32_bf16 v[200:203], v[104:107], v[16:19], v[200:203]
    ds_read_b64_tr_b16 v[68:69], v34 offset:8320
    ds_read_b64_tr_b16 v[70:71], v34 offset:9360
    s_waitcnt lgkmcnt(12)
    v_mfma_f32_16x16x32_bf16 v[200:203], v[108:111], v[20:23], v[200:203]
    ds_read_b64_tr_b16 v[72:73], v34 offset:16640
    ds_read_b64_tr_b16 v[74:75], v34 offset:17680
    s_waitcnt lgkmcnt(12)
    v_mfma_f32_16x16x32_bf16 v[204:207], v[112:115], v[8:11], 0
    ds_read_b64_tr_b16 v[76:77], v34 offset:24960
    ds_read_b64_tr_b16 v[78:79], v34 offset:26000
    s_waitcnt lgkmcnt(12)
    v_mfma_f32_16x16x32_bf16 v[204:207], v[116:119], v[12:15], v[204:207]
    ds_read_b64_tr_b16 v[80:81], v34 offset:8
    ds_read_b64_tr_b16 v[82:83], v34 offset:1048
    s_waitcnt lgkmcnt(12)
    v_mfma_f32_16x16x32_bf16 v[204:207], v[120:123], v[16:19], v[204:207]
    ds_read_b64_tr_b16 v[84:85], v34 offset:8328
    ds_read_b64_tr_b16 v[86:87], v34 offset:9368
    s_waitcnt lgkmcnt(12)
    v_mfma_f32_16x16x32_bf16 v[204:207], v[124:127], v[20:23], v[204:207]
    ds_read_b64_tr_b16 v[88:89], v34 offset:16648
    ds_read_b64_tr_b16 v[90:91], v34 offset:17688
    s_waitcnt lgkmcnt(12)
    v_mfma_f32_16x16x32_bf16 v[208:211], v[64:67], v[8:11], 0
    ds_read_b64_tr_b16 v[92:93], v34 offset:24968
    ds_read_b64_tr_b16 v[94:95], v34 offset:26008
    s_waitcnt lgkmcnt(12)
    v_mfma_f32_16x16x32_bf16 v[208:211], v[68:71], v[12:15], v[208:211]
    ds_read_b64_tr_b16 v[96:97], v35 offset:0
    ds_read_b64_tr_b16 v[98:99], v35 offset:1040
    s_waitcnt lgkmcnt(12)
    v_mfma_f32_16x16x32_bf16 v[208:211], v[72:75], v[16:19], v[208:211]
    ds_read_b64_tr_b16 v[100:101], v35 offset:8320
    ds_read_b64_tr_b16 v[102:103], v35 offset:9360
    s_waitcnt lgkmcnt(12)
    v_mfma_f32_16x16x32_bf16 v[208:211], v[76:79], v[20:23], v[208:211]
    ds_read_b64_tr_b16 v[104:105], v35 offset:16640
    ds_read_b64_tr_b16 v[106:107], v35 offset:17680
    s_waitcnt lgkmcnt(12)
    v_mfma_f32_16x16x32_bf16 v[212:215], v[80:83], v[8:11], 0
    ds_read_b64_tr_b16 v[108:109], v35 offset:24960
    ds_read_b64_tr_b16 v[110:111], v35 offset:26000
    s_waitcnt lgkmcnt(12)
    v_mfma_f32_16x16x32_bf16 v[212:215], v[84:87], v[12:15], v[212:215]
    ds_read_b64_tr_b16 v[112:113], v35 offset:8
    ds_read_b64_tr_b16 v[114:115], v35 offset:1048
    s_waitcnt lgkmcnt(12)
    v_mfma_f32_16x16x32_bf16 v[212:215], v[88:91], v[16:19], v[212:215]
    ds_read_b64_tr_b16 v[116:117], v35 offset:8328
    ds_read_b64_tr_b16 v[118:119], v35 offset:9368
    s_waitcnt lgkmcnt(12)
    v_mfma_f32_16x16x32_bf16 v[212:215], v[92:95], v[20:23], v[212:215]
    ds_read_b64_tr_b16 v[120:121], v35 offset:16648
    ds_read_b64_tr_b16 v[122:123], v35 offset:17688
    s_waitcnt lgkmcnt(12)
    v_mfma_f32_16x16x32_bf16 v[216:219], v[96:99], v[8:11], 0
    ds_read_b64_tr_b16 v[124:125], v35 offset:24968
    ds_read_b64_tr_b16 v[126:127], v35 offset:26008
    s_waitcnt lgkmcnt(12)
    v_mfma_f32_16x16x32_bf16 v[216:219], v[100:103], v[12:15], v[216:219]
    s_waitcnt lgkmcnt(10)
    v_mfma_f32_16x16x32_bf16 v[216:219], v[104:107], v[16:19], v[216:219]
    s_waitcnt lgkmcnt(8)
    v_mfma_f32_16x16x32_bf16 v[216:219], v[108:111], v[20:23], v[216:219]
    s_waitcnt lgkmcnt(6)
    v_mfma_f32_16x16x32_bf16 v[220:223], v[112:115], v[8:11], 0
    s_waitcnt lgkmcnt(4)
    v_mfma_f32_16x16x32_bf16 v[220:223], v[116:119], v[12:15], v[220:223]
    s_waitcnt lgkmcnt(2)
    v_mfma_f32_16x16x32_bf16 v[220:223], v[120:123], v[16:19], v[220:223]
    s_waitcnt lgkmcnt(0)
    v_mfma_f32_16x16x32_bf16 v[220:223], v[124:127], v[20:23], v[220:223]
    ds_read_b128 v[224:227], v40 offset:192
    ds_read_b128 v[228:231], v40 offset:128
    ds_read_b128 v[232:235], v40 offset:64
    ds_read_b128 v[236:239], v40 offset:0
    ds_read_b128 v[128:131], v36 offset:0
    ds_read_b128 v[132:135], v37 offset:0
    ds_read_b128 v[136:139], v38 offset:0
    ds_read_b128 v[140:143], v39 offset:0
    ds_read_b128 v[144:147], v36 offset:1040
    ds_read_b128 v[148:151], v37 offset:1040
    ds_read_b128 v[152:155], v38 offset:1040
    ds_read_b128 v[156:159], v39 offset:1040
    ds_read_b128 v[160:163], v36 offset:8320
    ds_read_b128 v[164:167], v37 offset:8320
    v_cvt_pk_bf16_f32 v44, v192, v193
    v_cvt_pk_bf16_f32 v45, v194, v195
    v_cvt_pk_bf16_f32 v46, v196, v197
    v_cvt_pk_bf16_f32 v47, v198, v199
    v_cvt_pk_bf16_f32 v48, v200, v201
    v_cvt_pk_bf16_f32 v49, v202, v203
    v_cvt_pk_bf16_f32 v50, v204, v205
    v_cvt_pk_bf16_f32 v51, v206, v207
    v_cvt_pk_bf16_f32 v52, v208, v209
    v_cvt_pk_bf16_f32 v53, v210, v211
    v_cvt_pk_bf16_f32 v54, v212, v213
    v_cvt_pk_bf16_f32 v55, v214, v215
    v_cvt_pk_bf16_f32 v56, v216, v217
    v_cvt_pk_bf16_f32 v57, v218, v219
    v_cvt_pk_bf16_f32 v58, v220, v221
    v_cvt_pk_bf16_f32 v59, v222, v223
    s_waitcnt lgkmcnt(10)
    v_mfma_f32_16x16x32_bf16 v[240:243], v[224:227], v[44:47], 0
    v_mfma_f32_16x16x32_bf16 v[240:243], v[228:231], v[48:51], v[240:243]
    v_mfma_f32_16x16x32_bf16 v[240:243], v[232:235], v[52:55], v[240:243]
    v_mfma_f32_16x16x32_bf16 v[240:243], v[236:239], v[56:59], v[240:243]
    ds_read_b128 v[168:171], v38 offset:8320
    s_waitcnt lgkmcnt(10)
    v_mfma_f32_16x16x32_bf16 v[192:195], v[128:131], v[44:47], 0
    ds_read_b128 v[172:175], v39 offset:8320
    s_waitcnt lgkmcnt(10)
    v_mfma_f32_16x16x32_bf16 v[192:195], v[132:135], v[48:51], v[192:195]
    ds_read_b128 v[176:179], v36 offset:9360
    s_waitcnt lgkmcnt(10)
    v_mfma_f32_16x16x32_bf16 v[192:195], v[136:139], v[52:55], v[192:195]
    ds_read_b128 v[180:183], v37 offset:9360
    s_waitcnt lgkmcnt(10)
    v_mfma_f32_16x16x32_bf16 v[192:195], v[140:143], v[56:59], v[192:195]
    ds_read_b128 v[184:187], v38 offset:9360
    s_waitcnt lgkmcnt(10)
    v_mfma_f32_16x16x32_bf16 v[196:199], v[144:147], v[44:47], 0
    ds_read_b128 v[188:191], v39 offset:9360
    s_waitcnt lgkmcnt(10)
    v_mfma_f32_16x16x32_bf16 v[196:199], v[148:151], v[48:51], v[196:199]
    ds_read_b128 v[128:131], v36 offset:16640
    s_waitcnt lgkmcnt(10)
    v_mfma_f32_16x16x32_bf16 v[196:199], v[152:155], v[52:55], v[196:199]
    v_mul_f32 v240, s47, v240
    ds_read_b128 v[132:135], v37 offset:16640
    s_waitcnt lgkmcnt(10)
    v_mfma_f32_16x16x32_bf16 v[196:199], v[156:159], v[56:59], v[196:199]
    ds_read_b128 v[136:139], v38 offset:16640
    s_waitcnt lgkmcnt(10)
    v_mfma_f32_16x16x32_bf16 v[200:203], v[160:163], v[44:47], 0
    ds_read_b128 v[140:143], v39 offset:16640
    s_waitcnt lgkmcnt(10)
    v_mfma_f32_16x16x32_bf16 v[200:203], v[164:167], v[48:51], v[200:203]
    ds_read_b128 v[144:147], v36 offset:17680
    s_waitcnt lgkmcnt(10)
    v_mfma_f32_16x16x32_bf16 v[200:203], v[168:171], v[52:55], v[200:203]
    ds_read_b128 v[148:151], v37 offset:17680
    s_waitcnt lgkmcnt(10)
    v_mfma_f32_16x16x32_bf16 v[200:203], v[172:175], v[56:59], v[200:203]
    ds_read_b128 v[152:155], v38 offset:17680
    s_waitcnt lgkmcnt(10)
    v_mfma_f32_16x16x32_bf16 v[204:207], v[176:179], v[44:47], 0
    ds_read_b128 v[156:159], v39 offset:17680
    s_waitcnt lgkmcnt(10)
    v_mfma_f32_16x16x32_bf16 v[204:207], v[180:183], v[48:51], v[204:207]
    v_fma_f32 v192, v192, s47, -v240
    v_fma_f32 v193, v193, s47, -v240
    v_fma_f32 v194, v194, s47, -v240
    v_fma_f32 v195, v195, s47, -v240
    v_fma_f32 v196, v196, s47, -v240
    v_fma_f32 v197, v197, s47, -v240
    v_fma_f32 v198, v198, s47, -v240
    v_fma_f32 v199, v199, s47, -v240
    v_cvt_pk_bf16_f32 v192, v192, v193
    v_cvt_pk_bf16_f32 v193, v194, v195
    v_cvt_pk_bf16_f32 v194, v196, v197
    v_cvt_pk_bf16_f32 v195, v198, v199
    buffer_store_dwordx4 v[192:195], v41, s[40:43], 0 offen offset:0 sc1
    ds_read_b128 v[160:163], v36 offset:24960
    s_waitcnt lgkmcnt(10)
    v_mfma_f32_16x16x32_bf16 v[204:207], v[184:187], v[52:55], v[204:207]
    ds_read_b128 v[164:167], v37 offset:24960
    s_waitcnt lgkmcnt(10)
    v_mfma_f32_16x16x32_bf16 v[204:207], v[188:191], v[56:59], v[204:207]
    ds_read_b128 v[168:171], v38 offset:24960
    s_waitcnt lgkmcnt(10)
    v_mfma_f32_16x16x32_bf16 v[208:211], v[128:131], v[44:47], 0
    ds_read_b128 v[172:175], v39 offset:24960
    s_waitcnt lgkmcnt(10)
    v_mfma_f32_16x16x32_bf16 v[208:211], v[132:135], v[48:51], v[208:211]
    ds_read_b128 v[176:179], v36 offset:26000
    s_waitcnt lgkmcnt(10)
    v_mfma_f32_16x16x32_bf16 v[208:211], v[136:139], v[52:55], v[208:211]
    ds_read_b128 v[180:183], v37 offset:26000
    s_waitcnt lgkmcnt(10)
    v_mfma_f32_16x16x32_bf16 v[208:211], v[140:143], v[56:59], v[208:211]
    ds_read_b128 v[184:187], v38 offset:26000
    s_waitcnt lgkmcnt(10)
    v_mfma_f32_16x16x32_bf16 v[212:215], v[144:147], v[44:47], 0
    ds_read_b128 v[188:191], v39 offset:26000
    s_waitcnt lgkmcnt(10)
    v_mfma_f32_16x16x32_bf16 v[212:215], v[148:151], v[48:51], v[212:215]
    v_fma_f32 v200, v200, s47, -v240
    v_fma_f32 v201, v201, s47, -v240
    v_fma_f32 v202, v202, s47, -v240
    v_fma_f32 v203, v203, s47, -v240
    v_fma_f32 v204, v204, s47, -v240
    v_fma_f32 v205, v205, s47, -v240
    v_fma_f32 v206, v206, s47, -v240
    v_fma_f32 v207, v207, s47, -v240
    v_cvt_pk_bf16_f32 v200, v200, v201
    v_cvt_pk_bf16_f32 v201, v202, v203
    v_cvt_pk_bf16_f32 v202, v204, v205
    v_cvt_pk_bf16_f32 v203, v206, v207
    buffer_store_dwordx4 v[200:203], v41, s[40:43], 0 offen offset:1024 sc1
    s_waitcnt lgkmcnt(9)
    v_mfma_f32_16x16x32_bf16 v[212:215], v[152:155], v[52:55], v[212:215]
    s_waitcnt lgkmcnt(8)
    v_mfma_f32_16x16x32_bf16 v[212:215], v[156:159], v[56:59], v[212:215]
    s_waitcnt lgkmcnt(7)
    v_mfma_f32_16x16x32_bf16 v[216:219], v[160:163], v[44:47], 0
    s_waitcnt lgkmcnt(6)
    v_mfma_f32_16x16x32_bf16 v[216:219], v[164:167], v[48:51], v[216:219]
    s_waitcnt lgkmcnt(5)
    v_mfma_f32_16x16x32_bf16 v[216:219], v[168:171], v[52:55], v[216:219]
    s_waitcnt lgkmcnt(4)
    v_mfma_f32_16x16x32_bf16 v[216:219], v[172:175], v[56:59], v[216:219]
    s_waitcnt lgkmcnt(3)
    v_mfma_f32_16x16x32_bf16 v[220:223], v[176:179], v[44:47], 0
    s_waitcnt lgkmcnt(2)
    v_mfma_f32_16x16x32_bf16 v[220:223], v[180:183], v[48:51], v[220:223]
    v_fma_f32 v208, v208, s47, -v240
    v_fma_f32 v209, v209, s47, -v240
    v_fma_f32 v210, v210, s47, -v240
    v_fma_f32 v211, v211, s47, -v240
    v_fma_f32 v212, v212, s47, -v240
    v_fma_f32 v213, v213, s47, -v240
    v_fma_f32 v214, v214, s47, -v240
    v_fma_f32 v215, v215, s47, -v240
    v_cvt_pk_bf16_f32 v208, v208, v209
    v_cvt_pk_bf16_f32 v209, v210, v211
    v_cvt_pk_bf16_f32 v210, v212, v213
    v_cvt_pk_bf16_f32 v211, v214, v215
    buffer_store_dwordx4 v[208:211], v41, s[40:43], 0 offen offset:2048 sc1
    s_waitcnt lgkmcnt(1)
    v_mfma_f32_16x16x32_bf16 v[220:223], v[184:187], v[52:55], v[220:223]
    s_waitcnt lgkmcnt(0)
    v_mfma_f32_16x16x32_bf16 v[220:223], v[188:191], v[56:59], v[220:223]
    s_nop 7
    v_fma_f32 v216, v216, s47, -v240
    v_fma_f32 v217, v217, s47, -v240
    v_fma_f32 v218, v218, s47, -v240
    v_fma_f32 v219, v219, s47, -v240
    v_fma_f32 v220, v220, s47, -v240
    v_fma_f32 v221, v221, s47, -v240
    v_fma_f32 v222, v222, s47, -v240
    v_fma_f32 v223, v223, s47, -v240
    v_cvt_pk_bf16_f32 v216, v216, v217
    v_cvt_pk_bf16_f32 v217, v218, v219
    v_cvt_pk_bf16_f32 v218, v220, v221
    v_cvt_pk_bf16_f32 v219, v222, v223
    buffer_store_dwordx4 v[216:219], v41, s[40:43], 0 offen offset:3072 sc1
    s_endpgm
K1_WROLE:
    s_waitcnt lgkmcnt(0)
    s_lshr_b32 s44, s2, 2
    s_and_b32 s48, s2, 3
    s_mov_b32 s28, s20
    s_mov_b32 s29, s21
    s_mov_b32 s30, 0x8000
    s_mov_b32 s31, 0x00020000
    s_add_u32 m0, s45, 0
    s_mov_b32 s47, s46
    buffer_load_dwordx4 v4, s[28:31], s47 offen lds
    s_add_u32 m0, m0, 1040
    s_add_u32 s47, s47, 1024
    buffer_load_dwordx4 v4, s[28:31], s47 offen lds
    s_add_u32 m0, m0, 1040
    s_add_u32 s47, s47, 1024
    buffer_load_dwordx4 v4, s[28:31], s47 offen lds
    s_add_u32 m0, m0, 1040
    s_add_u32 s47, s47, 1024
    buffer_load_dwordx4 v4, s[28:31], s47 offen lds
    s_add_u32 m0, m0, 1040
    s_add_u32 s47, s47, 1024
    buffer_load_dwordx4 v4, s[28:31], s47 offen lds
    s_add_u32 m0, m0, 1040
    s_add_u32 s47, s47, 1024
    buffer_load_dwordx4 v4, s[28:31], s47 offen lds
    s_add_u32 m0, m0, 1040
    s_add_u32 s47, s47, 1024
    buffer_load_dwordx4 v4, s[28:31], s47 offen lds
    s_add_u32 m0, m0, 1040
    s_add_u32 s47, s47, 1024
    buffer_load_dwordx4 v4, s[28:31], s47 offen lds
    s_cmp_eq_u32 s44, 0
    s_cselect_b32 s24, s18, s12
    s_cselect_b32 s25, s19, s13
    s_mov_b32 s26, 32768
    s_mov_b32 s27, 0x00020000
    s_add_u32 m0, s45, 33280
    s_mov_b32 s47, s46
    buffer_load_dwordx4 v4, s[24:27], s47 offen lds
    s_add_u32 m0, m0, 1040
    s_add_u32 s47, s47, 1024
    buffer_load_dwordx4 v4, s[24:27], s47 offen lds
    s_add_u32 m0, m0, 1040
    s_add_u32 s47, s47, 1024
    buffer_load_dwordx4 v4, s[24:27], s47 offen lds
    s_add_u32 m0, m0, 1040
    s_add_u32 s47, s47, 1024
    buffer_load_dwordx4 v4, s[24:27], s47 offen lds
    s_add_u32 m0, m0, 1040
    s_add_u32 s47, s47, 1024
    buffer_load_dwordx4 v4, s[24:27], s47 offen lds
    s_add_u32 m0, m0, 1040
    s_add_u32 s47, s47, 1024
    buffer_load_dwordx4 v4, s[24:27], s47 offen lds
    s_add_u32 m0, m0, 1040
    s_add_u32 s47, s47, 1024
    buffer_load_dwordx4 v4, s[24:27], s47 offen lds
    s_add_u32 m0, m0, 1040
    s_add_u32 s47, s47, 1024
    buffer_load_dwordx4 v4, s[24:27], s47 offen lds
    s_add_u32 s32, s22, 0x4f0000
    s_addc_u32 s33, s23, 0
    s_mov_b32 s34, 0x10000
    s_mov_b32 s35, 0x00020000
    v_lshrrev_b32 v25, 5, v1
    v_mul_u32_u24 v24, 2080, v25
    v_bfe_u32 v25, v1, 2, 2
    v_lshl_add_u32 v24, v25, 8, v24
    v_xor_b32 v25, s3, v25
    v_lshl_add_u32 v24, v25, 6, v24
    v_bfe_u32 v25, v1, 4, 1
    v_lshl_add_u32 v24, v25, 5, v24
    v_and_b32 v25, 3, v1
    v_lshl_add_u32 v24, v25, 3, v24
    v_and_b32 v25, 31, v1
    v_and_b32 v27, 4, v25
    v_and_b32 v28, 8, v25
    v_and_b32 v26, 0x13, v25
    v_lshl_or_b32 v26, v27, 1, v26
    v_lshrrev_b32 v28, 1, v28
    v_or_b32 v26, v26, v28
    s_cmp_eq_u32 s44, 0
    s_cselect_b64 vcc, -1, 0
    v_and_b32 v27, 8, v25
    v_and_b32 v28, 16, v25
    v_and_b32 v25, 7, v25
    v_lshl_or_b32 v25, v27, 1, v25
    v_lshrrev_b32 v28, 1, v28
    v_or_b32 v25, v25, v28
    v_cndmask_b32 v26, v26, v25, vcc
    s_mul_i32 s49, s48, 8320
    v_lshrrev_b32 v27, 2, v26
    v_add_u32 v27, v27, v6
    v_lshlrev_b32 v27, 4, v27
    v_lshl_add_u32 v27, v26, 8, v27
    v_add_u32 v27, s49, v27
    v_and_b32 v32, 3, v26
    v_xor_b32 v32, 0, v32
    v_lshl_add_u32 v28, v32, 6, v27
    v_and_b32 v32, 3, v26
    v_xor_b32 v32, 1, v32
    v_lshl_add_u32 v29, v32, 6, v27
    v_and_b32 v32, 3, v26
    v_xor_b32 v32, 2, v32
    v_lshl_add_u32 v30, v32, 6, v27
    v_and_b32 v32, 3, v26
    v_xor_b32 v32, 3, v32
    v_lshl_add_u32 v31, v32, 6, v27
    v_lshlrev_b32 v32, 4, v6
    v_add_u32 v32, 33280, v32
    v_bfe_u32 v42, v1, 4, 1
    v_lshlrev_b32 v42, 13, v42
    v_and_b32 v43, 15, v1
    v_lshl_add_u32 v42, v43, 4, v42
    v_lshl_add_u32 v42, v6, 8, v42
    s_lshl_b32 s50, s3, 14
    s_lshl_b32 s51, s2, 10
    s_add_u32 s50, s50, s51
    v_add_u32 v42, s50, v42
    s_getpc_b64 s[52:53]
K1_PC:
    s_add_u32 s52, s52, gps_attn_kernel - K1_PC
    s_addc_u32 s53, s53, 0
    v_lshlrev_b32 v44, 4, v0
    v_min_u32 v45, K2_END - gps_attn_kernel - 16, v44
    v_mov_b32 v47, s53
    v_add_co_u32 v46, vcc, s52, v45
    v_add_u32 v44, 4096, v44
    s_nop 0
    v_addc_co_u32 v47, vcc, 0, v47, vcc
    global_load_dwordx4 v[48:51], v[46:47], off
    v_min_u32 v45, K2_END - gps_attn_kernel - 16, v44
    v_mov_b32 v47, s53
    v_add_co_u32 v46, vcc, s52, v45
    v_add_u32 v44, 4096, v44
    s_nop 0
    v_addc_co_u32 v47, vcc, 0, v47, vcc
    global_load_dwordx4 v[48:51], v[46:47], off
    v_min_u32 v45, K2_END - gps_attn_kernel - 16, v44
    v_mov_b32 v47, s53
    v_add_co_u32 v46, vcc, s52, v45
    v_add_u32 v44, 4096, v44
    s_nop 0
    v_addc_co_u32 v47, vcc, 0, v47, vcc
    global_load_dwordx4 v[48:51], v[46:47], off
    v_min_u32 v45, K2_END - gps_attn_kernel - 16, v44
    v_mov_b32 v47, s53
    v_add_co_u32 v46, vcc, s52, v45
    v_add_u32 v44, 4096, v44
    s_nop 0
    v_addc_co_u32 v47, vcc, 0, v47, vcc
    global_load_dwordx4 v[48:51], v[46:47], off
    v_min_u32 v45, K2_END - gps_attn_kernel - 16, v44
    v_mov_b32 v47, s53
    v_add_co_u32 v46, vcc, s52, v45
    v_add_u32 v44, 4096, v44
    s_nop 0
    v_addc_co_u32 v47, vcc, 0, v47, vcc
    global_load_dwordx4 v[48:51], v[46:47], off
    v_min_u32 v45, K2_END - gps_attn_kernel - 16, v44
    v_mov_b32 v47, s53
    v_add_co_u32 v46, vcc, s52, v45
    v_add_u32 v44, 4096, v44
    s_nop 0
    v_addc_co_u32 v47, vcc, 0, v47, vcc
    global_load_dwordx4 v[48:51], v[46:47], off
    v_min_u32 v45, K2_END - gps_attn_kernel - 16, v44
    v_mov_b32 v47, s53
    v_add_co_u32 v46, vcc, s52, v45
    v_add_u32 v44, 4096, v44
    s_nop 0
    v_addc_co_u32 v47, vcc, 0, v47, vcc
    global_load_dwordx4 v[48:51], v[46:47], off
    v_min_u32 v45, K2_END - gps_attn_kernel - 16, v44
    v_mov_b32 v47, s53
    v_add_co_u32 v46, vcc, s52, v45
    v_add_u32 v44, 4096, v44
    s_nop 0
    v_addc_co_u32 v47, vcc, 0, v47, vcc
    global_load_dwordx4 v[48:51], v[46:47], off
    s_waitcnt vmcnt(8)
    s_barrier
    ds_read_b64_tr_b16 v[96:97], v24 offset:0
    ds_read_b64_tr_b16 v[98:99], v24 offset:1040
    ds_read_b64_tr_b16 v[100:101], v24 offset:4160
    ds_read_b64_tr_b16 v[102:103], v24 offset:5200
    ds_read_b64_tr_b16 v[104:105], v24 offset:8320
    ds_read_b64_tr_b16 v[106:107], v24 offset:9360
    ds_read_b64_tr_b16 v[108:109], v24 offset:12480
    ds_read_b64_tr_b16 v[110:111], v24 offset:13520
    ds_read_b64_tr_b16 v[112:113], v24 offset:16640
    ds_read_b64_tr_b16 v[114:115], v24 offset:17680
    ds_read_b64_tr_b16 v[116:117], v24 offset:20800
    ds_read_b64_tr_b16 v[118:119], v24 offset:21840
    ds_read_b64_tr_b16 v[120:121], v24 offset:24960
    ds_read_b64_tr_b16 v[122:123], v24 offset:26000
    ds_read_b64_tr_b16 v[124:125], v24 offset:29120
    ds_read_b64_tr_b16 v[126:127], v24 offset:30160
    s_waitcnt lgkmcnt(8)
    ds_read_b128 v[192:195], v28 offset:33280
    ds_read_b128 v[196:199], v28 offset:33312
    ds_read_b128 v[200:203], v29 offset:33280
    ds_read_b128 v[204:207], v29 offset:33312
    ds_read_b128 v[208:211], v30 offset:33280
    ds_read_b128 v[212:215], v30 offset:33312
    ds_read_b128 v[216:219], v31 offset:33280
    ds_read_b128 v[220:223], v31 offset:33312
    s_waitcnt lgkmcnt(8)
    ds_read_b128 v[224:227], v32 offset:33200
    ds_read_b128 v[228:231], v32 offset:33232
    ds_read_b128 v[232:235], v32 offset:33136
    ds_read_b128 v[236:239], v32 offset:33168
    ds_read_b128 v[240:243], v32 offset:33072
    ds_read_b128 v[244:247], v32 offset:33104
    ds_read_b128 v[248:251], v32 offset:33008
    ds_read_b128 v[252:255], v32 offset:33040
    s_waitcnt lgkmcnt(8)
    v_mfma_f32_32x32x16_bf16 v[160:175], v[192:195], v[96:99], 0
    v_mfma_f32_32x32x16_bf16 v[160:175], v[196:199], v[100:103], v[160:175]
    v_mfma_f32_32x32x16_bf16 v[160:175], v[200:203], v[104:107], v[160:175]
    v_mfma_f32_32x32x16_bf16 v[160:175], v[204:207], v[108:111], v[160:175]
    v_mfma_f32_32x32x16_bf16 v[160:175], v[208:211], v[112:115], v[160:175]
    v_mfma_f32_32x32x16_bf16 v[160:175], v[212:215], v[116:119], v[160:175]
    v_mfma_f32_32x32x16_bf16 v[160:175], v[216:219], v[120:123], v[160:175]
    v_mfma_f32_32x32x16_bf16 v[160:175], v[220:223], v[124:127], v[160:175]
    s_waitcnt lgkmcnt(0)
    v_mfma_f32_32x32x16_bf16 v[64:79], v[224:227], v[96:99], 0
    v_mfma_f32_32x32x16_bf16 v[64:79], v[228:231], v[100:103], v[64:79]
    v_mfma_f32_32x32x16_bf16 v[64:79], v[232:235], v[104:107], v[64:79]
    v_mfma_f32_32x32x16_bf16 v[64:79], v[236:239], v[108:111], v[64:79]
    v_mfma_f32_32x32x16_bf16 v[64:79], v[240:243], v[112:115], v[64:79]
    v_mfma_f32_32x32x16_bf16 v[64:79], v[244:247], v[116:119], v[64:79]
    v_mfma_f32_32x32x16_bf16 v[64:79], v[248:251], v[120:123], v[64:79]
    v_mfma_f32_32x32x16_bf16 v[64:79], v[252:255], v[124:127], v[64:79]
    s_nop 15
    v_sub_f32 v160, v160, v64
    v_sub_f32 v161, v161, v64
    v_sub_f32 v162, v162, v64
    v_sub_f32 v163, v163, v64
    v_sub_f32 v164, v164, v64
    v_sub_f32 v165, v165, v64
    v_sub_f32 v166, v166, v64
    v_sub_f32 v167, v167, v64
    v_sub_f32 v168, v168, v64
    v_sub_f32 v169, v169, v64
    v_sub_f32 v170, v170, v64
    v_sub_f32 v171, v171, v64
    v_sub_f32 v172, v172, v64
    v_sub_f32 v173, v173, v64
    v_sub_f32 v174, v174, v64
    v_sub_f32 v175, v175, v64
    v_cvt_pk_bf16_f32 v8, v160, v161
    v_cvt_pk_bf16_f32 v9, v162, v163
    v_cvt_pk_bf16_f32 v10, v164, v165
    v_cvt_pk_bf16_f32 v11, v166, v167
    v_cvt_pk_bf16_f32 v12, v168, v169
    v_cvt_pk_bf16_f32 v13, v170, v171
    v_cvt_pk_bf16_f32 v14, v172, v173
    v_cvt_pk_bf16_f32 v15, v174, v175
    buffer_store_dwordx4 v[8:11], v42, s[32:35], 0 offen sc1
    buffer_store_dwordx4 v[12:15], v42, s[32:35], 0 offen offset:512 sc1
    s_endpgm
K1_BIN:
    s_lshl_b32 s45, s44, 14
    v_lshl_add_u32 v3, v0, 4, s45
    s_waitcnt lgkmcnt(0)
    s_mov_b32 s28, s8
    s_mov_b32 s29, s9
    s_mov_b32 s30, 0x138800
    s_mov_b32 s31, 0x00020000
    s_mov_b32 s24, s6
    s_mov_b32 s25, s7
    s_mov_b32 s26, 0x138800
    s_mov_b32 s27, 0x00020000
    v_add_u32 v2, 4096, v3
    v_add_u32 v4, 8192, v3
    v_add_u32 v5, 12288, v3
    buffer_load_dwordx4 v[8:11], v3, s[28:31], 0 offen
    buffer_load_dwordx4 v[12:15], v2, s[28:31], 0 offen
    buffer_load_dwordx4 v[16:19], v4, s[28:31], 0 offen
    buffer_load_dwordx4 v[20:23], v5, s[28:31], 0 offen
    buffer_load_dwordx4 v[24:27], v3, s[24:27], 0 offen
    buffer_load_dwordx4 v[28:31], v2, s[24:27], 0 offen
    buffer_load_dwordx4 v[32:35], v4, s[24:27], 0 offen
    buffer_load_dwordx4 v[36:39], v5, s[24:27], 0 offen
    s_add_u32 s32, s22, 0x598000
    s_addc_u32 s33, s23, 0
    s_mov_b32 s34, 0x350a20
    s_mov_b32 s35, 0x00020000
    s_add_u32 s36, s22, 0x2400000
    s_addc_u32 s37, s23, 0
    s_mov_b32 s38, 0x278000
    s_mov_b32 s39, 0x00020000
    s_add_u32 s40, s22, 0x500000
    s_addc_u32 s41, s23, 0
    s_mov_b32 s42, 0x13c
    s_mov_b32 s43, 0x00020000
    v_mov_b32 v56, 0
    v_mov_b32 v57, 0
    v_mov_b32 v58, 0
    v_mov_b32 v59, 0
    v_lshlrev_b32 v60, 4, v0
    ds_write_b128 v60, v[56:59] offset:0
    ds_write_b128 v60, v[56:59] offset:4096
    ds_write_b128 v60, v[56:59] offset:8192
    ds_write_b128 v60, v[56:59] offset:12288
    ds_write_b128 v60, v[56:59] offset:16384
    ds_write_b128 v60, v[56:59] offset:20480
    ds_write_b128 v60, v[56:59] offset:24576
    ds_write_b128 v60, v[56:59] offset:28672
    ds_write_b128 v60, v[56:59] offset:32768
    ds_write_b128 v60, v[56:59] offset:36864
    ds_write_b128 v60, v[56:59] offset:40960
    ds_write_b128 v60, v[56:59] offset:45056
    v_mov_b32 v61, 1
    s_mov_b32 s46, 52429
    s_mov_b32 s47, 1280000
    v_cmp_gt_u32 s[48:49], s47, v3
    v_cmp_gt_u32 s[50:51], s47, v2
    v_cmp_gt_u32 s[52:53], s47, v4
    v_cmp_gt_u32 s[54:55], s47, v5
    s_mov_b32 s58, 47663
    s_mul_i32 s59, s44, 176
    s_mov_b32 s60, 13728
    v_add_u32 v62, 0, v0
    v_mul_u32_u24 v63, s58, v62
    v_lshrrev_b32 v63, 19, v63
    v_mul_u32_u24 v63, s60, v63
    v_lshl_add_u32 v63, v62, 4, v63
    v_add_u32 v112, s59, v63
    v_add_u32 v62, 256, v0
    v_mul_u32_u24 v63, s58, v62
    v_lshrrev_b32 v63, 19, v63
    v_mul_u32_u24 v63, s60, v63
    v_lshl_add_u32 v63, v62, 4, v63
    v_add_u32 v113, s59, v63
    v_add_u32 v62, 512, v0
    v_mul_u32_u24 v63, s58, v62
    v_lshrrev_b32 v63, 19, v63
    v_mul_u32_u24 v63, s60, v63
    v_lshl_add_u32 v63, v62, 4, v63
    v_add_u32 v114, s59, v63
    v_add_u32 v62, 768, v0
    v_mul_u32_u24 v63, s58, v62
    v_lshrrev_b32 v63, 19, v63
    v_mul_u32_u24 v63, s60, v63
    v_lshl_add_u32 v63, v62, 4, v63
    v_add_u32 v115, s59, v63
    v_add_u32 v62, 1024, v0
    v_mul_u32_u24 v63, s58, v62
    v_lshrrev_b32 v63, 19, v63
    v_mul_u32_u24 v63, s60, v63
    v_lshl_add_u32 v63, v62, 4, v63
    v_add_u32 v116, s59, v63
    v_add_u32 v62, 1280, v0
    v_mul_u32_u24 v63, s58, v62
    v_lshrrev_b32 v63, 19, v63
    v_mul_u32_u24 v63, s60, v63
    v_lshl_add_u32 v63, v62, 4, v63
    v_add_u32 v117, s59, v63
    v_add_u32 v62, 1536, v0
    v_mul_u32_u24 v63, s58, v62
    v_lshrrev_b32 v63, 19, v63
    v_mul_u32_u24 v63, s60, v63
    v_lshl_add_u32 v63, v62, 4, v63
    v_add_u32 v118, s59, v63
    v_add_u32 v62, 1792, v0
    v_mul_u32_u24 v63, s58, v62
    v_lshrrev_b32 v63, 19, v63
    v_mul_u32_u24 v63, s60, v63
    v_lshl_add_u32 v63, v62, 4, v63
    v_add_u32 v119, s59, v63
    v_add_u32 v62, 2048, v0
    v_mul_u32_u24 v63, s58, v62
    v_lshrrev_b32 v63, 19, v63
    v_mul_u32_u24 v63, s60, v63
    v_lshl_add_u32 v63, v62, 4, v63
    v_add_u32 v120, s59, v63
    v_add_u32 v62, 2304, v0
    v_mul_u32_u24 v63, s58, v62
    v_lshrrev_b32 v63, 19, v63
    v_mul_u32_u24 v63, s60, v63
    v_lshl_add_u32 v63, v62, 4, v63
    v_add_u32 v121, s59, v63
    v_add_u32 v62, 2560, v0
    v_mul_u32_u24 v63, s58, v62
    v_lshrrev_b32 v63, 19, v63
    v_mul_u32_u24 v63, s60, v63
    v_lshl_add_u32 v63, v62, 4, v63
    v_add_u32 v122, s59, v63
    v_lshlrev_b32 v56, 2, v1
    v_add_u32 v56, 46080, v56
    v_mov_b32 v57, 0
    s_waitcnt lgkmcnt(0)
    s_barrier
    s_waitcnt vmcnt(7)
    s_mov_b64 exec, s[48:49]
    v_mul_u32_u24 v64, s46, v8
    v_lshrrev_b32 v64, 21, v64
    v_min_u32 v64, 249, v64
    v_lshlrev_b32 v62, 2, v64
    ds_add_rtn_u32 v40, v62, v61
    v_mul_u32_u24 v65, s46, v9
    v_lshrrev_b32 v65, 21, v65
    v_min_u32 v65, 249, v65
    v_lshlrev_b32 v62, 2, v65
    ds_add_rtn_u32 v41, v62, v61
    v_mul_u32_u24 v66, s46, v10
    v_lshrrev_b32 v66, 21, v66
    v_min_u32 v66, 249, v66
    v_lshlrev_b32 v62, 2, v66
    ds_add_rtn_u32 v42, v62, v61
    v_mul_u32_u24 v67, s46, v11
    v_lshrrev_b32 v67, 21, v67
    v_min_u32 v67, 249, v67
    v_lshlrev_b32 v62, 2, v67
    ds_add_rtn_u32 v43, v62, v61
    s_waitcnt vmcnt(6)
    s_mov_b64 exec, s[50:51]
    v_mul_u32_u24 v68, s46, v12
    v_lshrrev_b32 v68, 21, v68
    v_min_u32 v68, 249, v68
    v_lshlrev_b32 v62, 2, v68
    ds_add_rtn_u32 v44, v62, v61
    v_mul_u32_u24 v69, s46, v13
    v_lshrrev_b32 v69, 21, v69
    v_min_u32 v69, 249, v69
    v_lshlrev_b32 v62, 2, v69
    ds_add_rtn_u32 v45, v62, v61
    v_mul_u32_u24 v70, s46, v14
    v_lshrrev_b32 v70, 21, v70
    v_min_u32 v70, 249, v70
    v_lshlrev_b32 v62, 2, v70
    ds_add_rtn_u32 v46, v62, v61
    v_mul_u32_u24 v71, s46, v15
    v_lshrrev_b32 v71, 21, v71
    v_min_u32 v71, 249, v71
    v_lshlrev_b32 v62, 2, v71
    ds_add_rtn_u32 v47, v62, v61
    s_waitcnt vmcnt(5)
    s_mov_b64 exec, s[52:53]
    v_mul_u32_u24 v72, s46, v16
    v_lshrrev_b32 v72, 21, v72
    v_min_u32 v72, 249, v72
    v_lshlrev_b32 v62, 2, v72
    ds_add_rtn_u32 v48, v62, v61
    v_mul_u32_u24 v73, s46, v17
    v_lshrrev_b32 v73, 21, v73
    v_min_u32 v73, 249, v73
    v_lshlrev_b32 v62, 2, v73
    ds_add_rtn_u32 v49, v62, v61
    v_mul_u32_u24 v74, s46, v18
    v_lshrrev_b32 v74, 21, v74
    v_min_u32 v74, 249, v74
    v_lshlrev_b32 v62, 2, v74
    ds_add_rtn_u32 v50, v62, v61
    v_mul_u32_u24 v75, s46, v19
    v_lshrrev_b32 v75, 21, v75
    v_min_u32 v75, 249, v75
    v_lshlrev_b32 v62, 2, v75
    ds_add_rtn_u32 v51, v62, v61
    s_waitcnt vmcnt(4)
    s_mov_b64 exec, s[54:55]
    v_mul_u32_u24 v76, s46, v20
    v_lshrrev_b32 v76, 21, v76
    v_min_u32 v76, 249, v76
    v_lshlrev_b32 v62, 2, v76
    ds_add_rtn_u32 v52, v62, v61
    v_mul_u32_u24 v77, s46, v21
    v_lshrrev_b32 v77, 21, v77
    v_min_u32 v77, 249, v77
    v_lshlrev_b32 v62, 2, v77
    ds_add_rtn_u32 v53, v62, v61
    v_mul_u32_u24 v78, s46, v22
    v_lshrrev_b32 v78, 21, v78
    v_min_u32 v78, 249, v78
    v_lshlrev_b32 v62, 2, v78
    ds_add_rtn_u32 v54, v62, v61
    v_mul_u32_u24 v79, s46, v23
    v_lshrrev_b32 v79, 21, v79
    v_min_u32 v79, 249, v79
    v_lshlrev_b32 v62, 2, v79
    ds_add_rtn_u32 v55, v62, v61
    s_mov_b64 exec, -1
    s_movk_i32 s46, -40
    s_mov_b32 s47, 0x80000000
    s_waitcnt vmcnt(3)
    v_mad_i32_i24 v62, v64, s46, v8
    v_lshlrev_b32 v24, 8, v24
    v_lshl_or_b32 v24, v62, 24, v24
    v_or_b32 v24, s47, v24
    v_mul_u32_u24 v64, 176, v64
    v_mad_i32_i24 v62, v65, s46, v9
    v_lshlrev_b32 v25, 8, v25
    v_lshl_or_b32 v25, v62, 24, v25
    v_or_b32 v25, s47, v25
    v_mul_u32_u24 v65, 176, v65
    v_mad_i32_i24 v62, v66, s46, v10
    v_lshlrev_b32 v26, 8, v26
    v_lshl_or_b32 v26, v62, 24, v26
    v_or_b32 v26, s47, v26
    v_mul_u32_u24 v66, 176, v66
    v_mad_i32_i24 v62, v67, s46, v11
    v_lshlrev_b32 v27, 8, v27
    v_lshl_or_b32 v27, v62, 24, v27
    v_or_b32 v27, s47, v27
    v_mul_u32_u24 v67, 176, v67
    s_waitcnt vmcnt(2)
    v_mad_i32_i24 v62, v68, s46, v12
    v_lshlrev_b32 v28, 8, v28
    v_lshl_or_b32 v28, v62, 24, v28
    v_or_b32 v28, s47, v28
    v_mul_u32_u24 v68, 176, v68
    v_mad_i32_i24 v62, v69, s46, v13
    v_lshlrev_b32 v29, 8, v29
    v_lshl_or_b32 v29, v62, 24, v29
    v_or_b32 v29, s47, v29
    v_mul_u32_u24 v69, 176, v69
    v_mad_i32_i24 v62, v70, s46, v14
    v_lshlrev_b32 v30, 8, v30
    v_lshl_or_b32 v30, v62, 24, v30
    v_or_b32 v30, s47, v30
    v_mul_u32_u24 v70, 176, v70
    v_mad_i32_i24 v62, v71, s46, v15
    v_lshlrev_b32 v31, 8, v31
    v_lshl_or_b32 v31, v62, 24, v31
    v_or_b32 v31, s47, v31
    v_mul_u32_u24 v71, 176, v71
    s_waitcnt vmcnt(1)
    v_mad_i32_i24 v62, v72, s46, v16
    v_lshlrev_b32 v32, 8, v32
    v_lshl_or_b32 v32, v62, 24, v32
    v_or_b32 v32, s47, v32
    v_mul_u32_u24 v72, 176, v72
    v_mad_i32_i24 v62, v73, s46, v17
    v_lshlrev_b32 v33, 8, v33
    v_lshl_or_b32 v33, v62, 24, v33
    v_or_b32 v33, s47, v33
    v_mul_u32_u24 v73, 176, v73
    v_mad_i32_i24 v62, v74, s46, v18
    v_lshlrev_b32 v34, 8, v34
    v_lshl_or_b32 v34, v62, 24, v34
    v_or_b32 v34, s47, v34
    v_mul_u32_u24 v74, 176, v74
    v_mad_i32_i24 v62, v75, s46, v19
    v_lshlrev_b32 v35, 8, v35
    v_lshl_or_b32 v35, v62, 24, v35
    v_or_b32 v35, s47, v35
    v_mul_u32_u24 v75, 176, v75
    s_waitcnt vmcnt(0)
    v_mad_i32_i24 v62, v76, s46, v20
    v_lshlrev_b32 v36, 8, v36
    v_lshl_or_b32 v36, v62, 24, v36
    v_or_b32 v36, s47, v36
    v_mul_u32_u24 v76, 176, v76
    v_mad_i32_i24 v62, v77, s46, v21
    v_lshlrev_b32 v37, 8, v37
    v_lshl_or_b32 v37, v62, 24, v37
    v_or_b32 v37, s47, v37
    v_mul_u32_u24 v77, 176, v77
    v_mad_i32_i24 v62, v78, s46, v22
    v_lshlrev_b32 v38, 8, v38
    v_lshl_or_b32 v38, v62, 24, v38
    v_or_b32 v38, s47, v38
    v_mul_u32_u24 v78, 176, v78
    v_mad_i32_i24 v62, v79, s46, v23
    v_lshlrev_b32 v39, 8, v39
    v_lshl_or_b32 v39, v62, 24, v39
    v_or_b32 v39, s47, v39
    v_mul_u32_u24 v79, 176, v79
    s_waitcnt lgkmcnt(0)
    s_mov_b64 exec, s[48:49]
    v_cmp_gt_u32 vcc, 44, v40
    v_lshl_add_u32 v63, v40, 2, v64
    v_max_u32 v57, v57, v40
    v_cndmask_b32 v63, v56, v63, vcc
    ds_write_b32 v63, v24 offset:1088
    v_cmp_gt_u32 vcc, 44, v41
    v_lshl_add_u32 v63, v41, 2, v65
    v_max_u32 v57, v57, v41
    v_cndmask_b32 v63, v56, v63, vcc
    ds_write_b32 v63, v25 offset:1088
    v_cmp_gt_u32 vcc, 44, v42
    v_lshl_add_u32 v63, v42, 2, v66
    v_max_u32 v57, v57, v42
    v_cndmask_b32 v63, v56, v63, vcc
    ds_write_b32 v63, v26 offset:1088
    v_cmp_gt_u32 vcc, 44, v43
    v_lshl_add_u32 v63, v43, 2, v67
    v_max_u32 v57, v57, v43
    v_cndmask_b32 v63, v56, v63, vcc
    ds_write_b32 v63, v27 offset:1088
    s_mov_b64 exec, s[50:51]
    v_cmp_gt_u32 vcc, 44, v44
    v_lshl_add_u32 v63, v44, 2, v68
    v_max_u32 v57, v57, v44
    v_cndmask_b32 v63, v56, v63, vcc
    ds_write_b32 v63, v28 offset:1088
    v_cmp_gt_u32 vcc, 44, v45
    v_lshl_add_u32 v63, v45, 2, v69
    v_max_u32 v57, v57, v45
    v_cndmask_b32 v63, v56, v63, vcc
    ds_write_b32 v63, v29 offset:1088
    v_cmp_gt_u32 vcc, 44, v46
    v_lshl_add_u32 v63, v46, 2, v70
    v_max_u32 v57, v57, v46
    v_cndmask_b32 v63, v56, v63, vcc
    ds_write_b32 v63, v30 offset:1088
    v_cmp_gt_u32 vcc, 44, v47
    v_lshl_add_u32 v63, v47, 2, v71
    v_max_u32 v57, v57, v47
    v_cndmask_b32 v63, v56, v63, vcc
    ds_write_b32 v63, v31 offset:1088
    s_mov_b64 exec, s[52:53]
    v_cmp_gt_u32 vcc, 44, v48
    v_lshl_add_u32 v63, v48, 2, v72
    v_max_u32 v57, v57, v48
    v_cndmask_b32 v63, v56, v63, vcc
    ds_write_b32 v63, v32 offset:1088
    v_cmp_gt_u32 vcc, 44, v49
    v_lshl_add_u32 v63, v49, 2, v73
    v_max_u32 v57, v57, v49
    v_cndmask_b32 v63, v56, v63, vcc
    ds_write_b32 v63, v33 offset:1088
    v_cmp_gt_u32 vcc, 44, v50
    v_lshl_add_u32 v63, v50, 2, v74
    v_max_u32 v57, v57, v50
    v_cndmask_b32 v63, v56, v63, vcc
    ds_write_b32 v63, v34 offset:1088
    v_cmp_gt_u32 vcc, 44, v51
    v_lshl_add_u32 v63, v51, 2, v75
    v_max_u32 v57, v57, v51
    v_cndmask_b32 v63, v56, v63, vcc
    ds_write_b32 v63, v35 offset:1088
    s_mov_b64 exec, s[54:55]
    v_cmp_gt_u32 vcc, 44, v52
    v_lshl_add_u32 v63, v52, 2, v76
    v_max_u32 v57, v57, v52
    v_cndmask_b32 v63, v56, v63, vcc
    ds_write_b32 v63, v36 offset:1088
    v_cmp_gt_u32 vcc, 44, v53
    v_lshl_add_u32 v63, v53, 2, v77
    v_max_u32 v57, v57, v53
    v_cndmask_b32 v63, v56, v63, vcc
    ds_write_b32 v63, v37 offset:1088
    v_cmp_gt_u32 vcc, 44, v54
    v_lshl_add_u32 v63, v54, 2, v78
    v_max_u32 v57, v57, v54
    v_cndmask_b32 v63, v56, v63, vcc
    ds_write_b32 v63, v38 offset:1088
    v_cmp_gt_u32 vcc, 44, v55
    v_lshl_add_u32 v63, v55, 2, v79
    v_max_u32 v57, v57, v55
    v_cndmask_b32 v63, v56, v63, vcc
    ds_write_b32 v63, v39 offset:1088
    s_mov_b64 exec, -1
    v_cmp_le_u32 s[56:57], 44, v57
    s_nop 1
    s_cmp_eq_u64 s[56:57], 0
    s_cbranch_scc1 K1_NOOVF
    v_mov_b32 v62, 1024
    s_lshl_b32 s46, s44, 15
    s_mov_b64 exec, s[48:49]
    v_cmp_le_u32 vcc, 44, v40
    s_mov_b64 exec, vcc
    s_cbranch_execz L_k1o_1
    ds_add_rtn_u32 v63, v62, v61
    v_mov_b32 v56, v24
    v_mov_b32 v57, v8
    s_waitcnt lgkmcnt(0)
    v_lshl_add_u32 v63, v63, 3, s46
    buffer_store_dwordx2 v[56:57], v63, s[36:39], 0 offen
    s_nop 1
L_k1o_1:
    s_mov_b64 exec, s[48:49]
    v_cmp_le_u32 vcc, 44, v41
    s_mov_b64 exec, vcc
    s_cbranch_execz L_k1o_2
    ds_add_rtn_u32 v63, v62, v61
    v_mov_b32 v56, v25
    v_mov_b32 v57, v9
    s_waitcnt lgkmcnt(0)
    v_lshl_add_u32 v63, v63, 3, s46
    buffer_store_dwordx2 v[56:57], v63, s[36:39], 0 offen
    s_nop 1
L_k1o_2:
    s_mov_b64 exec, s[48:49]
    v_cmp_le_u32 vcc, 44, v42
    s_mov_b64 exec, vcc
    s_cbranch_execz L_k1o_3
    ds_add_rtn_u32 v63, v62, v61
    v_mov_b32 v56, v26
    v_mov_b32 v57, v10
    s_waitcnt lgkmcnt(0)
    v_lshl_add_u32 v63, v63, 3, s46
    buffer_store_dwordx2 v[56:57], v63, s[36:39], 0 offen
    s_nop 1
L_k1o_3:
    s_mov_b64 exec, s[48:49]
    v_cmp_le_u32 vcc, 44, v43
    s_mov_b64 exec, vcc
    s_cbranch_execz L_k1o_4
    ds_add_rtn_u32 v63, v62, v61
    v_mov_b32 v56, v27
    v_mov_b32 v57, v11
    s_waitcnt lgkmcnt(0)
    v_lshl_add_u32 v63, v63, 3, s46
    buffer_store_dwordx2 v[56:57], v63, s[36:39], 0 offen
    s_nop 1
L_k1o_4:
    s_mov_b64 exec, s[50:51]
    v_cmp_le_u32 vcc, 44, v44
    s_mov_b64 exec, vcc
    s_cbranch_execz L_k1o_5
    ds_add_rtn_u32 v63, v62, v61
    v_mov_b32 v56, v28
    v_mov_b32 v57, v12
    s_waitcnt lgkmcnt(0)
    v_lshl_add_u32 v63, v63, 3, s46
    buffer_store_dwordx2 v[56:57], v63, s[36:39], 0 offen
    s_nop 1
L_k1o_5:
    s_mov_b64 exec, s[50:51]
    v_cmp_le_u32 vcc, 44, v45
    s_mov_b64 exec, vcc
    s_cbranch_execz L_k1o_6
    ds_add_rtn_u32 v63, v62, v61
    v_mov_b32 v56, v29
    v_mov_b32 v57, v13
    s_waitcnt lgkmcnt(0)
    v_lshl_add_u32 v63, v63, 3, s46
    buffer_store_dwordx2 v[56:57], v63, s[36:39], 0 offen
    s_nop 1
L_k1o_6:
    s_mov_b64 exec, s[50:51]
    v_cmp_le_u32 vcc, 44, v46
    s_mov_b64 exec, vcc
    s_cbranch_execz L_k1o_7
    ds_add_rtn_u32 v63, v62, v61
    v_mov_b32 v56, v30
    v_mov_b32 v57, v14
    s_waitcnt lgkmcnt(0)
    v_lshl_add_u32 v63, v63, 3, s46
    buffer_store_dwordx2 v[56:57], v63, s[36:39], 0 offen
    s_nop 1
L_k1o_7:
    s_mov_b64 exec, s[50:51]
    v_cmp_le_u32 vcc, 44, v47
    s_mov_b64 exec, vcc
    s_cbranch_execz L_k1o_8
    ds_add_rtn_u32 v63, v62, v61
    v_mov_b32 v56, v31
    v_mov_b32 v57, v15
    s_waitcnt lgkmcnt(0)
    v_lshl_add_u32 v63, v63, 3, s46
    buffer_store_dwordx2 v[56:57], v63, s[36:39], 0 offen
    s_nop 1
L_k1o_8:
    s_mov_b64 exec, s[52:53]
    v_cmp_le_u32 vcc, 44, v48
    s_mov_b64 exec, vcc
    s_cbranch_execz L_k1o_9
    ds_add_rtn_u32 v63, v62, v61
    v_mov_b32 v56, v32
    v_mov_b32 v57, v16
    s_waitcnt lgkmcnt(0)
    v_lshl_add_u32 v63, v63, 3, s46
    buffer_store_dwordx2 v[56:57], v63, s[36:39], 0 offen
    s_nop 1
L_k1o_9:
    s_mov_b64 exec, s[52:53]
    v_cmp_le_u32 vcc, 44, v49
    s_mov_b64 exec, vcc
    s_cbranch_execz L_k1o_10
    ds_add_rtn_u32 v63, v62, v61
    v_mov_b32 v56, v33
    v_mov_b32 v57, v17
    s_waitcnt lgkmcnt(0)
    v_lshl_add_u32 v63, v63, 3, s46
    buffer_store_dwordx2 v[56:57], v63, s[36:39], 0 offen
    s_nop 1
L_k1o_10:
    s_mov_b64 exec, s[52:53]
    v_cmp_le_u32 vcc, 44, v50
    s_mov_b64 exec, vcc
    s_cbranch_execz L_k1o_11
    ds_add_rtn_u32 v63, v62, v61
    v_mov_b32 v56, v34
    v_mov_b32 v57, v18
    s_waitcnt lgkmcnt(0)
    v_lshl_add_u32 v63, v63, 3, s46
    buffer_store_dwordx2 v[56:57], v63, s[36:39], 0 offen
    s_nop 1
L_k1o_11:
    s_mov_b64 exec, s[52:53]
    v_cmp_le_u32 vcc, 44, v51
    s_mov_b64 exec, vcc
    s_cbranch_execz L_k1o_12
    ds_add_rtn_u32 v63, v62, v61
    v_mov_b32 v56, v35
    v_mov_b32 v57, v19
    s_waitcnt lgkmcnt(0)
    v_lshl_add_u32 v63, v63, 3, s46
    buffer_store_dwordx2 v[56:57], v63, s[36:39], 0 offen
    s_nop 1
L_k1o_12:
    s_mov_b64 exec, s[54:55]
    v_cmp_le_u32 vcc, 44, v52
    s_mov_b64 exec, vcc
    s_cbranch_execz L_k1o_13
    ds_add_rtn_u32 v63, v62, v61
    v_mov_b32 v56, v36
    v_mov_b32 v57, v20
    s_waitcnt lgkmcnt(0)
    v_lshl_add_u32 v63, v63, 3, s46
    buffer_store_dwordx2 v[56:57], v63, s[36:39], 0 offen
    s_nop 1
L_k1o_13:
    s_mov_b64 exec, s[54:55]
    v_cmp_le_u32 vcc, 44, v53
    s_mov_b64 exec, vcc
    s_cbranch_execz L_k1o_14
    ds_add_rtn_u32 v63, v62, v61
    v_mov_b32 v56, v37
    v_mov_b32 v57, v21
    s_waitcnt lgkmcnt(0)
    v_lshl_add_u32 v63, v63, 3, s46
    buffer_store_dwordx2 v[56:57], v63, s[36:39], 0 offen
    s_nop 1
L_k1o_14:
    s_mov_b64 exec, s[54:55]
    v_cmp_le_u32 vcc, 44, v54
    s_mov_b64 exec, vcc
    s_cbranch_execz L_k1o_15
    ds_add_rtn_u32 v63, v62, v61
    v_mov_b32 v56, v38
    v_mov_b32 v57, v22
    s_waitcnt lgkmcnt(0)
    v_lshl_add_u32 v63, v63, 3, s46
    buffer_store_dwordx2 v[56:57], v63, s[36:39], 0 offen
    s_nop 1
L_k1o_15:
    s_mov_b64 exec, s[54:55]
    v_cmp_le_u32 vcc, 44, v55
    s_mov_b64 exec, vcc
    s_cbranch_execz L_k1o_16
    ds_add_rtn_u32 v63, v62, v61
    v_mov_b32 v56, v39
    v_mov_b32 v57, v23
    s_waitcnt lgkmcnt(0)
    v_lshl_add_u32 v63, v63, 3, s46
    buffer_store_dwordx2 v[56:57], v63, s[36:39], 0 offen
    s_nop 1
L_k1o_16:
    s_mov_b64 exec, -1
K1_NOOVF:
    s_waitcnt lgkmcnt(0)
    s_barrier
    v_mov_b32 v62, 1024
    ds_read_b32 v63, v62
    ds_read_b128 v[64:67], v60 offset:1088
    ds_read_b128 v[68:71], v60 offset:5184
    ds_read_b128 v[72:75], v60 offset:9280
    ds_read_b128 v[76:79], v60 offset:13376
    ds_read_b128 v[80:83], v60 offset:17472
    ds_read_b128 v[84:87], v60 offset:21568
    ds_read_b128 v[88:91], v60 offset:25664
    ds_read_b128 v[92:95], v60 offset:29760
    ds_read_b128 v[96:99], v60 offset:33856
    ds_read_b128 v[100:103], v60 offset:37952
    ds_read_b128 v[104:107], v60 offset:42048
    s_lshl_b32 s49, s44, 2
    v_mov_b32 v61, s49
    s_waitcnt lgkmcnt(10)
    buffer_store_dwordx4 v[64:67], v112, s[32:35], 0 offen
    s_waitcnt lgkmcnt(9)
    buffer_store_dwordx4 v[68:71], v113, s[32:35], 0 offen
    s_waitcnt lgkmcnt(8)
    buffer_store_dwordx4 v[72:75], v114, s[32:35], 0 offen
    s_waitcnt lgkmcnt(7)
    buffer_store_dwordx4 v[76:79], v115, s[32:35], 0 offen
    s_waitcnt lgkmcnt(6)
    buffer_store_dwordx4 v[80:83], v116, s[32:35], 0 offen
    s_waitcnt lgkmcnt(5)
    buffer_store_dwordx4 v[84:87], v117, s[32:35], 0 offen
    s_waitcnt lgkmcnt(4)
    buffer_store_dwordx4 v[88:91], v118, s[32:35], 0 offen
    s_waitcnt lgkmcnt(3)
    buffer_store_dwordx4 v[92:95], v119, s[32:35], 0 offen
    s_waitcnt lgkmcnt(2)
    buffer_store_dwordx4 v[96:99], v120, s[32:35], 0 offen
    s_waitcnt lgkmcnt(1)
    buffer_store_dwordx4 v[100:103], v121, s[32:35], 0 offen
    s_waitcnt lgkmcnt(0)
    buffer_store_dwordx4 v[104:107], v122, s[32:35], 0 offen
    buffer_store_dword v63, v61, s[40:43], 0 offen
K1_END:
    s_endpgm
.section .rodata,"a"
.p2align 6
.amdhsa_kernel gps_prep_kernel
  .amdhsa_next_free_vgpr 256
  .amdhsa_next_free_sgpr 96
  .amdhsa_accum_offset 256
  .amdhsa_group_segment_fixed_size 0
  .amdhsa_kernarg_size 96
  .amdhsa_user_sgpr_count 2
  .amdhsa_user_sgpr_kernarg_segment_ptr 1
  .amdhsa_system_sgpr_workgroup_id_x 1
.end_amdhsa_kernel
.text
.globl gps_attn_kernel
.p2align 8
.type gps_attn_kernel,@function
gps_attn_kernel:
    s_load_dwordx2 s[4:5], s[0:1], 88
    s_load_dwordx2 s[6:7], s[0:1], 24
    s_load_dwordx4 s[72:75], s[0:1], 72
    s_load_dwordx2 s[76:77], s[0:1], 0
    s_cmp_ge_u32 s2, 256
    s_cbranch_scc1 K2_END
    s_getpc_b64 s[46:47]
K2_PC0:
    v_lshlrev_b32 v232, 4, v0
    s_bfe_u32 s36, s2, 0x30003
    s_lshl_b32 s36, s36, 12
    s_add_u32 s36, s36, 8192
    v_add_u32 v233, 4096, v232
    v_add_u32 v238, s36, v232
    v_min_u32 v238, K2_END - K2_PC0 - 16, v238
    v_mov_b32 v235, s47
    v_add_co_u32 v234, vcc, s46, v232
    s_nop 1
    v_addc_co_u32 v235, vcc, 0, v235, vcc
    global_load_dwordx4 a[248:251], v[234:235], off
    v_mov_b32 v235, s47
    v_add_co_u32 v234, vcc, s46, v233
    s_nop 1
    v_addc_co_u32 v235, vcc, 0, v235, vcc
    global_load_dwordx4 a[248:251], v[234:235], off
    v_mov_b32 v235, s47
    v_add_co_u32 v234, vcc, s46, v238
    s_nop 1
    v_addc_co_u32 v235, vcc, 0, v235, vcc
    global_load_dwordx4 a[248:251], v[234:235], off
    s_and_b32 s36, s2, 7
    s_lshr_b32 s2, s2, 3
    s_lshl_b32 s36, s36, 5
    s_add_u32 s2, s2, s36
    v_and_b32 v225, 63, v0
    v_lshrrev_b32 v226, 6, v0
    v_lshlrev_b32 v222, 4, v225
    v_readfirstlane_b32 s3, v226
    v_mov_b32 v223, v0
    s_mul_i32 s36, s2, 13904
    s_movk_i32 s37, 3319
    s_movk_i32 s38, -13888
    v_add_u32 v232, 0, v0
    v_mul_u32_u24 v233, s37, v232
    v_lshrrev_b32 v233, 18, v233
    v_mul_u32_u24 v232, 176, v232
    v_mad_i32_i24 v232, v233, s38, v232
    v_add_u32 v226, s36, v232
    v_add_u32 v232, 256, v0
    v_mul_u32_u24 v233, s37, v232
    v_lshrrev_b32 v233, 18, v233
    v_mul_u32_u24 v232, 176, v232
    v_mad_i32_i24 v232, v233, s38, v232
    v_add_u32 v227, s36, v232
    v_add_u32 v232, 512, v0
    v_mul_u32_u24 v233, s37, v232
    v_lshrrev_b32 v233, 18, v233
    v_mul_u32_u24 v232, 176, v232
    v_mad_i32_i24 v232, v233, s38, v232
    v_add_u32 v228, s36, v232
    v_add_u32 v232, 768, v0
    v_mul_u32_u24 v233, s37, v232
    v_lshrrev_b32 v233, 18, v233
    v_mul_u32_u24 v232, 176, v232
    v_mad_i32_i24 v232, v233, s38, v232
    v_add_u32 v229, s36, v232
    v_cmp_gt_u32 vcc, 101, v0
    v_mov_b32 v230, 0x7f000000
    v_lshlrev_b32 v231, 2, v225
    v_cndmask_b32 v229, v230, v229, vcc
    s_mul_i32 s36, s2, 395
    s_add_u32 s37, s36, 395
    s_lshr_b32 s36, s36, 4
    s_lshr_b32 s37, s37, 4
    s_mul_hi_u32 s24, s36, 0x19ec8ea
    s_mul_i32 s38, s24, 158
    s_add_u32 s39, s38, 1
    s_max_u32 s40, s36, s39
    s_add_u32 s41, s38, 158
    s_min_u32 s42, s37, s41
    s_sub_u32 s25, s42, s40
    s_sub_u32 s33, s40, s39
    s_lshl_b32 s29, s33, 14
    s_mov_b32 s70, s24
    s_add_u32 s41, s41, 1
    s_max_u32 s42, s37, s41
    s_sub_u32 s26, s42, s41
    s_waitcnt lgkmcnt(0)
    s_add_u32 s48, s4, 0x598000
    s_addc_u32 s49, s5, 0
    s_mov_b32 s50, 0x350a20
    s_mov_b32 s51, 0x00020000
    buffer_load_dwordx4 v[128:131], v226, s[48:51], 0 offen
    buffer_load_dwordx4 v[132:135], v227, s[48:51], 0 offen
    buffer_load_dwordx4 v[136:139], v228, s[48:51], 0 offen
    s_add_u32 s8, s4, 0xfe0
    s_addc_u32 s9, s5, 0
    s_mov_b32 s10, 0x274020
    s_mov_b32 s11, 0x00020000
    v_lshrrev_b32 v226, 4, v225
    v_and_b32 v227, 15, v225
    v_lshlrev_b32 v253, 4, v226
    v_lshlrev_b32 v252, 4, v227
    v_lshlrev_b32 v228, 2, v226
    v_xor_b32 v228, v227, v228
    v_lshlrev_b32 v228, 4, v228
    v_lshl_add_u32 v228, v226, 8, v228
    s_lshl_b32 s36, s3, 11
    v_add_u32 v221, s36, v228
    v_add_u32 v220, 32, v221
    s_mul_i32 s28, s3, 2112
    s_add_u32 s28, s28, 12544
    s_mov_b32 s27, s28
    s_add_u32 s67, s28, 67584
    s_mov_b32 m0, s28
    s_nop 0
    buffer_load_dwordx4 v220, s[8:11], s29 offen lds
    buffer_load_dwordx4 v221, s[8:11], s29 offen offset:1056 lds
    s_add_u32 s29, s29, 8192
    s_add_u32 m0, s28, 8448
    s_nop 0
    buffer_load_dwordx4 v220, s[8:11], s29 offen lds
    buffer_load_dwordx4 v221, s[8:11], s29 offen offset:1056 lds
    s_add_u32 s29, s29, 8192
    s_add_u32 s28, s28, 16896
    s_cmp_eq_u32 s28, s67
    s_cselect_b32 s28, s27, s28
    s_cmp_eq_u32 s29, 2572288
    s_cselect_b32 s29, 0, s29
    v_mov_b32 v232, 0x7f000000
    v_mov_b32 v233, 0x7f000000
    v_mov_b32 v234, 0x7f000000
    v_mov_b32 v235, 0x7f000000
    v_lshlrev_b32 v236, 4, v223
    ds_write_b128 v236, v[232:235] offset:0
    ds_write_b128 v236, v[232:235] offset:4096
    ds_write_b128 v236, v[232:235] offset:8192
    v_and_b32 v237, 63, v223
    v_lshlrev_b32 v237, 2, v237
    v_mov_b32 v238, 0
    ds_write_b32 v237, v238 offset:12288
    s_add_u32 s12, s4, 0x278000
    s_addc_u32 s13, s5, 0
    s_mov_b32 s14, 0x274000
    s_mov_b32 s15, 0x00020000
    s_lshl_b32 s37, s24, 16
    s_lshl_b32 s38, s3, 14
    s_add_u32 s37, s37, s38
    v_add_u32 v224, s37, v222
    buffer_load_dwordx4 a[0:3], v224, s[12:15], 0 offen offset:0
    buffer_load_dwordx4 a[4:7], v224, s[12:15], 0 offen offset:1024
    buffer_load_dwordx4 a[8:11], v224, s[12:15], 0 offen offset:2048
    buffer_load_dwordx4 a[12:15], v224, s[12:15], 0 offen offset:3072
    v_add_u32 v224, 4096, v224
    buffer_load_dwordx4 a[16:19], v224, s[12:15], 0 offen offset:0
    buffer_load_dwordx4 a[20:23], v224, s[12:15], 0 offen offset:1024
    buffer_load_dwordx4 a[24:27], v224, s[12:15], 0 offen offset:2048
    buffer_load_dwordx4 a[28:31], v224, s[12:15], 0 offen offset:3072
    v_mov_b32 v239, v229
    s_waitcnt lgkmcnt(0)
    s_barrier
    s_add_u32 s16, s4, 0x900000
    s_addc_u32 s17, s5, 0
    s_mov_b32 s18, 0x13ba800
    s_mov_b32 s19, 0x00020000
    s_add_u32 s20, s4, 0x501000
    s_addc_u32 s21, s5, 0
    s_mov_b32 s22, 0x94000
    s_mov_b32 s23, 0x00020000
    s_mov_b32 s34, 0
    s_mov_b32 s35, 0xffff0000
    v_add_u32 v252, 32, v252
    v_mov_b32 v229, 0x3f80
    v_mov_b32 v230, 0x3f800000
    v_cmp_eq_u32 vcc, 0, v227
    v_cmp_eq_u32 s[36:37], 1, v227
    s_nop 0
    v_cndmask_b32 v228, 0, v229, vcc
    v_cndmask_b32 v228, v228, v230, s[36:37]
    v_accvgpr_write_b32 a212, v228
    v_cmp_eq_u32 vcc, 2, v227
    v_cmp_eq_u32 s[36:37], 3, v227
    s_nop 0
    v_cndmask_b32 v228, 0, v229, vcc
    v_cndmask_b32 v228, v228, v230, s[36:37]
    v_accvgpr_write_b32 a213, v228
    v_cmp_eq_u32 vcc, 4, v227
    v_cmp_eq_u32 s[36:37], 5, v227
    s_nop 0
    v_cndmask_b32 v228, 0, v229, vcc
    v_cndmask_b32 v228, v228, v230, s[36:37]
    v_accvgpr_write_b32 a214, v228
    v_cmp_eq_u32 vcc, 6, v227
    v_cmp_eq_u32 s[36:37], 7, v227
    s_nop 0
    v_cndmask_b32 v228, 0, v229, vcc
    v_cndmask_b32 v228, v228, v230, s[36:37]
    v_accvgpr_write_b32 a215, v228
    s_mul_i32 s36, s3, 2560
    v_add_u32 v254, s36, v253
    s_mul_i32 s36, s3, 11264
    s_add_u32 s36, s36, 80128
    v_add_u32 v255, s36, v222
    s_mov_b32 s68, 10
    v_lshlrev_b32 v228, 8, v227
    v_lshrrev_b32 v229, 2, v227
    v_lshl_add_u32 v228, v229, 5, v228
    v_add_u32 v228, v228, v253
    v_and_b32 v226, 3, v225
    v_xor_b32 v230, 0, v226
    v_lshl_add_u32 v204, v230, 6, v228
    v_xor_b32 v230, 1, v226
    v_lshl_add_u32 v205, v230, 6, v228
    v_xor_b32 v230, 2, v226
    v_lshl_add_u32 v206, v230, 6, v228
    v_xor_b32 v230, 3, v226
    v_lshl_add_u32 v207, v230, 6, v228
    v_mul_u32_u24 v228, 66, v253
    v_lshl_add_u32 v228, v229, 8, v228
    v_lshl_add_u32 v228, v226, 3, v228
    v_xor_b32 v230, 0, v229
    v_lshl_add_u32 v208, v230, 6, v228
    v_xor_b32 v230, 1, v229
    v_lshl_add_u32 v209, v230, 6, v228
    v_xor_b32 v230, 2, v229
    v_lshl_add_u32 v210, v230, 6, v228
    v_xor_b32 v230, 3, v229
    v_lshl_add_u32 v211, v230, 6, v228
    s_mov_b32 s30, 12544
    s_mov_b32 s31, 29440
    v_mov_b32 v0, 0
    v_mov_b32 v1, 0
    v_mov_b32 v2, 0
    v_mov_b32 v3, 0
    v_mov_b32 v4, 0
    v_mov_b32 v5, 0
    v_mov_b32 v6, 0
    v_mov_b32 v7, 0
    v_mov_b32 v8, 0
    v_mov_b32 v9, 0
    v_mov_b32 v10, 0
    v_mov_b32 v11, 0
    v_mov_b32 v12, 0
    v_mov_b32 v13, 0
    v_mov_b32 v14, 0
    v_mov_b32 v15, 0
    v_mov_b32 v16, 0
    v_mov_b32 v17, 0
    v_mov_b32 v18, 0
    v_mov_b32 v19, 0
    v_mov_b32 v20, 0
    v_mov_b32 v21, 0
    v_mov_b32 v22, 0
    v_mov_b32 v23, 0
    v_mov_b32 v24, 0
    v_mov_b32 v25, 0
    v_mov_b32 v26, 0
    v_mov_b32 v27, 0
    v_mov_b32 v28, 0
    v_mov_b32 v29, 0
    v_mov_b32 v30, 0
    v_mov_b32 v31, 0
    v_mov_b32 v32, 0
    v_mov_b32 v33, 0
    v_mov_b32 v34, 0
    v_mov_b32 v35, 0
    v_mov_b32 v36, 0
    v_mov_b32 v37, 0
    v_mov_b32 v38, 0
    v_mov_b32 v39, 0
    v_mov_b32 v40, 0
    v_mov_b32 v41, 0
    v_mov_b32 v42, 0
    v_mov_b32 v43, 0
    v_mov_b32 v44, 0
    v_mov_b32 v45, 0
    v_mov_b32 v46, 0
    v_mov_b32 v47, 0
    v_mov_b32 v48, 0
    v_mov_b32 v49, 0
    v_mov_b32 v50, 0
    v_mov_b32 v51, 0
    v_mov_b32 v52, 0
    v_mov_b32 v53, 0
    v_mov_b32 v54, 0
    v_mov_b32 v55, 0
    v_mov_b32 v56, 0
    v_mov_b32 v57, 0
    v_mov_b32 v58, 0
    v_mov_b32 v59, 0
    v_mov_b32 v60, 0
    v_mov_b32 v61, 0
    v_mov_b32 v62, 0
    v_mov_b32 v63, 0
    v_mov_b32 v64, 0
    v_mov_b32 v65, 0
    v_mov_b32 v66, 0
    v_mov_b32 v67, 0
    v_mov_b32 v68, 0
    v_mov_b32 v69, 0
    v_mov_b32 v70, 0
    v_mov_b32 v71, 0
    v_mov_b32 v72, 0
    v_mov_b32 v73, 0
    v_mov_b32 v74, 0
    v_mov_b32 v75, 0
    v_mov_b32 v76, 0
    v_mov_b32 v77, 0
    v_mov_b32 v78, 0
    v_mov_b32 v79, 0
    v_mov_b32 v80, 0
    v_mov_b32 v81, 0
    v_mov_b32 v82, 0
    v_mov_b32 v83, 0
    v_mov_b32 v84, 0
    v_mov_b32 v85, 0
    v_mov_b32 v86, 0
    v_mov_b32 v87, 0
    v_mov_b32 v88, 0
    v_mov_b32 v89, 0
    v_mov_b32 v90, 0
    v_mov_b32 v91, 0
    v_mov_b32 v92, 0
    v_mov_b32 v93, 0
    v_mov_b32 v94, 0
    v_mov_b32 v95, 0
    v_mov_b32 v96, 0
    v_mov_b32 v97, 0
    v_mov_b32 v98, 0
    v_mov_b32 v99, 0
    v_mov_b32 v100, 0
    v_mov_b32 v101, 0
    v_mov_b32 v102, 0
    v_mov_b32 v103, 0
    v_mov_b32 v104, 0
    v_mov_b32 v105, 0
    v_mov_b32 v106, 0
    v_mov_b32 v107, 0
    v_mov_b32 v108, 0
    v_mov_b32 v109, 0
    v_mov_b32 v110, 0
    v_mov_b32 v111, 0
    v_mov_b32 v112, 0
    v_mov_b32 v113, 0
    v_mov_b32 v114, 0
    v_mov_b32 v115, 0
    v_mov_b32 v116, 0
    v_mov_b32 v117, 0
    v_mov_b32 v118, 0
    v_mov_b32 v119, 0
    v_mov_b32 v120, 0
    v_mov_b32 v121, 0
    v_mov_b32 v122, 0
    v_mov_b32 v123, 0
    v_mov_b32 v124, 0
    v_mov_b32 v125, 0
    v_mov_b32 v126, 0
    v_mov_b32 v127, 0
    s_waitcnt vmcnt(12)
    v_mov_b32 v140, 0
    v_mov_b32 v141, 0
    v_mov_b32 v142, 0
    v_mov_b32 v143, 0
    v_mov_b32 v233, 1
    v_bfe_u32 v160, v128, 22, 8
    v_cmpx_ne_u32 vcc, 0, v128
    ds_add_rtn_u32 v144, v160, v233 offset:12288
    s_mov_b64 exec, -1
    v_bfe_u32 v161, v129, 22, 8
    v_cmpx_ne_u32 vcc, 0, v129
    ds_add_rtn_u32 v145, v161, v233 offset:12288
    s_mov_b64 exec, -1
    v_bfe_u32 v162, v130, 22, 8
    v_cmpx_ne_u32 vcc, 0, v130
    ds_add_rtn_u32 v146, v162, v233 offset:12288
    s_mov_b64 exec, -1
    v_bfe_u32 v163, v131, 22, 8
    v_cmpx_ne_u32 vcc, 0, v131
    ds_add_rtn_u32 v147, v163, v233 offset:12288
    s_mov_b64 exec, -1
    v_bfe_u32 v164, v132, 22, 8
    v_cmpx_ne_u32 vcc, 0, v132
    ds_add_rtn_u32 v148, v164, v233 offset:12288
    s_mov_b64 exec, -1
    v_bfe_u32 v165, v133, 22, 8
    v_cmpx_ne_u32 vcc, 0, v133
    ds_add_rtn_u32 v149, v165, v233 offset:12288
    s_mov_b64 exec, -1
    v_bfe_u32 v166, v134, 22, 8
    v_cmpx_ne_u32 vcc, 0, v134
    ds_add_rtn_u32 v150, v166, v233 offset:12288
    s_mov_b64 exec, -1
    v_bfe_u32 v167, v135, 22, 8
    v_cmpx_ne_u32 vcc, 0, v135
    ds_add_rtn_u32 v151, v167, v233 offset:12288
    s_mov_b64 exec, -1
    v_or3_b32 v232, v136, v137, v138
    v_or_b32 v232, v232, v139
    v_cmp_ne_u32 s[36:37], 0, v232
    s_waitcnt lgkmcnt(0)
    v_lshlrev_b32 v160, 6, v160
    v_lshl_add_u32 v160, v144, 2, v160
    v_and_b32 v232, 0x3fffff, v128
    v_cmpx_ne_u32 vcc, 0, v128
    v_cmpx_gt_u32 vcc, 64, v144
    ds_write_b32 v160, v232
    v_mov_b32 v128, 0
    s_mov_b64 exec, -1
    v_lshlrev_b32 v161, 6, v161
    v_lshl_add_u32 v161, v145, 2, v161
    v_and_b32 v232, 0x3fffff, v129
    v_cmpx_ne_u32 vcc, 0, v129
    v_cmpx_gt_u32 vcc, 64, v145
    ds_write_b32 v161, v232
    v_mov_b32 v129, 0
    s_mov_b64 exec, -1
    v_lshlrev_b32 v162, 6, v162
    v_lshl_add_u32 v162, v146, 2, v162
    v_and_b32 v232, 0x3fffff, v130
    v_cmpx_ne_u32 vcc, 0, v130
    v_cmpx_gt_u32 vcc, 64, v146
    ds_write_b32 v162, v232
    v_mov_b32 v130, 0
    s_mov_b64 exec, -1
    v_lshlrev_b32 v163, 6, v163
    v_lshl_add_u32 v163, v147, 2, v163
    v_and_b32 v232, 0x3fffff, v131
    v_cmpx_ne_u32 vcc, 0, v131
    v_cmpx_gt_u32 vcc, 64, v147
    ds_write_b32 v163, v232
    v_mov_b32 v131, 0
    s_mov_b64 exec, -1
    v_lshlrev_b32 v164, 6, v164
    v_lshl_add_u32 v164, v148, 2, v164
    v_and_b32 v232, 0x3fffff, v132
    v_cmpx_ne_u32 vcc, 0, v132
    v_cmpx_gt_u32 vcc, 64, v148
    ds_write_b32 v164, v232
    v_mov_b32 v132, 0
    s_mov_b64 exec, -1
    v_lshlrev_b32 v165, 6, v165
    v_lshl_add_u32 v165, v149, 2, v165
    v_and_b32 v232, 0x3fffff, v133
    v_cmpx_ne_u32 vcc, 0, v133
    v_cmpx_gt_u32 vcc, 64, v149
    ds_write_b32 v165, v232
    v_mov_b32 v133, 0
    s_mov_b64 exec, -1
    v_lshlrev_b32 v166, 6, v166
    v_lshl_add_u32 v166, v150, 2, v166
    v_and_b32 v232, 0x3fffff, v134
    v_cmpx_ne_u32 vcc, 0, v134
    v_cmpx_gt_u32 vcc, 64, v150
    ds_write_b32 v166, v232
    v_mov_b32 v134, 0
    s_mov_b64 exec, -1
    v_lshlrev_b32 v167, 6, v167
    v_lshl_add_u32 v167, v151, 2, v167
    v_and_b32 v232, 0x3fffff, v135
    v_cmpx_ne_u32 vcc, 0, v135
    v_cmpx_gt_u32 vcc, 64, v151
    ds_write_b32 v167, v232
    v_mov_b32 v135, 0
    s_mov_b64 exec, -1
    s_cmp_eq_u64 s[36:37], 0
    s_cbranch_scc1 K2_PSK
    v_bfe_u32 v168, v136, 22, 8
    v_cmpx_ne_u32 vcc, 0, v136
    ds_add_rtn_u32 v152, v168, v233 offset:12288
    s_mov_b64 exec, -1
    v_bfe_u32 v169, v137, 22, 8
    v_cmpx_ne_u32 vcc, 0, v137
    ds_add_rtn_u32 v153, v169, v233 offset:12288
    s_mov_b64 exec, -1
    v_bfe_u32 v170, v138, 22, 8
    v_cmpx_ne_u32 vcc, 0, v138
    ds_add_rtn_u32 v154, v170, v233 offset:12288
    s_mov_b64 exec, -1
    v_bfe_u32 v171, v139, 22, 8
    v_cmpx_ne_u32 vcc, 0, v139
    ds_add_rtn_u32 v155, v171, v233 offset:12288
    s_mov_b64 exec, -1
    s_waitcnt lgkmcnt(0)
    v_lshlrev_b32 v168, 6, v168
    v_lshl_add_u32 v168, v152, 2, v168
    v_and_b32 v232, 0x3fffff, v136
    v_cmpx_ne_u32 vcc, 0, v136
    v_cmpx_gt_u32 vcc, 64, v152
    ds_write_b32 v168, v232
    v_mov_b32 v136, 0
    s_mov_b64 exec, -1
    v_lshlrev_b32 v169, 6, v169
    v_lshl_add_u32 v169, v153, 2, v169
    v_and_b32 v232, 0x3fffff, v137
    v_cmpx_ne_u32 vcc, 0, v137
    v_cmpx_gt_u32 vcc, 64, v153
    ds_write_b32 v169, v232
    v_mov_b32 v137, 0
    s_mov_b64 exec, -1
    v_lshlrev_b32 v170, 6, v170
    v_lshl_add_u32 v170, v154, 2, v170
    v_and_b32 v232, 0x3fffff, v138
    v_cmpx_ne_u32 vcc, 0, v138
    v_cmpx_gt_u32 vcc, 64, v154
    ds_write_b32 v170, v232
    v_mov_b32 v138, 0
    s_mov_b64 exec, -1
    v_lshlrev_b32 v171, 6, v171
    v_lshl_add_u32 v171, v155, 2, v171
    v_and_b32 v232, 0x3fffff, v139
    v_cmpx_ne_u32 vcc, 0, v139
    v_cmpx_gt_u32 vcc, 64, v155
    ds_write_b32 v171, v232
    v_mov_b32 v139, 0
    s_mov_b64 exec, -1
K2_PSK:
    v_or3_b32 v232, v128, v129, v130
    v_or3_b32 v232, v232, v131, v132
    v_or3_b32 v232, v232, v133, v134
    v_or3_b32 v232, v232, v135, v136
    v_or3_b32 v232, v232, v137, v138
    v_or3_b32 v232, v232, v139, v140
    v_or3_b32 v232, v232, v141, v142
    v_or_b32 v232, v232, v143
    v_mov_b32 v234, 12480
    v_cmpx_ne_u32 vcc, 0, v232
    ds_write_b32 v234, v233
    s_mov_b64 exec, -1
    v_add_u32 v224, 4096, v224
    buffer_load_dwordx4 a[32:35], v224, s[12:15], 0 offen offset:0
    buffer_load_dwordx4 a[36:39], v224, s[12:15], 0 offen offset:1024
    buffer_load_dwordx4 a[40:43], v224, s[12:15], 0 offen offset:2048
    buffer_load_dwordx4 a[44:47], v224, s[12:15], 0 offen offset:3072
    v_add_u32 v224, 4096, v224
    buffer_load_dwordx4 a[48:51], v224, s[12:15], 0 offen offset:0
    buffer_load_dwordx4 a[52:55], v224, s[12:15], 0 offen offset:1024
    buffer_load_dwordx4 a[56:59], v224, s[12:15], 0 offen offset:2048
    buffer_load_dwordx4 a[60:63], v224, s[12:15], 0 offen offset:3072
    buffer_load_dwordx4 a[204:207], v239, s[48:51], 0 offen
    s_mov_b32 m0, s28
    s_nop 0
    buffer_load_dwordx4 v220, s[8:11], s29 offen lds
    buffer_load_dwordx4 v221, s[8:11], s29 offen offset:1056 lds
    s_add_u32 s29, s29, 8192
    s_add_u32 m0, s28, 8448
    s_nop 0
    buffer_load_dwordx4 v220, s[8:11], s29 offen lds
    buffer_load_dwordx4 v221, s[8:11], s29 offen offset:1056 lds
    s_add_u32 s29, s29, 8192
    s_add_u32 s28, s28, 16896
    s_cmp_eq_u32 s28, s67
    s_cselect_b32 s28, s27, s28
    s_cmp_eq_u32 s29, 2572288
    s_cselect_b32 s29, 0, s29
    s_add_u32 s52, s4, 0x500000
    s_addc_u32 s53, s5, 0
    s_mov_b32 s54, 0x13c
    s_mov_b32 s55, 0x00020000
    s_mov_b32 s56, s6
    s_mov_b32 s57, s7
    s_mov_b32 s58, 0x4e20
    s_mov_b32 s59, 0x00020000
    buffer_load_dword a208, v231, s[52:55], 0 offen
    buffer_load_dword a209, v231, s[52:55], 0 offen offset:256
    s_mul_i32 s36, s2, 80
    s_mul_i32 s37, s3, 20
    s_add_u32 s36, s36, s37
    v_lshl_add_u32 v231, v225, 1, s36
    buffer_load_ushort a210, v231, s[56:59], 0 offen
    s_mov_b32 m0, s28
    s_nop 0
    buffer_load_dwordx4 v220, s[8:11], s29 offen lds
    buffer_load_dwordx4 v221, s[8:11], s29 offen offset:1056 lds
    s_add_u32 s29, s29, 8192
    s_add_u32 m0, s28, 8448
    s_nop 0
    buffer_load_dwordx4 v220, s[8:11], s29 offen lds
    buffer_load_dwordx4 v221, s[8:11], s29 offen offset:1056 lds
    s_add_u32 s29, s29, 8192
    s_add_u32 s28, s28, 16896
    s_cmp_eq_u32 s28, s67
    s_cselect_b32 s28, s27, s28
    s_cmp_eq_u32 s29, 2572288
    s_cselect_b32 s29, 0, s29
    v_accvgpr_write_b32 a192, v128
    v_accvgpr_write_b32 a193, v129
    v_accvgpr_write_b32 a194, v130
    v_accvgpr_write_b32 a195, v131
    v_accvgpr_write_b32 a196, v132
    v_accvgpr_write_b32 a197, v133
    v_accvgpr_write_b32 a198, v134
    v_accvgpr_write_b32 a199, v135
    v_accvgpr_write_b32 a200, v136
    v_accvgpr_write_b32 a201, v137
    v_accvgpr_write_b32 a202, v138
    v_accvgpr_write_b32 a203, v139
    s_waitcnt vmcnt(28) lgkmcnt(0)
    s_barrier
    ds_read_b128 v[244:247], v254
K2_SEG:
    v_add_u32 v212, s30, v204
    v_add_u32 v216, s30, v208
    v_add_u32 v213, s30, v205
    v_add_u32 v217, s30, v209
    v_add_u32 v214, s30, v206
    v_add_u32 v218, s30, v210
    v_add_u32 v215, s30, v207
    v_add_u32 v219, s30, v211
    ds_read_b128 a[64:67], v212 offset:0
    ds_read_b128 a[68:71], v213 offset:0
    ds_read_b128 a[72:75], v214 offset:0
    ds_read_b128 a[76:79], v215 offset:0
    ds_read_b128 a[80:83], v212 offset:4224
    ds_read_b128 a[84:87], v213 offset:4224
    ds_read_b128 a[88:91], v214 offset:4224
    ds_read_b128 a[92:95], v215 offset:4224
    s_waitcnt vmcnt(20)
    s_waitcnt lgkmcnt(7)
    v_mfma_f32_16x16x32_bf16 v[128:131], a[64:67], a[0:3], 0
    v_mfma_f32_16x16x32_bf16 v[136:139], a[64:67], a[16:19], 0
    s_waitcnt lgkmcnt(6)
    v_mfma_f32_16x16x32_bf16 v[128:131], a[68:71], a[4:7], v[128:131]
    v_mfma_f32_16x16x32_bf16 v[136:139], a[68:71], a[20:23], v[136:139]
    s_waitcnt lgkmcnt(5)
    v_mfma_f32_16x16x32_bf16 v[128:131], a[72:75], a[8:11], v[128:131]
    v_mfma_f32_16x16x32_bf16 v[136:139], a[72:75], a[24:27], v[136:139]
    s_waitcnt lgkmcnt(4)
    v_mfma_f32_16x16x32_bf16 v[128:131], a[76:79], a[12:15], v[128:131]
    v_mfma_f32_16x16x32_bf16 v[136:139], a[76:79], a[28:31], v[136:139]
    s_waitcnt lgkmcnt(3)
    v_mfma_f32_16x16x32_bf16 v[132:135], a[80:83], a[0:3], 0
    v_mfma_f32_16x16x32_bf16 v[140:143], a[80:83], a[16:19], 0
    s_waitcnt lgkmcnt(2)
    v_mfma_f32_16x16x32_bf16 v[132:135], a[84:87], a[4:7], v[132:135]
    v_mfma_f32_16x16x32_bf16 v[140:143], a[84:87], a[20:23], v[140:143]
    s_waitcnt lgkmcnt(1)
    v_mfma_f32_16x16x32_bf16 v[132:135], a[88:91], a[8:11], v[132:135]
    v_mfma_f32_16x16x32_bf16 v[140:143], a[88:91], a[24:27], v[140:143]
    s_waitcnt lgkmcnt(0)
    v_mfma_f32_16x16x32_bf16 v[132:135], a[92:95], a[12:15], v[132:135]
    v_mfma_f32_16x16x32_bf16 v[140:143], a[92:95], a[28:31], v[140:143]
    s_waitcnt vmcnt(12)
    v_mfma_f32_16x16x32_bf16 v[144:147], a[64:67], a[32:35], 0
    v_mfma_f32_16x16x32_bf16 v[152:155], a[64:67], a[48:51], 0
    ds_read_b128 a[64:67], v212 offset:8448
    v_mfma_f32_16x16x32_bf16 v[144:147], a[68:71], a[36:39], v[144:147]
    v_mfma_f32_16x16x32_bf16 v[152:155], a[68:71], a[52:55], v[152:155]
    ds_read_b128 a[68:71], v213 offset:8448
    v_mfma_f32_16x16x32_bf16 v[144:147], a[72:75], a[40:43], v[144:147]
    v_mfma_f32_16x16x32_bf16 v[152:155], a[72:75], a[56:59], v[152:155]
    ds_read_b128 a[72:75], v214 offset:8448
    v_mfma_f32_16x16x32_bf16 v[144:147], a[76:79], a[44:47], v[144:147]
    v_mfma_f32_16x16x32_bf16 v[152:155], a[76:79], a[60:63], v[152:155]
    ds_read_b128 a[76:79], v215 offset:8448
    v_mfma_f32_16x16x32_bf16 v[148:151], a[80:83], a[32:35], 0
    v_mfma_f32_16x16x32_bf16 v[156:159], a[80:83], a[48:51], 0
    ds_read_b128 a[80:83], v212 offset:12672
    v_mfma_f32_16x16x32_bf16 v[148:151], a[84:87], a[36:39], v[148:151]
    v_mfma_f32_16x16x32_bf16 v[156:159], a[84:87], a[52:55], v[156:159]
    ds_read_b128 a[84:87], v213 offset:12672
    v_mfma_f32_16x16x32_bf16 v[148:151], a[88:91], a[40:43], v[148:151]
    v_mfma_f32_16x16x32_bf16 v[156:159], a[88:91], a[56:59], v[156:159]
    ds_read_b128 a[88:91], v214 offset:12672
    v_mfma_f32_16x16x32_bf16 v[148:151], a[92:95], a[44:47], v[148:151]
    v_mfma_f32_16x16x32_bf16 v[156:159], a[92:95], a[60:63], v[156:159]
    ds_read_b128 a[92:95], v215 offset:12672
    s_nop 7
    v_max3_f32 v240, v128, v129, v130
    v_max3_f32 v240, v240, v131, v132
    v_max3_f32 v240, v240, v133, v134
    v_max3_f32 v240, v240, v135, v135
    v_max3_f32 v241, v136, v137, v138
    v_max3_f32 v241, v241, v139, v140
    v_max3_f32 v241, v241, v141, v142
    v_max3_f32 v241, v241, v143, v143
    v_max3_f32 v242, v144, v145, v146
    v_max3_f32 v242, v242, v147, v148
    v_max3_f32 v242, v242, v149, v150
    v_max3_f32 v242, v242, v151, v151
    v_max3_f32 v243, v152, v153, v154
    v_max3_f32 v243, v243, v155, v156
    v_max3_f32 v243, v243, v157, v158
    v_max3_f32 v243, v243, v159, v159
    v_mov_b32 v228, v240
    v_mov_b32 v229, v241
    v_mov_b32 v230, v242
    v_mov_b32 v231, v243
    s_nop 1
    v_permlane32_swap_b32 v240, v228
    v_permlane32_swap_b32 v241, v229
    v_permlane32_swap_b32 v242, v230
    v_permlane32_swap_b32 v243, v231
    s_nop 1
    v_max_f32 v240, v240, v228
    v_max_f32 v241, v241, v229
    v_max_f32 v242, v242, v230
    v_max_f32 v243, v243, v231
    v_mov_b32 v228, v240
    v_mov_b32 v229, v241
    v_mov_b32 v230, v242
    v_mov_b32 v231, v243
    s_nop 1
    v_permlane16_swap_b32 v240, v228
    v_permlane16_swap_b32 v241, v229
    v_permlane16_swap_b32 v242, v230
    v_permlane16_swap_b32 v243, v231
    s_nop 1
    v_max_f32 v240, v240, v228
    v_max_f32 v241, v241, v229
    v_max_f32 v242, v242, v230
    v_max_f32 v243, v243, v231
    v_cvt_pk_bf16_f32 v240, -v240, -v240
    v_and_b32 v240, 0xffff0000, v240
    v_accvgpr_read_b32 v235, a15
    v_and_b32 v236, 0xffff, v235
    v_or_b32 v236, v236, v240
    v_cndmask_b32 v235, v235, v236, s[34:35]
    v_accvgpr_write_b32 a15, v235
    v_add_f32 v128, v128, v240
    v_add_f32 v129, v129, v240
    v_add_f32 v130, v130, v240
    v_add_f32 v131, v131, v240
    v_add_f32 v132, v132, v240
    v_add_f32 v133, v133, v240
    v_add_f32 v134, v134, v240
    v_add_f32 v135, v135, v240
    v_cvt_pk_bf16_f32 v241, -v241, -v241
    v_and_b32 v241, 0xffff0000, v241
    v_accvgpr_read_b32 v235, a31
    v_and_b32 v236, 0xffff, v235
    v_or_b32 v236, v236, v241
    v_cndmask_b32 v235, v235, v236, s[34:35]
    v_accvgpr_write_b32 a31, v235
    v_add_f32 v136, v136, v241
    v_add_f32 v137, v137, v241
    v_add_f32 v138, v138, v241
    v_add_f32 v139, v139, v241
    v_add_f32 v140, v140, v241
    v_add_f32 v141, v141, v241
    v_add_f32 v142, v142, v241
    v_add_f32 v143, v143, v241
    v_cvt_pk_bf16_f32 v242, -v242, -v242
    v_and_b32 v242, 0xffff0000, v242
    v_accvgpr_read_b32 v235, a47
    v_and_b32 v236, 0xffff, v235
    v_or_b32 v236, v236, v242
    v_cndmask_b32 v235, v235, v236, s[34:35]
    v_accvgpr_write_b32 a47, v235
    v_add_f32 v144, v144, v242
    v_add_f32 v145, v145, v242
    v_add_f32 v146, v146, v242
    v_add_f32 v147, v147, v242
    v_add_f32 v148, v148, v242
    v_add_f32 v149, v149, v242
    v_add_f32 v150, v150, v242
    v_add_f32 v151, v151, v242
    v_cvt_pk_bf16_f32 v243, -v243, -v243
    v_and_b32 v243, 0xffff0000, v243
    v_accvgpr_read_b32 v235, a63
    v_and_b32 v236, 0xffff, v235
    v_or_b32 v236, v236, v243
    v_cndmask_b32 v235, v235, v236, s[34:35]
    v_accvgpr_write_b32 a63, v235
    v_add_f32 v152, v152, v243
    v_add_f32 v153, v153, v243
    v_add_f32 v154, v154, v243
    v_add_f32 v155, v155, v243
    v_add_f32 v156, v156, v243
    v_add_f32 v157, v157, v243
    v_add_f32 v158, v158, v243
    v_add_f32 v159, v159, v243
    v_exp_f32_e64 v200, v128
    v_exp_f32_e64 v201, v129
    v_exp_f32_e64 v202, v130
    v_cvt_pk_bf16_f32 v176, v200, v201
    v_exp_f32_e64 v203, v131
    v_exp_f32_e64 v200, v132
    v_cvt_pk_bf16_f32 v177, v202, v203
    v_exp_f32_e64 v201, v133
    v_exp_f32_e64 v202, v134
    v_cvt_pk_bf16_f32 v178, v200, v201
    v_exp_f32_e64 v203, v135
    v_exp_f32_e64 v200, v136
    v_cvt_pk_bf16_f32 v179, v202, v203
    v_exp_f32_e64 v201, v137
    v_exp_f32_e64 v202, v138
    v_cvt_pk_bf16_f32 v180, v200, v201
    v_exp_f32_e64 v203, v139
    v_exp_f32_e64 v200, v140
    v_cvt_pk_bf16_f32 v181, v202, v203
    v_exp_f32_e64 v201, v141
    v_exp_f32_e64 v202, v142
    v_cvt_pk_bf16_f32 v182, v200, v201
    v_exp_f32_e64 v203, v143
    s_nop 0
    v_cvt_pk_bf16_f32 v183, v202, v203
    s_mov_b32 s71, 1
    s_sub_u32 s32, s25, 1
    s_lshr_b32 s69, s32, 1
    s_min_u32 s69, s69, s68
    s_sub_u32 s68, s68, s69
    s_sub_u32 s32, s32, s69
    s_sub_u32 s32, s32, s69
    s_sub_u32 s32, 0, s32
    s_sub_u32 s69, 0, s69
    s_cmp_eq_u32 s69, 0
    s_waitcnt lgkmcnt(0)
    s_cbranch_scc1 K2_NLOOP_IN
.p2align 6
K2_GLOOP:
    v_mfma_f32_16x16x32_bf16 v[128:131], a[64:67], a[0:3], 0
    v_exp_f32_e64 v200, v144
    v_mfma_f32_16x16x32_bf16 v[128:131], a[68:71], a[4:7], v[128:131]
    ds_read_b64_tr_b16 a[96:97], v216 offset:0
    ds_read_b64_tr_b16 a[98:99], v216 offset:4224
    v_mfma_f32_16x16x32_bf16 v[128:131], a[72:75], a[8:11], v[128:131]
    v_exp_f32_e64 v201, v145
    v_mfma_f32_16x16x32_bf16 v[128:131], a[76:79], a[12:15], v[128:131]
    v_cvt_pk_bf16_f32 v192, v200, v201
    s_cmp_eq_u32 s29, 2572288
    v_mfma_f32_16x16x32_bf16 v[132:135], a[80:83], a[0:3], 0
    v_exp_f32_e64 v202, v146
    v_mfma_f32_16x16x32_bf16 v[132:135], a[84:87], a[4:7], v[132:135]
    ds_read_b64_tr_b16 a[100:101], v216 offset:32
    ds_read_b64_tr_b16 a[102:103], v216 offset:4256
    v_mfma_f32_16x16x32_bf16 v[132:135], a[88:91], a[8:11], v[132:135]
    v_exp_f32_e64 v203, v147
    v_mfma_f32_16x16x32_bf16 v[132:135], a[92:95], a[12:15], v[132:135]
    v_cvt_pk_bf16_f32 v193, v202, v203
    s_cselect_b32 s29, 0, s29
    v_mfma_f32_16x16x32_bf16 v[136:139], a[64:67], a[16:19], 0
    v_exp_f32_e64 v200, v148
    v_mfma_f32_16x16x32_bf16 v[136:139], a[68:71], a[20:23], v[136:139]
    ds_read_b64_tr_b16 a[104:105], v217 offset:0
    ds_read_b64_tr_b16 a[106:107], v217 offset:4224
    v_mfma_f32_16x16x32_bf16 v[136:139], a[72:75], a[24:27], v[136:139]
    v_exp_f32_e64 v201, v149
    v_mfma_f32_16x16x32_bf16 v[136:139], a[76:79], a[28:31], v[136:139]
    v_cvt_pk_bf16_f32 v194, v200, v201
    v_add_u32 v212, s31, v204
    v_mfma_f32_16x16x32_bf16 v[140:143], a[80:83], a[16:19], 0
    v_exp_f32_e64 v202, v150
    v_mfma_f32_16x16x32_bf16 v[140:143], a[84:87], a[20:23], v[140:143]
    ds_read_b64_tr_b16 a[108:109], v217 offset:32
    ds_read_b64_tr_b16 a[110:111], v217 offset:4256
    v_mfma_f32_16x16x32_bf16 v[140:143], a[88:91], a[24:27], v[140:143]
    v_exp_f32_e64 v203, v151
    v_mfma_f32_16x16x32_bf16 v[140:143], a[92:95], a[28:31], v[140:143]
    v_cvt_pk_bf16_f32 v195, v202, v203
    v_add_u32 v213, s31, v205
    v_mfma_f32_16x16x32_bf16 v[160:163], a[64:67], a[32:35], 0
    v_exp_f32_e64 v200, v152
    v_mfma_f32_16x16x32_bf16 v[160:163], a[68:71], a[36:39], v[160:163]
    ds_read_b64_tr_b16 a[112:113], v218 offset:0
    ds_read_b64_tr_b16 a[114:115], v218 offset:4224
    v_mfma_f32_16x16x32_bf16 v[160:163], a[72:75], a[40:43], v[160:163]
    v_exp_f32_e64 v201, v153
    v_mfma_f32_16x16x32_bf16 v[160:163], a[76:79], a[44:47], v[160:163]
    v_cvt_pk_bf16_f32 v196, v200, v201
    v_add_u32 v214, s31, v206
    v_mfma_f32_16x16x32_bf16 v[164:167], a[80:83], a[32:35], 0
    v_exp_f32_e64 v202, v154
    v_mfma_f32_16x16x32_bf16 v[164:167], a[84:87], a[36:39], v[164:167]
    ds_read_b64_tr_b16 a[116:117], v218 offset:32
    ds_read_b64_tr_b16 a[118:119], v218 offset:4256
    v_mfma_f32_16x16x32_bf16 v[164:167], a[88:91], a[40:43], v[164:167]
    v_exp_f32_e64 v203, v155
    v_mfma_f32_16x16x32_bf16 v[164:167], a[92:95], a[44:47], v[164:167]
    v_cvt_pk_bf16_f32 v197, v202, v203
    v_add_u32 v215, s31, v207
    v_mfma_f32_16x16x32_bf16 v[168:171], a[64:67], a[48:51], 0
    v_exp_f32_e64 v200, v156
    v_mfma_f32_16x16x32_bf16 v[168:171], a[68:71], a[52:55], v[168:171]
    ds_read_b64_tr_b16 a[120:121], v219 offset:0
    ds_read_b64_tr_b16 a[122:123], v219 offset:4224
    v_mfma_f32_16x16x32_bf16 v[168:171], a[72:75], a[56:59], v[168:171]
    v_exp_f32_e64 v201, v157
    v_mfma_f32_16x16x32_bf16 v[168:171], a[76:79], a[60:63], v[168:171]
    v_cvt_pk_bf16_f32 v198, v200, v201
    s_waitcnt vmcnt(4)
    v_mfma_f32_16x16x32_bf16 v[172:175], a[80:83], a[48:51], 0
    v_exp_f32_e64 v202, v158
    v_mfma_f32_16x16x32_bf16 v[172:175], a[84:87], a[52:55], v[172:175]
    ds_read_b64_tr_b16 a[124:125], v219 offset:32
    ds_read_b64_tr_b16 a[126:127], v219 offset:4256
    v_mfma_f32_16x16x32_bf16 v[172:175], a[88:91], a[56:59], v[172:175]
    v_exp_f32_e64 v203, v159
    v_mfma_f32_16x16x32_bf16 v[172:175], a[92:95], a[60:63], v[172:175]
    v_cvt_pk_bf16_f32 v199, v202, v203
    s_waitcnt lgkmcnt(4)
    v_mfma_f32_16x16x32_bf16 v[0:3], a[96:99], v[176:179], v[0:3]
    v_exp_f32_e64 v200, v128
    v_mfma_f32_16x16x32_bf16 v[32:35], a[96:99], v[180:183], v[32:35]
    s_barrier
    s_mov_b32 m0, s28
    v_mfma_f32_16x16x32_bf16 v[4:7], a[100:103], v[176:179], v[4:7]
    v_mfma_f32_16x16x32_bf16 v[248:251], a[212:215], a[216:219], v[248:251]
    v_exp_f32_e64 v201, v129
    v_mfma_f32_16x16x32_bf16 v[36:39], a[100:103], v[180:183], v[36:39]
    v_cvt_pk_bf16_f32 v184, v200, v201
    v_add_u32 v244, v244, v252
    v_mfma_f32_16x16x32_bf16 v[8:11], a[104:107], v[176:179], v[8:11]
    v_mfma_f32_16x16x32_bf16 v[248:251], a[212:215], a[220:223], v[248:251]
    v_exp_f32_e64 v202, v130
    v_mfma_f32_16x16x32_bf16 v[40:43], a[104:107], v[180:183], v[40:43]
    ds_read_b128 a[64:67], v212 offset:0
    ds_read_b128 a[68:71], v213 offset:0
    v_mfma_f32_16x16x32_bf16 v[12:15], a[108:111], v[176:179], v[12:15]
    v_mfma_f32_16x16x32_bf16 v[248:251], a[212:215], a[224:227], v[248:251]
    v_exp_f32_e64 v203, v131
    v_mfma_f32_16x16x32_bf16 v[44:47], a[108:111], v[180:183], v[44:47]
    v_cvt_pk_bf16_f32 v185, v202, v203
    v_add_u32 v245, v245, v252
    v_mfma_f32_16x16x32_bf16 v[16:19], a[112:115], v[176:179], v[16:19]
    v_mfma_f32_16x16x32_bf16 v[248:251], a[212:215], a[228:231], v[248:251]
    v_exp_f32_e64 v200, v132
    v_mfma_f32_16x16x32_bf16 v[48:51], a[112:115], v[180:183], v[48:51]
    ds_read_b128 a[72:75], v214 offset:0
    ds_read_b128 a[76:79], v215 offset:0
    v_mfma_f32_16x16x32_bf16 v[20:23], a[116:119], v[176:179], v[20:23]
    v_add_u32 v246, v246, v252
    v_exp_f32_e64 v201, v133
    v_mfma_f32_16x16x32_bf16 v[52:55], a[116:119], v[180:183], v[52:55]
    v_cvt_pk_bf16_f32 v186, v200, v201
    s_waitcnt lgkmcnt(4)
    v_mfma_f32_16x16x32_bf16 v[24:27], a[120:123], v[176:179], v[24:27]
    v_add_u32 v247, v247, v252
    v_exp_f32_e64 v202, v134
    v_mfma_f32_16x16x32_bf16 v[56:59], a[120:123], v[180:183], v[56:59]
    ds_read_b128 a[80:83], v212 offset:4224
    ds_read_b128 a[84:87], v213 offset:4224
    v_mfma_f32_16x16x32_bf16 v[28:31], a[124:127], v[176:179], v[28:31]
    v_exp_f32_e64 v203, v135
    v_mfma_f32_16x16x32_bf16 v[60:63], a[124:127], v[180:183], v[60:63]
    buffer_load_dwordx4 a[216:219], v244, s[8:11], 0 offen
    v_cvt_pk_bf16_f32 v187, v202, v203
    v_mfma_f32_16x16x32_bf16 v[64:67], a[96:99], v[192:195], v[64:67]
    v_exp_f32_e64 v200, v136
    v_mfma_f32_16x16x32_bf16 v[96:99], a[96:99], v[196:199], v[96:99]
    ds_read_b128 a[88:91], v214 offset:4224
    ds_read_b128 a[92:95], v215 offset:4224
    v_mfma_f32_16x16x32_bf16 v[68:71], a[100:103], v[192:195], v[68:71]
    v_exp_f32_e64 v201, v137
    v_mfma_f32_16x16x32_bf16 v[100:103], a[100:103], v[196:199], v[100:103]
    buffer_load_dwordx4 a[220:223], v245, s[8:11], 0 offen
    v_cvt_pk_bf16_f32 v188, v200, v201
    v_mfma_f32_16x16x32_bf16 v[72:75], a[104:107], v[192:195], v[72:75]
    v_exp_f32_e64 v202, v138
    v_mfma_f32_16x16x32_bf16 v[104:107], a[104:107], v[196:199], v[104:107]
    buffer_load_dwordx4 a[224:227], v246, s[8:11], 0 offen
    buffer_load_dwordx4 a[228:231], v247, s[8:11], 0 offen
    v_mfma_f32_16x16x32_bf16 v[76:79], a[108:111], v[192:195], v[76:79]
    v_exp_f32_e64 v203, v139
    v_mfma_f32_16x16x32_bf16 v[108:111], a[108:111], v[196:199], v[108:111]
    ds_read_b128 v[244:247], v254 offset:64
    v_cvt_pk_bf16_f32 v189, v202, v203
    v_mfma_f32_16x16x32_bf16 v[80:83], a[112:115], v[192:195], v[80:83]
    v_exp_f32_e64 v200, v140
    v_mfma_f32_16x16x32_bf16 v[112:115], a[112:115], v[196:199], v[112:115]
    buffer_load_dwordx4 v220, s[8:11], s29 offen lds
    buffer_load_dwordx4 v221, s[8:11], s29 offen offset:1056 lds
    v_mfma_f32_16x16x32_bf16 v[84:87], a[116:119], v[192:195], v[84:87]
    v_exp_f32_e64 v201, v141
    v_mfma_f32_16x16x32_bf16 v[116:119], a[116:119], v[196:199], v[116:119]
    v_cvt_pk_bf16_f32 v190, v200, v201
    s_add_u32 s29, s29, 8192
    v_mfma_f32_16x16x32_bf16 v[88:91], a[120:123], v[192:195], v[88:91]
    v_exp_f32_e64 v202, v142
    v_mfma_f32_16x16x32_bf16 v[120:123], a[120:123], v[196:199], v[120:123]
    ds_write_b128 v255, v[248:251]
    s_add_u32 s66, s28, 8448
    v_mfma_f32_16x16x32_bf16 v[92:95], a[124:127], v[192:195], v[92:95]
    v_exp_f32_e64 v203, v143
    v_mfma_f32_16x16x32_bf16 v[124:127], a[124:127], v[196:199], v[124:127]
    v_cvt_pk_bf16_f32 v191, v202, v203
    s_waitcnt lgkmcnt(1)
    v_mfma_f32_16x16x32_bf16 v[128:131], a[64:67], a[0:3], 0
    v_exp_f32_e64 v200, v160
    v_mfma_f32_16x16x32_bf16 v[128:131], a[68:71], a[4:7], v[128:131]
    ds_read_b64_tr_b16 a[96:97], v216 offset:8448
    ds_read_b64_tr_b16 a[98:99], v216 offset:12672
    v_mfma_f32_16x16x32_bf16 v[128:131], a[72:75], a[8:11], v[128:131]
    v_exp_f32_e64 v201, v161
    v_mfma_f32_16x16x32_bf16 v[128:131], a[76:79], a[12:15], v[128:131]
    v_cvt_pk_bf16_f32 v192, v200, v201
    s_add_u32 s28, s28, 16896
    v_mfma_f32_16x16x32_bf16 v[132:135], a[80:83], a[0:3], 0
    v_exp_f32_e64 v202, v162
    v_mfma_f32_16x16x32_bf16 v[132:135], a[84:87], a[4:7], v[132:135]
    ds_read_b64_tr_b16 a[100:101], v216 offset:8480
    ds_read_b64_tr_b16 a[102:103], v216 offset:12704
    v_mfma_f32_16x16x32_bf16 v[132:135], a[88:91], a[8:11], v[132:135]
    v_exp_f32_e64 v203, v163
    v_mfma_f32_16x16x32_bf16 v[132:135], a[92:95], a[12:15], v[132:135]
    v_cvt_pk_bf16_f32 v193, v202, v203
    s_cmp_eq_u32 s28, s67
    v_mfma_f32_16x16x32_bf16 v[136:139], a[64:67], a[16:19], 0
    v_exp_f32_e64 v200, v164
    v_mfma_f32_16x16x32_bf16 v[136:139], a[68:71], a[20:23], v[136:139]
    ds_read_b64_tr_b16 a[104:105], v217 offset:8448
    ds_read_b64_tr_b16 a[106:107], v217 offset:12672
    v_mfma_f32_16x16x32_bf16 v[136:139], a[72:75], a[24:27], v[136:139]
    v_exp_f32_e64 v201, v165
    v_mfma_f32_16x16x32_bf16 v[136:139], a[76:79], a[28:31], v[136:139]
    v_cvt_pk_bf16_f32 v194, v200, v201
    s_cselect_b32 s28, s27, s28
    v_mfma_f32_16x16x32_bf16 v[140:143], a[80:83], a[16:19], 0
    v_exp_f32_e64 v202, v166
    v_mfma_f32_16x16x32_bf16 v[140:143], a[84:87], a[20:23], v[140:143]
    ds_read_b64_tr_b16 a[108:109], v217 offset:8480
    ds_read_b64_tr_b16 a[110:111], v217 offset:12704
    v_mfma_f32_16x16x32_bf16 v[140:143], a[88:91], a[24:27], v[140:143]
    v_exp_f32_e64 v203, v167
    v_mfma_f32_16x16x32_bf16 v[140:143], a[92:95], a[28:31], v[140:143]
    v_cvt_pk_bf16_f32 v195, v202, v203
    v_add_u32 v244, v244, v252
    v_mfma_f32_16x16x32_bf16 v[144:147], a[64:67], a[32:35], 0
    v_exp_f32_e64 v200, v168
    v_mfma_f32_16x16x32_bf16 v[144:147], a[68:71], a[36:39], v[144:147]
    ds_read_b64_tr_b16 a[112:113], v218 offset:8448
    ds_read_b64_tr_b16 a[114:115], v218 offset:12672
    v_mfma_f32_16x16x32_bf16 v[144:147], a[72:75], a[40:43], v[144:147]
    v_exp_f32_e64 v201, v169
    v_mfma_f32_16x16x32_bf16 v[144:147], a[76:79], a[44:47], v[144:147]
    v_cvt_pk_bf16_f32 v196, v200, v201
    v_add_u32 v245, v245, v252
    v_mfma_f32_16x16x32_bf16 v[148:151], a[80:83], a[32:35], 0
    v_exp_f32_e64 v202, v170
    v_mfma_f32_16x16x32_bf16 v[148:151], a[84:87], a[36:39], v[148:151]
    ds_read_b64_tr_b16 a[116:117], v218 offset:8480
    ds_read_b64_tr_b16 a[118:119], v218 offset:12704
    v_mfma_f32_16x16x32_bf16 v[148:151], a[88:91], a[40:43], v[148:151]
    v_exp_f32_e64 v203, v171
    v_mfma_f32_16x16x32_bf16 v[148:151], a[92:95], a[44:47], v[148:151]
    v_cvt_pk_bf16_f32 v197, v202, v203
    v_add_u32 v246, v246, v252
    v_mfma_f32_16x16x32_bf16 v[152:155], a[64:67], a[48:51], 0
    v_exp_f32_e64 v200, v172
    v_mfma_f32_16x16x32_bf16 v[152:155], a[68:71], a[52:55], v[152:155]
    ds_read_b64_tr_b16 a[120:121], v219 offset:8448
    ds_read_b64_tr_b16 a[122:123], v219 offset:12672
    v_mfma_f32_16x16x32_bf16 v[152:155], a[72:75], a[56:59], v[152:155]
    v_exp_f32_e64 v201, v173
    v_mfma_f32_16x16x32_bf16 v[152:155], a[76:79], a[60:63], v[152:155]
    v_cvt_pk_bf16_f32 v198, v200, v201
    v_add_u32 v247, v247, v252
    v_mfma_f32_16x16x32_bf16 v[156:159], a[80:83], a[48:51], 0
    v_exp_f32_e64 v202, v174
    v_mfma_f32_16x16x32_bf16 v[156:159], a[84:87], a[52:55], v[156:159]
    ds_read_b64_tr_b16 a[124:125], v219 offset:8480
    ds_read_b64_tr_b16 a[126:127], v219 offset:12704
    v_mfma_f32_16x16x32_bf16 v[156:159], a[88:91], a[56:59], v[156:159]
    v_exp_f32_e64 v203, v175
    v_mfma_f32_16x16x32_bf16 v[156:159], a[92:95], a[60:63], v[156:159]
    v_cvt_pk_bf16_f32 v199, v202, v203
    s_waitcnt lgkmcnt(4)
    v_mfma_f32_16x16x32_bf16 v[0:3], a[96:99], v[184:187], v[0:3]
    v_exp_f32_e64 v200, v128
    v_mfma_f32_16x16x32_bf16 v[32:35], a[96:99], v[188:191], v[32:35]
    s_mov_b32 m0, s66
    v_add_u32 v216, s31, v208
    v_mfma_f32_16x16x32_bf16 v[4:7], a[100:103], v[184:187], v[4:7]
    v_exp_f32_e64 v201, v129
    v_mfma_f32_16x16x32_bf16 v[36:39], a[100:103], v[188:191], v[36:39]
    v_cvt_pk_bf16_f32 v176, v200, v201
    v_add_u32 v217, s31, v209
    v_mfma_f32_16x16x32_bf16 v[8:11], a[104:107], v[184:187], v[8:11]
    v_exp_f32_e64 v202, v130
    v_mfma_f32_16x16x32_bf16 v[40:43], a[104:107], v[188:191], v[40:43]
    ds_read_b128 a[64:67], v212 offset:8448
    ds_read_b128 a[68:71], v213 offset:8448
    v_mfma_f32_16x16x32_bf16 v[12:15], a[108:111], v[184:187], v[12:15]
    v_exp_f32_e64 v203, v131
    v_mfma_f32_16x16x32_bf16 v[44:47], a[108:111], v[188:191], v[44:47]
    v_cvt_pk_bf16_f32 v177, v202, v203
    v_add_u32 v218, s31, v210
    v_mfma_f32_16x16x32_bf16 v[16:19], a[112:115], v[184:187], v[16:19]
    v_exp_f32_e64 v200, v132
    v_mfma_f32_16x16x32_bf16 v[48:51], a[112:115], v[188:191], v[48:51]
    ds_read_b128 a[72:75], v214 offset:8448
    ds_read_b128 a[76:79], v215 offset:8448
    v_mfma_f32_16x16x32_bf16 v[20:23], a[116:119], v[184:187], v[20:23]
    v_exp_f32_e64 v201, v133
    v_mfma_f32_16x16x32_bf16 v[52:55], a[116:119], v[188:191], v[52:55]
    v_cvt_pk_bf16_f32 v178, v200, v201
    s_waitcnt lgkmcnt(4)
    v_mfma_f32_16x16x32_bf16 v[24:27], a[120:123], v[184:187], v[24:27]
    v_exp_f32_e64 v202, v134
    v_mfma_f32_16x16x32_bf16 v[56:59], a[120:123], v[188:191], v[56:59]
    ds_read_b128 a[80:83], v212 offset:12672
    ds_read_b128 a[84:87], v213 offset:12672
    v_mfma_f32_16x16x32_bf16 v[28:31], a[124:127], v[184:187], v[28:31]
    v_exp_f32_e64 v203, v135
    v_mfma_f32_16x16x32_bf16 v[60:63], a[124:127], v[188:191], v[60:63]
    buffer_load_dwordx4 a[232:235], v244, s[8:11], 0 offen
    v_cvt_pk_bf16_f32 v179, v202, v203
    v_mfma_f32_16x16x32_bf16 v[64:67], a[96:99], v[192:195], v[64:67]
    v_exp_f32_e64 v200, v136
    v_mfma_f32_16x16x32_bf16 v[96:99], a[96:99], v[196:199], v[96:99]
    ds_read_b128 a[88:91], v214 offset:12672
    ds_read_b128 a[92:95], v215 offset:12672
    v_mfma_f32_16x16x32_bf16 v[68:71], a[100:103], v[192:195], v[68:71]
    v_exp_f32_e64 v201, v137
    v_mfma_f32_16x16x32_bf16 v[100:103], a[100:103], v[196:199], v[100:103]
    buffer_load_dwordx4 a[236:239], v245, s[8:11], 0 offen
    v_cvt_pk_bf16_f32 v180, v200, v201
    v_mfma_f32_16x16x32_bf16 v[72:75], a[104:107], v[192:195], v[72:75]
    v_exp_f32_e64 v202, v138
    v_mfma_f32_16x16x32_bf16 v[104:107], a[104:107], v[196:199], v[104:107]
    buffer_load_dwordx4 a[240:243], v246, s[8:11], 0 offen
    buffer_load_dwordx4 a[244:247], v247, s[8:11], 0 offen
    v_mfma_f32_16x16x32_bf16 v[76:79], a[108:111], v[192:195], v[76:79]
    v_exp_f32_e64 v203, v139
    v_mfma_f32_16x16x32_bf16 v[108:111], a[108:111], v[196:199], v[108:111]
    ds_read_b128 v[244:247], v254 offset:128
    v_cvt_pk_bf16_f32 v181, v202, v203
    v_mfma_f32_16x16x32_bf16 v[80:83], a[112:115], v[192:195], v[80:83]
    v_exp_f32_e64 v200, v140
    v_mfma_f32_16x16x32_bf16 v[112:115], a[112:115], v[196:199], v[112:115]
    buffer_load_dwordx4 v220, s[8:11], s29 offen lds
    buffer_load_dwordx4 v221, s[8:11], s29 offen offset:1056 lds
    v_mfma_f32_16x16x32_bf16 v[84:87], a[116:119], v[192:195], v[84:87]
    v_exp_f32_e64 v201, v141
    v_mfma_f32_16x16x32_bf16 v[116:119], a[116:119], v[196:199], v[116:119]
    v_cvt_pk_bf16_f32 v182, v200, v201
    s_add_u32 s29, s29, 8192
    v_mfma_f32_16x16x32_bf16 v[88:91], a[120:123], v[192:195], v[88:91]
    v_exp_f32_e64 v202, v142
    v_mfma_f32_16x16x32_bf16 v[120:123], a[120:123], v[196:199], v[120:123]
    v_add_u32 v219, s31, v211
    s_mov_b32 s30, s31
    v_mfma_f32_16x16x32_bf16 v[92:95], a[124:127], v[192:195], v[92:95]
    v_exp_f32_e64 v203, v143
    v_mfma_f32_16x16x32_bf16 v[124:127], a[124:127], v[196:199], v[124:127]
    v_cvt_pk_bf16_f32 v183, v202, v203
    s_waitcnt lgkmcnt(0)
    s_add_u32 s31, s31, 16896
    s_cmp_eq_u32 s31, 80128
    s_cselect_b32 s31, 12544, s31
    v_mfma_f32_16x16x32_bf16 v[128:131], a[64:67], a[0:3], 0
    v_exp_f32_e64 v200, v144
    v_mfma_f32_16x16x32_bf16 v[128:131], a[68:71], a[4:7], v[128:131]
    ds_read_b64_tr_b16 a[96:97], v216 offset:0
    ds_read_b64_tr_b16 a[98:99], v216 offset:4224
    v_mfma_f32_16x16x32_bf16 v[128:131], a[72:75], a[8:11], v[128:131]
    v_exp_f32_e64 v201, v145
    v_mfma_f32_16x16x32_bf16 v[128:131], a[76:79], a[12:15], v[128:131]
    v_cvt_pk_bf16_f32 v192, v200, v201
    s_cmp_eq_u32 s29, 2572288
    v_mfma_f32_16x16x32_bf16 v[132:135], a[80:83], a[0:3], 0
    v_exp_f32_e64 v202, v146
    v_mfma_f32_16x16x32_bf16 v[132:135], a[84:87], a[4:7], v[132:135]
    ds_read_b64_tr_b16 a[100:101], v216 offset:32
    ds_read_b64_tr_b16 a[102:103], v216 offset:4256
    v_mfma_f32_16x16x32_bf16 v[132:135], a[88:91], a[8:11], v[132:135]
    v_exp_f32_e64 v203, v147
    v_mfma_f32_16x16x32_bf16 v[132:135], a[92:95], a[12:15], v[132:135]
    v_cvt_pk_bf16_f32 v193, v202, v203
    s_cselect_b32 s29, 0, s29
    v_mfma_f32_16x16x32_bf16 v[136:139], a[64:67], a[16:19], 0
    v_exp_f32_e64 v200, v148
    v_mfma_f32_16x16x32_bf16 v[136:139], a[68:71], a[20:23], v[136:139]
    ds_read_b64_tr_b16 a[104:105], v217 offset:0
    ds_read_b64_tr_b16 a[106:107], v217 offset:4224
    v_mfma_f32_16x16x32_bf16 v[136:139], a[72:75], a[24:27], v[136:139]
    v_exp_f32_e64 v201, v149
    v_mfma_f32_16x16x32_bf16 v[136:139], a[76:79], a[28:31], v[136:139]
    v_cvt_pk_bf16_f32 v194, v200, v201
    v_add_u32 v212, s31, v204
    v_mfma_f32_16x16x32_bf16 v[140:143], a[80:83], a[16:19], 0
    v_exp_f32_e64 v202, v150
    v_mfma_f32_16x16x32_bf16 v[140:143], a[84:87], a[20:23], v[140:143]
    ds_read_b64_tr_b16 a[108:109], v217 offset:32
    ds_read_b64_tr_b16 a[110:111], v217 offset:4256
    v_mfma_f32_16x16x32_bf16 v[140:143], a[88:91], a[24:27], v[140:143]
    v_exp_f32_e64 v203, v151
    v_mfma_f32_16x16x32_bf16 v[140:143], a[92:95], a[28:31], v[140:143]
    v_cvt_pk_bf16_f32 v195, v202, v203
    v_add_u32 v213, s31, v205
    v_mfma_f32_16x16x32_bf16 v[160:163], a[64:67], a[32:35], 0
    v_exp_f32_e64 v200, v152
    v_mfma_f32_16x16x32_bf16 v[160:163], a[68:71], a[36:39], v[160:163]
    ds_read_b64_tr_b16 a[112:113], v218 offset:0
    ds_read_b64_tr_b16 a[114:115], v218 offset:4224
    v_mfma_f32_16x16x32_bf16 v[160:163], a[72:75], a[40:43], v[160:163]
    v_exp_f32_e64 v201, v153
    v_mfma_f32_16x16x32_bf16 v[160:163], a[76:79], a[44:47], v[160:163]
    v_cvt_pk_bf16_f32 v196, v200, v201
    v_add_u32 v214, s31, v206
    v_mfma_f32_16x16x32_bf16 v[164:167], a[80:83], a[32:35], 0
    v_exp_f32_e64 v202, v154
    v_mfma_f32_16x16x32_bf16 v[164:167], a[84:87], a[36:39], v[164:167]
    ds_read_b64_tr_b16 a[116:117], v218 offset:32
    ds_read_b64_tr_b16 a[118:119], v218 offset:4256
    v_mfma_f32_16x16x32_bf16 v[164:167], a[88:91], a[40:43], v[164:167]
    v_exp_f32_e64 v203, v155
    v_mfma_f32_16x16x32_bf16 v[164:167], a[92:95], a[44:47], v[164:167]
    v_cvt_pk_bf16_f32 v197, v202, v203
    v_add_u32 v215, s31, v207
    v_mfma_f32_16x16x32_bf16 v[168:171], a[64:67], a[48:51], 0
    v_exp_f32_e64 v200, v156
    v_mfma_f32_16x16x32_bf16 v[168:171], a[68:71], a[52:55], v[168:171]
    ds_read_b64_tr_b16 a[120:121], v219 offset:0
    ds_read_b64_tr_b16 a[122:123], v219 offset:4224
    v_mfma_f32_16x16x32_bf16 v[168:171], a[72:75], a[56:59], v[168:171]
    v_exp_f32_e64 v201, v157
    v_mfma_f32_16x16x32_bf16 v[168:171], a[76:79], a[60:63], v[168:171]
    v_cvt_pk_bf16_f32 v198, v200, v201
    s_waitcnt vmcnt(8)
    v_mfma_f32_16x16x32_bf16 v[172:175], a[80:83], a[48:51], 0
    v_exp_f32_e64 v202, v158
    v_mfma_f32_16x16x32_bf16 v[172:175], a[84:87], a[52:55], v[172:175]
    ds_read_b64_tr_b16 a[124:125], v219 offset:32
    ds_read_b64_tr_b16 a[126:127], v219 offset:4256
    v_mfma_f32_16x16x32_bf16 v[172:175], a[88:91], a[56:59], v[172:175]
    v_exp_f32_e64 v203, v159
    v_mfma_f32_16x16x32_bf16 v[172:175], a[92:95], a[60:63], v[172:175]
    v_cvt_pk_bf16_f32 v199, v202, v203
    s_waitcnt lgkmcnt(4)
    v_mfma_f32_16x16x32_bf16 v[0:3], a[96:99], v[176:179], v[0:3]
    v_exp_f32_e64 v200, v128
    v_mfma_f32_16x16x32_bf16 v[32:35], a[96:99], v[180:183], v[32:35]
    s_barrier
    s_mov_b32 m0, s28
    v_mfma_f32_16x16x32_bf16 v[4:7], a[100:103], v[176:179], v[4:7]
    v_mfma_f32_16x16x32_bf16 v[248:251], a[212:215], a[216:219], 0
    v_exp_f32_e64 v201, v129
    v_mfma_f32_16x16x32_bf16 v[36:39], a[100:103], v[180:183], v[36:39]
    v_cvt_pk_bf16_f32 v184, v200, v201
    v_add_u32 v244, v244, v252
    v_mfma_f32_16x16x32_bf16 v[8:11], a[104:107], v[176:179], v[8:11]
    v_mfma_f32_16x16x32_bf16 v[248:251], a[212:215], a[220:223], v[248:251]
    v_exp_f32_e64 v202, v130
    v_mfma_f32_16x16x32_bf16 v[40:43], a[104:107], v[180:183], v[40:43]
    ds_read_b128 a[64:67], v212 offset:0
    ds_read_b128 a[68:71], v213 offset:0
    v_mfma_f32_16x16x32_bf16 v[12:15], a[108:111], v[176:179], v[12:15]
    v_mfma_f32_16x16x32_bf16 v[248:251], a[212:215], a[224:227], v[248:251]
    v_exp_f32_e64 v203, v131
    v_mfma_f32_16x16x32_bf16 v[44:47], a[108:111], v[180:183], v[44:47]
    v_cvt_pk_bf16_f32 v185, v202, v203
    v_add_u32 v245, v245, v252
    v_mfma_f32_16x16x32_bf16 v[16:19], a[112:115], v[176:179], v[16:19]
    v_mfma_f32_16x16x32_bf16 v[248:251], a[212:215], a[228:231], v[248:251]
    v_exp_f32_e64 v200, v132
    v_mfma_f32_16x16x32_bf16 v[48:51], a[112:115], v[180:183], v[48:51]
    ds_read_b128 a[72:75], v214 offset:0
    ds_read_b128 a[76:79], v215 offset:0
    v_mfma_f32_16x16x32_bf16 v[20:23], a[116:119], v[176:179], v[20:23]
    v_add_u32 v246, v246, v252
    v_exp_f32_e64 v201, v133
    v_mfma_f32_16x16x32_bf16 v[52:55], a[116:119], v[180:183], v[52:55]
    v_cvt_pk_bf16_f32 v186, v200, v201
    s_waitcnt lgkmcnt(4)
    v_mfma_f32_16x16x32_bf16 v[24:27], a[120:123], v[176:179], v[24:27]
    v_add_u32 v247, v247, v252
    v_exp_f32_e64 v202, v134
    v_mfma_f32_16x16x32_bf16 v[56:59], a[120:123], v[180:183], v[56:59]
    ds_read_b128 a[80:83], v212 offset:4224
    ds_read_b128 a[84:87], v213 offset:4224
    v_mfma_f32_16x16x32_bf16 v[28:31], a[124:127], v[176:179], v[28:31]
    v_exp_f32_e64 v203, v135
    v_mfma_f32_16x16x32_bf16 v[60:63], a[124:127], v[180:183], v[60:63]
    buffer_load_dwordx4 a[216:219], v244, s[8:11], 0 offen
    v_cvt_pk_bf16_f32 v187, v202, v203
    v_mfma_f32_16x16x32_bf16 v[64:67], a[96:99], v[192:195], v[64:67]
    v_exp_f32_e64 v200, v136
    v_mfma_f32_16x16x32_bf16 v[96:99], a[96:99], v[196:199], v[96:99]
    ds_read_b128 a[88:91], v214 offset:4224
    ds_read_b128 a[92:95], v215 offset:4224
    v_mfma_f32_16x16x32_bf16 v[68:71], a[100:103], v[192:195], v[68:71]
    v_exp_f32_e64 v201, v137
    v_mfma_f32_16x16x32_bf16 v[100:103], a[100:103], v[196:199], v[100:103]
    buffer_load_dwordx4 a[220:223], v245, s[8:11], 0 offen
    v_cvt_pk_bf16_f32 v188, v200, v201
    v_mfma_f32_16x16x32_bf16 v[72:75], a[104:107], v[192:195], v[72:75]
    v_exp_f32_e64 v202, v138
    v_mfma_f32_16x16x32_bf16 v[104:107], a[104:107], v[196:199], v[104:107]
    buffer_load_dwordx4 a[224:227], v246, s[8:11], 0 offen
    buffer_load_dwordx4 a[228:231], v247, s[8:11], 0 offen
    v_mfma_f32_16x16x32_bf16 v[76:79], a[108:111], v[192:195], v[76:79]
    v_exp_f32_e64 v203, v139
    v_mfma_f32_16x16x32_bf16 v[108:111], a[108:111], v[196:199], v[108:111]
    ds_read_b128 v[244:247], v254 offset:256
    v_cvt_pk_bf16_f32 v189, v202, v203
    v_mfma_f32_16x16x32_bf16 v[80:83], a[112:115], v[192:195], v[80:83]
    v_exp_f32_e64 v200, v140
    v_mfma_f32_16x16x32_bf16 v[112:115], a[112:115], v[196:199], v[112:115]
    buffer_load_dwordx4 v220, s[8:11], s29 offen lds
    buffer_load_dwordx4 v221, s[8:11], s29 offen offset:1056 lds
    v_mfma_f32_16x16x32_bf16 v[84:87], a[116:119], v[192:195], v[84:87]
    v_exp_f32_e64 v201, v141
    v_mfma_f32_16x16x32_bf16 v[116:119], a[116:119], v[196:199], v[116:119]
    v_cvt_pk_bf16_f32 v190, v200, v201
    s_add_u32 s29, s29, 8192
    v_mfma_f32_16x16x32_bf16 v[88:91], a[120:123], v[192:195], v[88:91]
    v_exp_f32_e64 v202, v142
    v_mfma_f32_16x16x32_bf16 v[120:123], a[120:123], v[196:199], v[120:123]
    v_add_u32 v254, 256, v254
    s_add_u32 s66, s28, 8448
    v_mfma_f32_16x16x32_bf16 v[92:95], a[124:127], v[192:195], v[92:95]
    v_exp_f32_e64 v203, v143
    v_mfma_f32_16x16x32_bf16 v[124:127], a[124:127], v[196:199], v[124:127]
    v_cvt_pk_bf16_f32 v191, v202, v203
    s_waitcnt lgkmcnt(0)
    v_mfma_f32_16x16x32_bf16 v[128:131], a[64:67], a[0:3], 0
    v_exp_f32_e64 v200, v160
    v_mfma_f32_16x16x32_bf16 v[128:131], a[68:71], a[4:7], v[128:131]
    ds_read_b64_tr_b16 a[96:97], v216 offset:8448
    ds_read_b64_tr_b16 a[98:99], v216 offset:12672
    v_mfma_f32_16x16x32_bf16 v[128:131], a[72:75], a[8:11], v[128:131]
    v_exp_f32_e64 v201, v161
    v_mfma_f32_16x16x32_bf16 v[128:131], a[76:79], a[12:15], v[128:131]
    v_cvt_pk_bf16_f32 v192, v200, v201
    s_add_u32 s28, s28, 16896
    v_mfma_f32_16x16x32_bf16 v[132:135], a[80:83], a[0:3], 0
    v_exp_f32_e64 v202, v162
    v_mfma_f32_16x16x32_bf16 v[132:135], a[84:87], a[4:7], v[132:135]
    ds_read_b64_tr_b16 a[100:101], v216 offset:8480
    ds_read_b64_tr_b16 a[102:103], v216 offset:12704
    v_mfma_f32_16x16x32_bf16 v[132:135], a[88:91], a[8:11], v[132:135]
    v_exp_f32_e64 v203, v163
    v_mfma_f32_16x16x32_bf16 v[132:135], a[92:95], a[12:15], v[132:135]
    v_cvt_pk_bf16_f32 v193, v202, v203
    s_cmp_eq_u32 s28, s67
    v_mfma_f32_16x16x32_bf16 v[136:139], a[64:67], a[16:19], 0
    v_exp_f32_e64 v200, v164
    v_mfma_f32_16x16x32_bf16 v[136:139], a[68:71], a[20:23], v[136:139]
    ds_read_b64_tr_b16 a[104:105], v217 offset:8448
    ds_read_b64_tr_b16 a[106:107], v217 offset:12672
    v_mfma_f32_16x16x32_bf16 v[136:139], a[72:75], a[24:27], v[136:139]
    v_exp_f32_e64 v201, v165
    v_mfma_f32_16x16x32_bf16 v[136:139], a[76:79], a[28:31], v[136:139]
    v_cvt_pk_bf16_f32 v194, v200, v201
    s_cselect_b32 s28, s27, s28
    v_mfma_f32_16x16x32_bf16 v[140:143], a[80:83], a[16:19], 0
    v_exp_f32_e64 v202, v166
    v_mfma_f32_16x16x32_bf16 v[140:143], a[84:87], a[20:23], v[140:143]
    ds_read_b64_tr_b16 a[108:109], v217 offset:8480
    ds_read_b64_tr_b16 a[110:111], v217 offset:12704
    v_mfma_f32_16x16x32_bf16 v[140:143], a[88:91], a[24:27], v[140:143]
    v_exp_f32_e64 v203, v167
    v_mfma_f32_16x16x32_bf16 v[140:143], a[92:95], a[28:31], v[140:143]
    v_cvt_pk_bf16_f32 v195, v202, v203
    v_add_u32 v255, 1024, v255
    v_mfma_f32_16x16x32_bf16 v[144:147], a[64:67], a[32:35], 0
    v_exp_f32_e64 v200, v168
    v_mfma_f32_16x16x32_bf16 v[144:147], a[68:71], a[36:39], v[144:147]
    ds_read_b64_tr_b16 a[112:113], v218 offset:8448
    ds_read_b64_tr_b16 a[114:115], v218 offset:12672
    v_mfma_f32_16x16x32_bf16 v[144:147], a[72:75], a[40:43], v[144:147]
    v_exp_f32_e64 v201, v169
    v_mfma_f32_16x16x32_bf16 v[144:147], a[76:79], a[44:47], v[144:147]
    v_cvt_pk_bf16_f32 v196, v200, v201
    v_mfma_f32_16x16x32_bf16 v[148:151], a[80:83], a[32:35], 0
    v_exp_f32_e64 v202, v170
    v_mfma_f32_16x16x32_bf16 v[148:151], a[84:87], a[36:39], v[148:151]
    ds_read_b64_tr_b16 a[116:117], v218 offset:8480
    ds_read_b64_tr_b16 a[118:119], v218 offset:12704
    v_mfma_f32_16x16x32_bf16 v[148:151], a[88:91], a[40:43], v[148:151]
    v_exp_f32_e64 v203, v171
    v_mfma_f32_16x16x32_bf16 v[148:151], a[92:95], a[44:47], v[148:151]
    v_cvt_pk_bf16_f32 v197, v202, v203
    v_mfma_f32_16x16x32_bf16 v[152:155], a[64:67], a[48:51], 0
    v_exp_f32_e64 v200, v172
    v_mfma_f32_16x16x32_bf16 v[152:155], a[68:71], a[52:55], v[152:155]
    ds_read_b64_tr_b16 a[120:121], v219 offset:8448
    ds_read_b64_tr_b16 a[122:123], v219 offset:12672
    v_mfma_f32_16x16x32_bf16 v[152:155], a[72:75], a[56:59], v[152:155]
    v_exp_f32_e64 v201, v173
    v_mfma_f32_16x16x32_bf16 v[152:155], a[76:79], a[60:63], v[152:155]
    v_cvt_pk_bf16_f32 v198, v200, v201
    s_waitcnt vmcnt(8)
    v_mfma_f32_16x16x32_bf16 v[156:159], a[80:83], a[48:51], 0
    v_exp_f32_e64 v202, v174
    v_mfma_f32_16x16x32_bf16 v[156:159], a[84:87], a[52:55], v[156:159]
    ds_read_b64_tr_b16 a[124:125], v219 offset:8480
    ds_read_b64_tr_b16 a[126:127], v219 offset:12704
    v_mfma_f32_16x16x32_bf16 v[156:159], a[88:91], a[56:59], v[156:159]
    v_exp_f32_e64 v203, v175
    v_mfma_f32_16x16x32_bf16 v[156:159], a[92:95], a[60:63], v[156:159]
    v_cvt_pk_bf16_f32 v199, v202, v203
    s_waitcnt lgkmcnt(4)
    v_mfma_f32_16x16x32_bf16 v[0:3], a[96:99], v[184:187], v[0:3]
    v_exp_f32_e64 v200, v128
    v_mfma_f32_16x16x32_bf16 v[32:35], a[96:99], v[188:191], v[32:35]
    v_add_u32 v216, s31, v208
    v_add_u32 v217, s31, v209
    v_mfma_f32_16x16x32_bf16 v[4:7], a[100:103], v[184:187], v[4:7]
    v_mfma_f32_16x16x32_bf16 v[248:251], a[212:215], a[232:235], v[248:251]
    v_exp_f32_e64 v201, v129
    v_mfma_f32_16x16x32_bf16 v[36:39], a[100:103], v[188:191], v[36:39]
    v_cvt_pk_bf16_f32 v176, v200, v201
    v_add_u32 v218, s31, v210
    v_mfma_f32_16x16x32_bf16 v[8:11], a[104:107], v[184:187], v[8:11]
    v_mfma_f32_16x16x32_bf16 v[248:251], a[212:215], a[236:239], v[248:251]
    v_exp_f32_e64 v202, v130
    v_mfma_f32_16x16x32_bf16 v[40:43], a[104:107], v[188:191], v[40:43]
    ds_read_b128 a[64:67], v212 offset:8448
    ds_read_b128 a[68:71], v213 offset:8448
    v_mfma_f32_16x16x32_bf16 v[12:15], a[108:111], v[184:187], v[12:15]
    v_mfma_f32_16x16x32_bf16 v[248:251], a[212:215], a[240:243], v[248:251]
    v_exp_f32_e64 v203, v131
    v_mfma_f32_16x16x32_bf16 v[44:47], a[108:111], v[188:191], v[44:47]
    v_cvt_pk_bf16_f32 v177, v202, v203
    v_add_u32 v219, s31, v211
    v_mfma_f32_16x16x32_bf16 v[16:19], a[112:115], v[184:187], v[16:19]
    v_mfma_f32_16x16x32_bf16 v[248:251], a[212:215], a[244:247], v[248:251]
    v_exp_f32_e64 v200, v132
    v_mfma_f32_16x16x32_bf16 v[48:51], a[112:115], v[188:191], v[48:51]
    ds_read_b128 a[72:75], v214 offset:8448
    ds_read_b128 a[76:79], v215 offset:8448
    v_mfma_f32_16x16x32_bf16 v[20:23], a[116:119], v[184:187], v[20:23]
    v_exp_f32_e64 v201, v133
    v_mfma_f32_16x16x32_bf16 v[52:55], a[116:119], v[188:191], v[52:55]
    v_cvt_pk_bf16_f32 v178, v200, v201
    s_waitcnt lgkmcnt(4)
    v_mfma_f32_16x16x32_bf16 v[24:27], a[120:123], v[184:187], v[24:27]
    v_exp_f32_e64 v202, v134
    v_mfma_f32_16x16x32_bf16 v[56:59], a[120:123], v[188:191], v[56:59]
    ds_read_b128 a[80:83], v212 offset:12672
    ds_read_b128 a[84:87], v213 offset:12672
    v_mfma_f32_16x16x32_bf16 v[28:31], a[124:127], v[184:187], v[28:31]
    v_exp_f32_e64 v203, v135
    v_mfma_f32_16x16x32_bf16 v[60:63], a[124:127], v[188:191], v[60:63]
    v_cvt_pk_bf16_f32 v179, v202, v203
    s_mov_b32 m0, s66
    v_mfma_f32_16x16x32_bf16 v[64:67], a[96:99], v[192:195], v[64:67]
    v_exp_f32_e64 v200, v136
    v_mfma_f32_16x16x32_bf16 v[96:99], a[96:99], v[196:199], v[96:99]
    ds_read_b128 a[88:91], v214 offset:12672
    ds_read_b128 a[92:95], v215 offset:12672
    v_mfma_f32_16x16x32_bf16 v[68:71], a[100:103], v[192:195], v[68:71]
    v_exp_f32_e64 v201, v137
    v_mfma_f32_16x16x32_bf16 v[100:103], a[100:103], v[196:199], v[100:103]
    v_cvt_pk_bf16_f32 v180, v200, v201
    s_mov_b32 s30, s31
    v_mfma_f32_16x16x32_bf16 v[72:75], a[104:107], v[192:195], v[72:75]
    v_exp_f32_e64 v202, v138
    v_mfma_f32_16x16x32_bf16 v[104:107], a[104:107], v[196:199], v[104:107]
    buffer_load_dwordx4 v220, s[8:11], s29 offen lds
    s_add_u32 s31, s31, 16896
    v_mfma_f32_16x16x32_bf16 v[76:79], a[108:111], v[192:195], v[76:79]
    v_exp_f32_e64 v203, v139
    v_mfma_f32_16x16x32_bf16 v[108:111], a[108:111], v[196:199], v[108:111]
    v_cvt_pk_bf16_f32 v181, v202, v203
    s_cmp_eq_u32 s31, 80128
    v_mfma_f32_16x16x32_bf16 v[80:83], a[112:115], v[192:195], v[80:83]
    v_exp_f32_e64 v200, v140
    v_mfma_f32_16x16x32_bf16 v[112:115], a[112:115], v[196:199], v[112:115]
    buffer_load_dwordx4 v221, s[8:11], s29 offen offset:1056 lds
    s_cselect_b32 s31, 12544, s31
    v_mfma_f32_16x16x32_bf16 v[84:87], a[116:119], v[192:195], v[84:87]
    v_exp_f32_e64 v201, v141
    v_mfma_f32_16x16x32_bf16 v[116:119], a[116:119], v[196:199], v[116:119]
    v_cvt_pk_bf16_f32 v182, v200, v201
    s_add_u32 s29, s29, 8192
    v_mfma_f32_16x16x32_bf16 v[88:91], a[120:123], v[192:195], v[88:91]
    v_exp_f32_e64 v202, v142
    v_mfma_f32_16x16x32_bf16 v[120:123], a[120:123], v[196:199], v[120:123]
    s_add_u32 s69, s69, 1
    v_mfma_f32_16x16x32_bf16 v[92:95], a[124:127], v[192:195], v[92:95]
    v_exp_f32_e64 v203, v143
    v_mfma_f32_16x16x32_bf16 v[124:127], a[124:127], v[196:199], v[124:127]
    v_cvt_pk_bf16_f32 v183, v202, v203
    s_waitcnt lgkmcnt(0)
    s_cbranch_scc0 K2_GLOOP
K2_NLOOP_IN:
    s_cmp_eq_u32 s32, 0
    s_cbranch_scc1 K2_TAIL
.p2align 6
K2_LOOP:
    v_mfma_f32_16x16x32_bf16 v[128:131], a[64:67], a[0:3], 0
    v_exp_f32_e64 v200, v144
    v_mfma_f32_16x16x32_bf16 v[128:131], a[68:71], a[4:7], v[128:131]
    ds_read_b64_tr_b16 a[96:97], v216 offset:0
    ds_read_b64_tr_b16 a[98:99], v216 offset:4224
    v_mfma_f32_16x16x32_bf16 v[128:131], a[72:75], a[8:11], v[128:131]
    v_exp_f32_e64 v201, v145
    v_mfma_f32_16x16x32_bf16 v[128:131], a[76:79], a[12:15], v[128:131]
    v_cvt_pk_bf16_f32 v192, v200, v201
    s_cmp_eq_u32 s29, 2572288
    v_mfma_f32_16x16x32_bf16 v[132:135], a[80:83], a[0:3], 0
    v_exp_f32_e64 v202, v146
    v_mfma_f32_16x16x32_bf16 v[132:135], a[84:87], a[4:7], v[132:135]
    ds_read_b64_tr_b16 a[100:101], v216 offset:32
    ds_read_b64_tr_b16 a[102:103], v216 offset:4256
    v_mfma_f32_16x16x32_bf16 v[132:135], a[88:91], a[8:11], v[132:135]
    v_exp_f32_e64 v203, v147
    v_mfma_f32_16x16x32_bf16 v[132:135], a[92:95], a[12:15], v[132:135]
    v_cvt_pk_bf16_f32 v193, v202, v203
    s_cselect_b32 s29, 0, s29
    v_mfma_f32_16x16x32_bf16 v[136:139], a[64:67], a[16:19], 0
    v_exp_f32_e64 v200, v148
    v_mfma_f32_16x16x32_bf16 v[136:139], a[68:71], a[20:23], v[136:139]
    ds_read_b64_tr_b16 a[104:105], v217 offset:0
    ds_read_b64_tr_b16 a[106:107], v217 offset:4224
    v_mfma_f32_16x16x32_bf16 v[136:139], a[72:75], a[24:27], v[136:139]
    v_exp_f32_e64 v201, v149
    v_mfma_f32_16x16x32_bf16 v[136:139], a[76:79], a[28:31], v[136:139]
    v_cvt_pk_bf16_f32 v194, v200, v201
    v_add_u32 v212, s31, v204
    v_mfma_f32_16x16x32_bf16 v[140:143], a[80:83], a[16:19], 0
    v_exp_f32_e64 v202, v150
    v_mfma_f32_16x16x32_bf16 v[140:143], a[84:87], a[20:23], v[140:143]
    ds_read_b64_tr_b16 a[108:109], v217 offset:32
    ds_read_b64_tr_b16 a[110:111], v217 offset:4256
    v_mfma_f32_16x16x32_bf16 v[140:143], a[88:91], a[24:27], v[140:143]
    v_exp_f32_e64 v203, v151
    v_mfma_f32_16x16x32_bf16 v[140:143], a[92:95], a[28:31], v[140:143]
    v_cvt_pk_bf16_f32 v195, v202, v203
    v_add_u32 v213, s31, v205
    v_mfma_f32_16x16x32_bf16 v[160:163], a[64:67], a[32:35], 0
    v_exp_f32_e64 v200, v152
    v_mfma_f32_16x16x32_bf16 v[160:163], a[68:71], a[36:39], v[160:163]
    ds_read_b64_tr_b16 a[112:113], v218 offset:0
    ds_read_b64_tr_b16 a[114:115], v218 offset:4224
    v_mfma_f32_16x16x32_bf16 v[160:163], a[72:75], a[40:43], v[160:163]
    v_exp_f32_e64 v201, v153
    v_mfma_f32_16x16x32_bf16 v[160:163], a[76:79], a[44:47], v[160:163]
    v_cvt_pk_bf16_f32 v196, v200, v201
    v_add_u32 v214, s31, v206
    v_mfma_f32_16x16x32_bf16 v[164:167], a[80:83], a[32:35], 0
    v_exp_f32_e64 v202, v154
    v_mfma_f32_16x16x32_bf16 v[164:167], a[84:87], a[36:39], v[164:167]
    ds_read_b64_tr_b16 a[116:117], v218 offset:32
    ds_read_b64_tr_b16 a[118:119], v218 offset:4256
    v_mfma_f32_16x16x32_bf16 v[164:167], a[88:91], a[40:43], v[164:167]
    v_exp_f32_e64 v203, v155
    v_mfma_f32_16x16x32_bf16 v[164:167], a[92:95], a[44:47], v[164:167]
    v_cvt_pk_bf16_f32 v197, v202, v203
    v_add_u32 v215, s31, v207
    v_mfma_f32_16x16x32_bf16 v[168:171], a[64:67], a[48:51], 0
    v_exp_f32_e64 v200, v156
    v_mfma_f32_16x16x32_bf16 v[168:171], a[68:71], a[52:55], v[168:171]
    ds_read_b64_tr_b16 a[120:121], v219 offset:0
    ds_read_b64_tr_b16 a[122:123], v219 offset:4224
    v_mfma_f32_16x16x32_bf16 v[168:171], a[72:75], a[56:59], v[168:171]
    v_exp_f32_e64 v201, v157
    v_mfma_f32_16x16x32_bf16 v[168:171], a[76:79], a[60:63], v[168:171]
    v_cvt_pk_bf16_f32 v198, v200, v201
    s_waitcnt vmcnt(4)
    v_mfma_f32_16x16x32_bf16 v[172:175], a[80:83], a[48:51], 0
    v_exp_f32_e64 v202, v158
    v_mfma_f32_16x16x32_bf16 v[172:175], a[84:87], a[52:55], v[172:175]
    ds_read_b64_tr_b16 a[124:125], v219 offset:32
    ds_read_b64_tr_b16 a[126:127], v219 offset:4256
    v_mfma_f32_16x16x32_bf16 v[172:175], a[88:91], a[56:59], v[172:175]
    v_exp_f32_e64 v203, v159
    v_mfma_f32_16x16x32_bf16 v[172:175], a[92:95], a[60:63], v[172:175]
    v_cvt_pk_bf16_f32 v199, v202, v203
    s_waitcnt lgkmcnt(4)
    v_mfma_f32_16x16x32_bf16 v[0:3], a[96:99], v[176:179], v[0:3]
    v_exp_f32_e64 v200, v128
    v_mfma_f32_16x16x32_bf16 v[32:35], a[96:99], v[180:183], v[32:35]
    s_barrier
    s_mov_b32 m0, s28
    v_mfma_f32_16x16x32_bf16 v[4:7], a[100:103], v[176:179], v[4:7]
    v_exp_f32_e64 v201, v129
    v_mfma_f32_16x16x32_bf16 v[36:39], a[100:103], v[180:183], v[36:39]
    v_cvt_pk_bf16_f32 v184, v200, v201
    v_mfma_f32_16x16x32_bf16 v[8:11], a[104:107], v[176:179], v[8:11]
    v_exp_f32_e64 v202, v130
    v_mfma_f32_16x16x32_bf16 v[40:43], a[104:107], v[180:183], v[40:43]
    ds_read_b128 a[64:67], v212 offset:0
    ds_read_b128 a[68:71], v213 offset:0
    v_mfma_f32_16x16x32_bf16 v[12:15], a[108:111], v[176:179], v[12:15]
    v_exp_f32_e64 v203, v131
    v_mfma_f32_16x16x32_bf16 v[44:47], a[108:111], v[180:183], v[44:47]
    v_cvt_pk_bf16_f32 v185, v202, v203
    v_mfma_f32_16x16x32_bf16 v[16:19], a[112:115], v[176:179], v[16:19]
    v_exp_f32_e64 v200, v132
    v_mfma_f32_16x16x32_bf16 v[48:51], a[112:115], v[180:183], v[48:51]
    ds_read_b128 a[72:75], v214 offset:0
    ds_read_b128 a[76:79], v215 offset:0
    v_mfma_f32_16x16x32_bf16 v[20:23], a[116:119], v[176:179], v[20:23]
    v_exp_f32_e64 v201, v133
    v_mfma_f32_16x16x32_bf16 v[52:55], a[116:119], v[180:183], v[52:55]
    v_cvt_pk_bf16_f32 v186, v200, v201
    s_waitcnt lgkmcnt(4)
    v_mfma_f32_16x16x32_bf16 v[24:27], a[120:123], v[176:179], v[24:27]
    v_exp_f32_e64 v202, v134
    v_mfma_f32_16x16x32_bf16 v[56:59], a[120:123], v[180:183], v[56:59]
    ds_read_b128 a[80:83], v212 offset:4224
    ds_read_b128 a[84:87], v213 offset:4224
    v_mfma_f32_16x16x32_bf16 v[28:31], a[124:127], v[176:179], v[28:31]
    v_exp_f32_e64 v203, v135
    v_mfma_f32_16x16x32_bf16 v[60:63], a[124:127], v[180:183], v[60:63]
    v_cvt_pk_bf16_f32 v187, v202, v203
    v_mfma_f32_16x16x32_bf16 v[64:67], a[96:99], v[192:195], v[64:67]
    v_exp_f32_e64 v200, v136
    v_mfma_f32_16x16x32_bf16 v[96:99], a[96:99], v[196:199], v[96:99]
    ds_read_b128 a[88:91], v214 offset:4224
    ds_read_b128 a[92:95], v215 offset:4224
    v_mfma_f32_16x16x32_bf16 v[68:71], a[100:103], v[192:195], v[68:71]
    v_exp_f32_e64 v201, v137
    v_mfma_f32_16x16x32_bf16 v[100:103], a[100:103], v[196:199], v[100:103]
    v_cvt_pk_bf16_f32 v188, v200, v201
    v_mfma_f32_16x16x32_bf16 v[72:75], a[104:107], v[192:195], v[72:75]
    v_exp_f32_e64 v202, v138
    v_mfma_f32_16x16x32_bf16 v[104:107], a[104:107], v[196:199], v[104:107]
    buffer_load_dwordx4 v220, s[8:11], s29 offen lds
    s_add_u32 s66, s28, 8448
    v_mfma_f32_16x16x32_bf16 v[76:79], a[108:111], v[192:195], v[76:79]
    v_exp_f32_e64 v203, v139
    v_mfma_f32_16x16x32_bf16 v[108:111], a[108:111], v[196:199], v[108:111]
    v_cvt_pk_bf16_f32 v189, v202, v203
    v_mfma_f32_16x16x32_bf16 v[80:83], a[112:115], v[192:195], v[80:83]
    v_exp_f32_e64 v200, v140
    v_mfma_f32_16x16x32_bf16 v[112:115], a[112:115], v[196:199], v[112:115]
    buffer_load_dwordx4 v221, s[8:11], s29 offen offset:1056 lds
    s_add_u32 s29, s29, 8192
    v_mfma_f32_16x16x32_bf16 v[84:87], a[116:119], v[192:195], v[84:87]
    v_exp_f32_e64 v201, v141
    v_mfma_f32_16x16x32_bf16 v[116:119], a[116:119], v[196:199], v[116:119]
    v_cvt_pk_bf16_f32 v190, v200, v201
    v_mfma_f32_16x16x32_bf16 v[88:91], a[120:123], v[192:195], v[88:91]
    v_exp_f32_e64 v202, v142
    v_mfma_f32_16x16x32_bf16 v[120:123], a[120:123], v[196:199], v[120:123]
    s_cmp_eq_u32 s71, 0
    s_cbranch_scc0 K2_PFN
K2_PFRN:
    v_mfma_f32_16x16x32_bf16 v[92:95], a[124:127], v[192:195], v[92:95]
    v_exp_f32_e64 v203, v143
    v_mfma_f32_16x16x32_bf16 v[124:127], a[124:127], v[196:199], v[124:127]
    v_cvt_pk_bf16_f32 v191, v202, v203
    s_waitcnt lgkmcnt(0)
    v_mfma_f32_16x16x32_bf16 v[128:131], a[64:67], a[0:3], 0
    v_exp_f32_e64 v200, v160
    v_mfma_f32_16x16x32_bf16 v[128:131], a[68:71], a[4:7], v[128:131]
    ds_read_b64_tr_b16 a[96:97], v216 offset:8448
    ds_read_b64_tr_b16 a[98:99], v216 offset:12672
    v_mfma_f32_16x16x32_bf16 v[128:131], a[72:75], a[8:11], v[128:131]
    v_exp_f32_e64 v201, v161
    v_mfma_f32_16x16x32_bf16 v[128:131], a[76:79], a[12:15], v[128:131]
    v_cvt_pk_bf16_f32 v192, v200, v201
    s_add_u32 s28, s28, 16896
    v_mfma_f32_16x16x32_bf16 v[132:135], a[80:83], a[0:3], 0
    v_exp_f32_e64 v202, v162
    v_mfma_f32_16x16x32_bf16 v[132:135], a[84:87], a[4:7], v[132:135]
    ds_read_b64_tr_b16 a[100:101], v216 offset:8480
    ds_read_b64_tr_b16 a[102:103], v216 offset:12704
    v_mfma_f32_16x16x32_bf16 v[132:135], a[88:91], a[8:11], v[132:135]
    v_exp_f32_e64 v203, v163
    v_mfma_f32_16x16x32_bf16 v[132:135], a[92:95], a[12:15], v[132:135]
    v_cvt_pk_bf16_f32 v193, v202, v203
    s_cmp_eq_u32 s28, s67
    v_mfma_f32_16x16x32_bf16 v[136:139], a[64:67], a[16:19], 0
    v_exp_f32_e64 v200, v164
    v_mfma_f32_16x16x32_bf16 v[136:139], a[68:71], a[20:23], v[136:139]
    ds_read_b64_tr_b16 a[104:105], v217 offset:8448
    ds_read_b64_tr_b16 a[106:107], v217 offset:12672
    v_mfma_f32_16x16x32_bf16 v[136:139], a[72:75], a[24:27], v[136:139]
    v_exp_f32_e64 v201, v165
    v_mfma_f32_16x16x32_bf16 v[136:139], a[76:79], a[28:31], v[136:139]
    v_cvt_pk_bf16_f32 v194, v200, v201
    s_cselect_b32 s28, s27, s28
    v_mfma_f32_16x16x32_bf16 v[140:143], a[80:83], a[16:19], 0
    v_exp_f32_e64 v202, v166
    v_mfma_f32_16x16x32_bf16 v[140:143], a[84:87], a[20:23], v[140:143]
    ds_read_b64_tr_b16 a[108:109], v217 offset:8480
    ds_read_b64_tr_b16 a[110:111], v217 offset:12704
    v_mfma_f32_16x16x32_bf16 v[140:143], a[88:91], a[24:27], v[140:143]
    v_exp_f32_e64 v203, v167
    v_mfma_f32_16x16x32_bf16 v[140:143], a[92:95], a[28:31], v[140:143]
    v_cvt_pk_bf16_f32 v195, v202, v203
    v_mfma_f32_16x16x32_bf16 v[144:147], a[64:67], a[32:35], 0
    v_exp_f32_e64 v200, v168
    v_mfma_f32_16x16x32_bf16 v[144:147], a[68:71], a[36:39], v[144:147]
    ds_read_b64_tr_b16 a[112:113], v218 offset:8448
    ds_read_b64_tr_b16 a[114:115], v218 offset:12672
    v_mfma_f32_16x16x32_bf16 v[144:147], a[72:75], a[40:43], v[144:147]
    v_exp_f32_e64 v201, v169
    v_mfma_f32_16x16x32_bf16 v[144:147], a[76:79], a[44:47], v[144:147]
    v_cvt_pk_bf16_f32 v196, v200, v201
    v_mfma_f32_16x16x32_bf16 v[148:151], a[80:83], a[32:35], 0
    v_exp_f32_e64 v202, v170
    v_mfma_f32_16x16x32_bf16 v[148:151], a[84:87], a[36:39], v[148:151]
    ds_read_b64_tr_b16 a[116:117], v218 offset:8480
    ds_read_b64_tr_b16 a[118:119], v218 offset:12704
    v_mfma_f32_16x16x32_bf16 v[148:151], a[88:91], a[40:43], v[148:151]
    v_exp_f32_e64 v203, v171
    v_mfma_f32_16x16x32_bf16 v[148:151], a[92:95], a[44:47], v[148:151]
    v_cvt_pk_bf16_f32 v197, v202, v203
    v_mfma_f32_16x16x32_bf16 v[152:155], a[64:67], a[48:51], 0
    v_exp_f32_e64 v200, v172
    v_mfma_f32_16x16x32_bf16 v[152:155], a[68:71], a[52:55], v[152:155]
    ds_read_b64_tr_b16 a[120:121], v219 offset:8448
    ds_read_b64_tr_b16 a[122:123], v219 offset:12672
    v_mfma_f32_16x16x32_bf16 v[152:155], a[72:75], a[56:59], v[152:155]
    v_exp_f32_e64 v201, v173
    v_mfma_f32_16x16x32_bf16 v[152:155], a[76:79], a[60:63], v[152:155]
    v_cvt_pk_bf16_f32 v198, v200, v201
    v_mfma_f32_16x16x32_bf16 v[156:159], a[80:83], a[48:51], 0
    v_exp_f32_e64 v202, v174
    v_mfma_f32_16x16x32_bf16 v[156:159], a[84:87], a[52:55], v[156:159]
    ds_read_b64_tr_b16 a[124:125], v219 offset:8480
    ds_read_b64_tr_b16 a[126:127], v219 offset:12704
    v_mfma_f32_16x16x32_bf16 v[156:159], a[88:91], a[56:59], v[156:159]
    v_exp_f32_e64 v203, v175
    v_mfma_f32_16x16x32_bf16 v[156:159], a[92:95], a[60:63], v[156:159]
    v_cvt_pk_bf16_f32 v199, v202, v203
    s_waitcnt lgkmcnt(4)
    v_mfma_f32_16x16x32_bf16 v[0:3], a[96:99], v[184:187], v[0:3]
    v_exp_f32_e64 v200, v128
    v_mfma_f32_16x16x32_bf16 v[32:35], a[96:99], v[188:191], v[32:35]
    v_add_u32 v216, s31, v208
    v_add_u32 v217, s31, v209
    v_mfma_f32_16x16x32_bf16 v[4:7], a[100:103], v[184:187], v[4:7]
    v_exp_f32_e64 v201, v129
    v_mfma_f32_16x16x32_bf16 v[36:39], a[100:103], v[188:191], v[36:39]
    v_cvt_pk_bf16_f32 v176, v200, v201
    v_add_u32 v218, s31, v210
    v_mfma_f32_16x16x32_bf16 v[8:11], a[104:107], v[184:187], v[8:11]
    v_exp_f32_e64 v202, v130
    v_mfma_f32_16x16x32_bf16 v[40:43], a[104:107], v[188:191], v[40:43]
    ds_read_b128 a[64:67], v212 offset:8448
    ds_read_b128 a[68:71], v213 offset:8448
    v_mfma_f32_16x16x32_bf16 v[12:15], a[108:111], v[184:187], v[12:15]
    v_exp_f32_e64 v203, v131
    v_mfma_f32_16x16x32_bf16 v[44:47], a[108:111], v[188:191], v[44:47]
    v_cvt_pk_bf16_f32 v177, v202, v203
    v_add_u32 v219, s31, v211
    v_mfma_f32_16x16x32_bf16 v[16:19], a[112:115], v[184:187], v[16:19]
    v_exp_f32_e64 v200, v132
    v_mfma_f32_16x16x32_bf16 v[48:51], a[112:115], v[188:191], v[48:51]
    ds_read_b128 a[72:75], v214 offset:8448
    ds_read_b128 a[76:79], v215 offset:8448
    v_mfma_f32_16x16x32_bf16 v[20:23], a[116:119], v[184:187], v[20:23]
    v_exp_f32_e64 v201, v133
    v_mfma_f32_16x16x32_bf16 v[52:55], a[116:119], v[188:191], v[52:55]
    v_cvt_pk_bf16_f32 v178, v200, v201
    s_waitcnt lgkmcnt(4)
    v_mfma_f32_16x16x32_bf16 v[24:27], a[120:123], v[184:187], v[24:27]
    v_exp_f32_e64 v202, v134
    v_mfma_f32_16x16x32_bf16 v[56:59], a[120:123], v[188:191], v[56:59]
    ds_read_b128 a[80:83], v212 offset:12672
    ds_read_b128 a[84:87], v213 offset:12672
    v_mfma_f32_16x16x32_bf16 v[28:31], a[124:127], v[184:187], v[28:31]
    v_exp_f32_e64 v203, v135
    v_mfma_f32_16x16x32_bf16 v[60:63], a[124:127], v[188:191], v[60:63]
    v_cvt_pk_bf16_f32 v179, v202, v203
    s_mov_b32 m0, s66
    v_mfma_f32_16x16x32_bf16 v[64:67], a[96:99], v[192:195], v[64:67]
    v_exp_f32_e64 v200, v136
    v_mfma_f32_16x16x32_bf16 v[96:99], a[96:99], v[196:199], v[96:99]
    ds_read_b128 a[88:91], v214 offset:12672
    ds_read_b128 a[92:95], v215 offset:12672
    v_mfma_f32_16x16x32_bf16 v[68:71], a[100:103], v[192:195], v[68:71]
    v_exp_f32_e64 v201, v137
    v_mfma_f32_16x16x32_bf16 v[100:103], a[100:103], v[196:199], v[100:103]
    v_cvt_pk_bf16_f32 v180, v200, v201
    s_mov_b32 s30, s31
    v_mfma_f32_16x16x32_bf16 v[72:75], a[104:107], v[192:195], v[72:75]
    v_exp_f32_e64 v202, v138
    v_mfma_f32_16x16x32_bf16 v[104:107], a[104:107], v[196:199], v[104:107]
    buffer_load_dwordx4 v220, s[8:11], s29 offen lds
    s_add_u32 s31, s31, 16896
    v_mfma_f32_16x16x32_bf16 v[76:79], a[108:111], v[192:195], v[76:79]
    v_exp_f32_e64 v203, v139
    v_mfma_f32_16x16x32_bf16 v[108:111], a[108:111], v[196:199], v[108:111]
    v_cvt_pk_bf16_f32 v181, v202, v203
    s_cmp_eq_u32 s31, 80128
    v_mfma_f32_16x16x32_bf16 v[80:83], a[112:115], v[192:195], v[80:83]
    v_exp_f32_e64 v200, v140
    v_mfma_f32_16x16x32_bf16 v[112:115], a[112:115], v[196:199], v[112:115]
    buffer_load_dwordx4 v221, s[8:11], s29 offen offset:1056 lds
    s_cselect_b32 s31, 12544, s31
    v_mfma_f32_16x16x32_bf16 v[84:87], a[116:119], v[192:195], v[84:87]
    v_exp_f32_e64 v201, v141
    v_mfma_f32_16x16x32_bf16 v[116:119], a[116:119], v[196:199], v[116:119]
    v_cvt_pk_bf16_f32 v182, v200, v201
    s_add_u32 s29, s29, 8192
    v_mfma_f32_16x16x32_bf16 v[88:91], a[120:123], v[192:195], v[88:91]
    v_exp_f32_e64 v202, v142
    v_mfma_f32_16x16x32_bf16 v[120:123], a[120:123], v[196:199], v[120:123]
    s_add_u32 s32, s32, 1
    v_mfma_f32_16x16x32_bf16 v[92:95], a[124:127], v[192:195], v[92:95]
    v_exp_f32_e64 v203, v143
    v_mfma_f32_16x16x32_bf16 v[124:127], a[124:127], v[196:199], v[124:127]
    v_cvt_pk_bf16_f32 v183, v202, v203
    s_waitcnt lgkmcnt(0)
    s_cbranch_scc0 K2_LOOP
K2_TAIL:
    v_mfma_f32_16x16x32_bf16 v[128:131], a[64:67], a[0:3], 0
    v_exp_f32_e64 v200, v144
    v_mfma_f32_16x16x32_bf16 v[128:131], a[68:71], a[4:7], v[128:131]
    ds_read_b64_tr_b16 a[96:97], v216 offset:0
    ds_read_b64_tr_b16 a[98:99], v216 offset:4224
    v_mfma_f32_16x16x32_bf16 v[128:131], a[72:75], a[8:11], v[128:131]
    v_exp_f32_e64 v201, v145
    v_mfma_f32_16x16x32_bf16 v[128:131], a[76:79], a[12:15], v[128:131]
    v_cvt_pk_bf16_f32 v192, v200, v201
    s_cmp_eq_u32 s29, 2572288
    v_mfma_f32_16x16x32_bf16 v[132:135], a[80:83], a[0:3], 0
    v_exp_f32_e64 v202, v146
    v_mfma_f32_16x16x32_bf16 v[132:135], a[84:87], a[4:7], v[132:135]
    ds_read_b64_tr_b16 a[100:101], v216 offset:32
    ds_read_b64_tr_b16 a[102:103], v216 offset:4256
    v_mfma_f32_16x16x32_bf16 v[132:135], a[88:91], a[8:11], v[132:135]
    v_exp_f32_e64 v203, v147
    v_mfma_f32_16x16x32_bf16 v[132:135], a[92:95], a[12:15], v[132:135]
    v_cvt_pk_bf16_f32 v193, v202, v203
    s_cselect_b32 s29, 0, s29
    v_mfma_f32_16x16x32_bf16 v[136:139], a[64:67], a[16:19], 0
    v_exp_f32_e64 v200, v148
    v_mfma_f32_16x16x32_bf16 v[136:139], a[68:71], a[20:23], v[136:139]
    ds_read_b64_tr_b16 a[104:105], v217 offset:0
    ds_read_b64_tr_b16 a[106:107], v217 offset:4224
    v_mfma_f32_16x16x32_bf16 v[136:139], a[72:75], a[24:27], v[136:139]
    v_exp_f32_e64 v201, v149
    v_mfma_f32_16x16x32_bf16 v[136:139], a[76:79], a[28:31], v[136:139]
    v_cvt_pk_bf16_f32 v194, v200, v201
    v_add_u32 v212, s31, v204
    v_mfma_f32_16x16x32_bf16 v[140:143], a[80:83], a[16:19], 0
    v_exp_f32_e64 v202, v150
    v_mfma_f32_16x16x32_bf16 v[140:143], a[84:87], a[20:23], v[140:143]
    ds_read_b64_tr_b16 a[108:109], v217 offset:32
    ds_read_b64_tr_b16 a[110:111], v217 offset:4256
    v_mfma_f32_16x16x32_bf16 v[140:143], a[88:91], a[24:27], v[140:143]
    v_exp_f32_e64 v203, v151
    v_mfma_f32_16x16x32_bf16 v[140:143], a[92:95], a[28:31], v[140:143]
    v_cvt_pk_bf16_f32 v195, v202, v203
    v_add_u32 v213, s31, v205
    v_mfma_f32_16x16x32_bf16 v[160:163], a[64:67], a[32:35], 0
    v_exp_f32_e64 v200, v152
    v_mfma_f32_16x16x32_bf16 v[160:163], a[68:71], a[36:39], v[160:163]
    ds_read_b64_tr_b16 a[112:113], v218 offset:0
    ds_read_b64_tr_b16 a[114:115], v218 offset:4224
    v_mfma_f32_16x16x32_bf16 v[160:163], a[72:75], a[40:43], v[160:163]
    v_exp_f32_e64 v201, v153
    v_mfma_f32_16x16x32_bf16 v[160:163], a[76:79], a[44:47], v[160:163]
    v_cvt_pk_bf16_f32 v196, v200, v201
    v_add_u32 v214, s31, v206
    v_mfma_f32_16x16x32_bf16 v[164:167], a[80:83], a[32:35], 0
    v_exp_f32_e64 v202, v154
    v_mfma_f32_16x16x32_bf16 v[164:167], a[84:87], a[36:39], v[164:167]
    ds_read_b64_tr_b16 a[116:117], v218 offset:32
    ds_read_b64_tr_b16 a[118:119], v218 offset:4256
    v_mfma_f32_16x16x32_bf16 v[164:167], a[88:91], a[40:43], v[164:167]
    v_exp_f32_e64 v203, v155
    v_mfma_f32_16x16x32_bf16 v[164:167], a[92:95], a[44:47], v[164:167]
    v_cvt_pk_bf16_f32 v197, v202, v203
    v_add_u32 v215, s31, v207
    v_mfma_f32_16x16x32_bf16 v[168:171], a[64:67], a[48:51], 0
    v_exp_f32_e64 v200, v156
    v_mfma_f32_16x16x32_bf16 v[168:171], a[68:71], a[52:55], v[168:171]
    ds_read_b64_tr_b16 a[120:121], v219 offset:0
    ds_read_b64_tr_b16 a[122:123], v219 offset:4224
    v_mfma_f32_16x16x32_bf16 v[168:171], a[72:75], a[56:59], v[168:171]
    v_exp_f32_e64 v201, v157
    v_mfma_f32_16x16x32_bf16 v[168:171], a[76:79], a[60:63], v[168:171]
    v_cvt_pk_bf16_f32 v198, v200, v201
    s_waitcnt vmcnt(4)
    v_mfma_f32_16x16x32_bf16 v[172:175], a[80:83], a[48:51], 0
    v_exp_f32_e64 v202, v158
    v_mfma_f32_16x16x32_bf16 v[172:175], a[84:87], a[52:55], v[172:175]
    ds_read_b64_tr_b16 a[124:125], v219 offset:32
    ds_read_b64_tr_b16 a[126:127], v219 offset:4256
    v_mfma_f32_16x16x32_bf16 v[172:175], a[88:91], a[56:59], v[172:175]
    v_exp_f32_e64 v203, v159
    v_mfma_f32_16x16x32_bf16 v[172:175], a[92:95], a[60:63], v[172:175]
    v_cvt_pk_bf16_f32 v199, v202, v203
    s_waitcnt lgkmcnt(4)
    v_mfma_f32_16x16x32_bf16 v[0:3], a[96:99], v[176:179], v[0:3]
    v_exp_f32_e64 v200, v128
    v_mfma_f32_16x16x32_bf16 v[32:35], a[96:99], v[180:183], v[32:35]
    s_barrier
    v_mfma_f32_16x16x32_bf16 v[4:7], a[100:103], v[176:179], v[4:7]
    v_exp_f32_e64 v201, v129
    v_mfma_f32_16x16x32_bf16 v[36:39], a[100:103], v[180:183], v[36:39]
    v_cvt_pk_bf16_f32 v184, v200, v201
    s_mov_b32 m0, s28
    v_mfma_f32_16x16x32_bf16 v[8:11], a[104:107], v[176:179], v[8:11]
    v_exp_f32_e64 v202, v130
    v_mfma_f32_16x16x32_bf16 v[40:43], a[104:107], v[180:183], v[40:43]
    s_cmp_eq_u32 s71, 0
    s_cbranch_scc0 K2_PFT
K2_PFRT:
    v_mfma_f32_16x16x32_bf16 v[12:15], a[108:111], v[176:179], v[12:15]
    v_exp_f32_e64 v203, v131
    v_mfma_f32_16x16x32_bf16 v[44:47], a[108:111], v[180:183], v[44:47]
    v_cvt_pk_bf16_f32 v185, v202, v203
    v_mfma_f32_16x16x32_bf16 v[16:19], a[112:115], v[176:179], v[16:19]
    v_exp_f32_e64 v200, v132
    v_mfma_f32_16x16x32_bf16 v[48:51], a[112:115], v[180:183], v[48:51]
    buffer_load_dwordx4 v220, s[8:11], s29 offen lds
    buffer_load_dwordx4 v221, s[8:11], s29 offen offset:1056 lds
    v_mfma_f32_16x16x32_bf16 v[20:23], a[116:119], v[176:179], v[20:23]
    v_exp_f32_e64 v201, v133
    v_mfma_f32_16x16x32_bf16 v[52:55], a[116:119], v[180:183], v[52:55]
    v_cvt_pk_bf16_f32 v186, v200, v201
    s_waitcnt lgkmcnt(0)
    v_mfma_f32_16x16x32_bf16 v[24:27], a[120:123], v[176:179], v[24:27]
    v_exp_f32_e64 v202, v134
    v_mfma_f32_16x16x32_bf16 v[56:59], a[120:123], v[180:183], v[56:59]
    s_add_u32 s29, s29, 8192
    s_add_u32 s37, s2, s24
    v_mfma_f32_16x16x32_bf16 v[28:31], a[124:127], v[176:179], v[28:31]
    v_exp_f32_e64 v203, v135
    v_mfma_f32_16x16x32_bf16 v[60:63], a[124:127], v[180:183], v[60:63]
    v_cvt_pk_bf16_f32 v187, v202, v203
    s_mul_i32 s38, s37, 65536
    v_mfma_f32_16x16x32_bf16 v[64:67], a[96:99], v[192:195], v[64:67]
    v_exp_f32_e64 v200, v136
    v_mfma_f32_16x16x32_bf16 v[96:99], a[96:99], v[196:199], v[96:99]
    ds_read_b64_tr_b16 a[96:97], v216 offset:8448
    ds_read_b64_tr_b16 a[98:99], v216 offset:12672
    v_mfma_f32_16x16x32_bf16 v[68:71], a[100:103], v[192:195], v[68:71]
    v_exp_f32_e64 v201, v137
    v_mfma_f32_16x16x32_bf16 v[100:103], a[100:103], v[196:199], v[100:103]
    ds_read_b64_tr_b16 a[100:101], v216 offset:8480
    ds_read_b64_tr_b16 a[102:103], v216 offset:12704
    v_cvt_pk_bf16_f32 v188, v200, v201
    s_lshl_b32 s39, s3, 14
    v_mfma_f32_16x16x32_bf16 v[72:75], a[104:107], v[192:195], v[72:75]
    v_exp_f32_e64 v202, v138
    v_mfma_f32_16x16x32_bf16 v[104:107], a[104:107], v[196:199], v[104:107]
    ds_read_b64_tr_b16 a[104:105], v217 offset:8448
    ds_read_b64_tr_b16 a[106:107], v217 offset:12672
    v_mfma_f32_16x16x32_bf16 v[76:79], a[108:111], v[192:195], v[76:79]
    v_exp_f32_e64 v203, v139
    v_mfma_f32_16x16x32_bf16 v[108:111], a[108:111], v[196:199], v[108:111]
    ds_read_b64_tr_b16 a[108:109], v217 offset:8480
    ds_read_b64_tr_b16 a[110:111], v217 offset:12704
    v_cvt_pk_bf16_f32 v189, v202, v203
    s_add_u32 s38, s38, s39
    v_mfma_f32_16x16x32_bf16 v[80:83], a[112:115], v[192:195], v[80:83]
    v_exp_f32_e64 v200, v140
    v_mfma_f32_16x16x32_bf16 v[112:115], a[112:115], v[196:199], v[112:115]
    ds_read_b64_tr_b16 a[112:113], v218 offset:8448
    ds_read_b64_tr_b16 a[114:115], v218 offset:12672
    v_mfma_f32_16x16x32_bf16 v[84:87], a[116:119], v[192:195], v[84:87]
    v_exp_f32_e64 v201, v141
    v_mfma_f32_16x16x32_bf16 v[116:119], a[116:119], v[196:199], v[116:119]
    ds_read_b64_tr_b16 a[116:117], v218 offset:8480
    ds_read_b64_tr_b16 a[118:119], v218 offset:12704
    v_cvt_pk_bf16_f32 v190, v200, v201
    v_add_u32 v236, s38, v222
    v_mfma_f32_16x16x32_bf16 v[88:91], a[120:123], v[192:195], v[88:91]
    v_exp_f32_e64 v202, v142
    v_mfma_f32_16x16x32_bf16 v[120:123], a[120:123], v[196:199], v[120:123]
    ds_read_b64_tr_b16 a[120:121], v219 offset:8448
    ds_read_b64_tr_b16 a[122:123], v219 offset:12672
    v_mfma_f32_16x16x32_bf16 v[92:95], a[124:127], v[192:195], v[92:95]
    v_exp_f32_e64 v203, v143
    v_mfma_f32_16x16x32_bf16 v[124:127], a[124:127], v[196:199], v[124:127]
    ds_read_b64_tr_b16 a[124:125], v219 offset:8480
    ds_read_b64_tr_b16 a[126:127], v219 offset:12704
    v_cvt_pk_bf16_f32 v191, v202, v203
    v_add_u32 v237, 8192, v236
    s_waitcnt lgkmcnt(8)
    v_mfma_f32_16x16x32_bf16 v[0:3], a[96:99], v[184:187], v[0:3]
    v_exp_f32_e64 v200, v160
    v_mfma_f32_16x16x32_bf16 v[4:7], a[100:103], v[184:187], v[4:7]
    v_exp_f32_e64 v201, v161
    s_add_u32 m0, s28, 8448
    v_mfma_f32_16x16x32_bf16 v[8:11], a[104:107], v[184:187], v[8:11]
    v_cvt_pk_bf16_f32 v192, v200, v201
    v_exp_f32_e64 v202, v162
    v_mfma_f32_16x16x32_bf16 v[12:15], a[108:111], v[184:187], v[12:15]
    s_waitcnt lgkmcnt(0)
    v_exp_f32_e64 v203, v163
    v_mfma_f32_16x16x32_bf16 v[16:19], a[112:115], v[184:187], v[16:19]
    v_cvt_pk_bf16_f32 v193, v202, v203
    v_exp_f32_e64 v200, v164
    v_mfma_f32_16x16x32_bf16 v[20:23], a[116:119], v[184:187], v[20:23]
    v_exp_f32_e64 v201, v165
    v_mfma_f32_16x16x32_bf16 v[24:27], a[120:123], v[184:187], v[24:27]
    v_cvt_pk_bf16_f32 v194, v200, v201
    v_exp_f32_e64 v202, v166
    v_mfma_f32_16x16x32_bf16 v[28:31], a[124:127], v[184:187], v[28:31]
    v_exp_f32_e64 v203, v167
    v_mfma_f32_16x16x32_bf16 v[32:35], a[96:99], v[188:191], v[32:35]
    v_cvt_pk_bf16_f32 v195, v202, v203
    v_exp_f32_e64 v200, v168
    v_mfma_f32_16x16x32_bf16 v[36:39], a[100:103], v[188:191], v[36:39]
    v_exp_f32_e64 v201, v169
    v_mfma_f32_16x16x32_bf16 v[40:43], a[104:107], v[188:191], v[40:43]
    v_cvt_pk_bf16_f32 v196, v200, v201
    v_exp_f32_e64 v202, v170
    v_mfma_f32_16x16x32_bf16 v[44:47], a[108:111], v[188:191], v[44:47]
    v_exp_f32_e64 v203, v171
    v_mfma_f32_16x16x32_bf16 v[48:51], a[112:115], v[188:191], v[48:51]
    v_cvt_pk_bf16_f32 v197, v202, v203
    v_exp_f32_e64 v200, v172
    v_mfma_f32_16x16x32_bf16 v[52:55], a[116:119], v[188:191], v[52:55]
    v_exp_f32_e64 v201, v173
    v_mfma_f32_16x16x32_bf16 v[56:59], a[120:123], v[188:191], v[56:59]
    v_cvt_pk_bf16_f32 v198, v200, v201
    v_exp_f32_e64 v202, v174
    v_mfma_f32_16x16x32_bf16 v[60:63], a[124:127], v[188:191], v[60:63]
    v_exp_f32_e64 v203, v175
    v_mfma_f32_16x16x32_bf16 v[64:67], a[96:99], v[192:195], v[64:67]
    v_cvt_pk_bf16_f32 v199, v202, v203
    v_mfma_f32_16x16x32_bf16 v[68:71], a[100:103], v[192:195], v[68:71]
    buffer_load_dwordx4 v220, s[8:11], s29 offen lds
    buffer_load_dwordx4 v221, s[8:11], s29 offen offset:1056 lds
    v_cvt_pk_bf16_f32 v128, v0, v1
    v_cvt_pk_bf16_f32 v129, v2, v3
    v_cvt_pk_bf16_f32 v130, v4, v5
    v_mfma_f32_16x16x32_bf16 v[72:75], a[104:107], v[192:195], v[72:75]
    s_add_u32 s29, s29, 8192
    s_add_u32 s28, s28, 16896
    s_cmp_eq_u32 s28, s67
    s_cselect_b32 s28, s27, s28
    v_cvt_pk_bf16_f32 v131, v6, v7
    buffer_store_dwordx4 v[128:131], v236, s[16:19], 0 offen offset:0 sc1
    v_cvt_pk_bf16_f32 v132, v8, v9
    v_mfma_f32_16x16x32_bf16 v[76:79], a[108:111], v[192:195], v[76:79]
    s_cmp_eq_u32 s29, 2572288
    s_cselect_b32 s29, 0, s29
    v_cvt_pk_bf16_f32 v133, v10, v11
    v_cvt_pk_bf16_f32 v134, v12, v13
    v_cvt_pk_bf16_f32 v135, v14, v15
    v_mfma_f32_16x16x32_bf16 v[80:83], a[112:115], v[192:195], v[80:83]
    s_mov_b32 s30, s31
    s_add_u32 s31, s31, 16896
    s_cmp_eq_u32 s31, 80128
    s_cselect_b32 s31, 12544, s31
    buffer_store_dwordx4 v[132:135], v236, s[16:19], 0 offen offset:1024 sc1
    v_cvt_pk_bf16_f32 v136, v16, v17
    v_mfma_f32_16x16x32_bf16 v[84:87], a[116:119], v[192:195], v[84:87]
    v_cvt_pk_bf16_f32 v137, v18, v19
    v_cvt_pk_bf16_f32 v138, v20, v21
    v_cvt_pk_bf16_f32 v139, v22, v23
    v_mfma_f32_16x16x32_bf16 v[88:91], a[120:123], v[192:195], v[88:91]
    buffer_store_dwordx4 v[136:139], v236, s[16:19], 0 offen offset:2048 sc1
    v_cvt_pk_bf16_f32 v140, v24, v25
    v_cvt_pk_bf16_f32 v141, v26, v27
    v_mfma_f32_16x16x32_bf16 v[92:95], a[124:127], v[192:195], v[92:95]
    v_cvt_pk_bf16_f32 v142, v28, v29
    v_cvt_pk_bf16_f32 v143, v30, v31
    buffer_store_dwordx4 v[140:143], v236, s[16:19], 0 offen offset:3072 sc1
    v_mfma_f32_16x16x32_bf16 v[96:99], a[96:99], v[196:199], v[96:99]
    v_cvt_pk_bf16_f32 v128, v32, v33
    v_cvt_pk_bf16_f32 v129, v34, v35
    v_mfma_f32_16x16x32_bf16 v[100:103], a[100:103], v[196:199], v[100:103]
    v_cvt_pk_bf16_f32 v130, v36, v37
    v_cvt_pk_bf16_f32 v131, v38, v39
    v_add_u32 v236, 4096, v236
    v_mfma_f32_16x16x32_bf16 v[104:107], a[104:107], v[196:199], v[104:107]
    buffer_store_dwordx4 v[128:131], v236, s[16:19], 0 offen offset:0 sc1
    v_cvt_pk_bf16_f32 v132, v40, v41
    v_cvt_pk_bf16_f32 v133, v42, v43
    v_mfma_f32_16x16x32_bf16 v[108:111], a[108:111], v[196:199], v[108:111]
    v_cvt_pk_bf16_f32 v134, v44, v45
    v_cvt_pk_bf16_f32 v135, v46, v47
    buffer_store_dwordx4 v[132:135], v236, s[16:19], 0 offen offset:1024 sc1
    v_mfma_f32_16x16x32_bf16 v[112:115], a[112:115], v[196:199], v[112:115]
    v_cvt_pk_bf16_f32 v136, v48, v49
    v_cvt_pk_bf16_f32 v137, v50, v51
    v_mfma_f32_16x16x32_bf16 v[116:119], a[116:119], v[196:199], v[116:119]
    v_cvt_pk_bf16_f32 v138, v52, v53
    v_cvt_pk_bf16_f32 v139, v54, v55
    buffer_store_dwordx4 v[136:139], v236, s[16:19], 0 offen offset:2048 sc1
    v_mfma_f32_16x16x32_bf16 v[120:123], a[120:123], v[196:199], v[120:123]
    v_cvt_pk_bf16_f32 v140, v56, v57
    v_cvt_pk_bf16_f32 v141, v58, v59
    v_cvt_pk_bf16_f32 v142, v60, v61
    v_mfma_f32_16x16x32_bf16 v[124:127], a[124:127], v[196:199], v[124:127]
    v_cvt_pk_bf16_f32 v143, v62, v63
    buffer_store_dwordx4 v[140:143], v236, s[16:19], 0 offen offset:3072 sc1
    s_mov_b32 s36, 0x71800000
    s_nop 5
    v_add_f32 v227, v31, v63
    v_add_f32 v228, v95, v127
    v_add_f32 v227, v227, v228
    v_cmp_ngt_f32 vcc, s36, v227
    s_nop 1
    s_and_b32 s38, vcc_hi, s35
    s_cbranch_scc1 K2_SLOW
K2_STORE:
    v_cvt_pk_bf16_f32 v128, v64, v65
    v_cvt_pk_bf16_f32 v129, v66, v67
    v_cvt_pk_bf16_f32 v130, v68, v69
    v_cvt_pk_bf16_f32 v131, v70, v71
    buffer_store_dwordx4 v[128:131], v237, s[16:19], 0 offen offset:0 sc1
    v_cvt_pk_bf16_f32 v132, v72, v73
    v_cvt_pk_bf16_f32 v133, v74, v75
    v_cvt_pk_bf16_f32 v134, v76, v77
    v_cvt_pk_bf16_f32 v135, v78, v79
    buffer_store_dwordx4 v[132:135], v237, s[16:19], 0 offen offset:1024 sc1
    v_cvt_pk_bf16_f32 v136, v80, v81
    v_cvt_pk_bf16_f32 v137, v82, v83
    v_cvt_pk_bf16_f32 v138, v84, v85
    v_cvt_pk_bf16_f32 v139, v86, v87
    buffer_store_dwordx4 v[136:139], v237, s[16:19], 0 offen offset:2048 sc1
    v_cvt_pk_bf16_f32 v140, v88, v89
    v_cvt_pk_bf16_f32 v141, v90, v91
    v_cvt_pk_bf16_f32 v142, v92, v93
    v_cvt_pk_bf16_f32 v143, v94, v95
    buffer_store_dwordx4 v[140:143], v237, s[16:19], 0 offen offset:3072 sc1
    v_cvt_pk_bf16_f32 v128, v96, v97
    v_cvt_pk_bf16_f32 v129, v98, v99
    v_cvt_pk_bf16_f32 v130, v100, v101
    v_cvt_pk_bf16_f32 v131, v102, v103
    v_add_u32 v237, 4096, v237
    buffer_store_dwordx4 v[128:131], v237, s[16:19], 0 offen offset:0 sc1
    v_cvt_pk_bf16_f32 v132, v104, v105
    v_cvt_pk_bf16_f32 v133, v106, v107
    v_cvt_pk_bf16_f32 v134, v108, v109
    v_cvt_pk_bf16_f32 v135, v110, v111
    buffer_store_dwordx4 v[132:135], v237, s[16:19], 0 offen offset:1024 sc1
    v_cvt_pk_bf16_f32 v136, v112, v113
    v_cvt_pk_bf16_f32 v137, v114, v115
    v_cvt_pk_bf16_f32 v138, v116, v117
    v_cvt_pk_bf16_f32 v139, v118, v119
    buffer_store_dwordx4 v[136:139], v237, s[16:19], 0 offen offset:2048 sc1
    v_cvt_pk_bf16_f32 v140, v120, v121
    v_cvt_pk_bf16_f32 v141, v122, v123
    v_cvt_pk_bf16_f32 v142, v124, v125
    v_cvt_pk_bf16_f32 v143, v126, v127
    buffer_store_dwordx4 v[140:143], v237, s[16:19], 0 offen offset:3072 sc1
    v_sub_f32 v192, 0, v240
    v_mov_b32 v193, v31
    v_sub_f32 v194, 0, v241
    v_mov_b32 v195, v63
    v_sub_f32 v196, 0, v242
    v_mov_b32 v197, v95
    v_sub_f32 v198, 0, v243
    v_mov_b32 v199, v127
    s_cmp_eq_u32 s26, 0
    s_cbranch_scc1 K2_DONE
    v_accvgpr_write_b32 a248, v192
    v_accvgpr_write_b32 a249, v193
    v_accvgpr_write_b32 a250, v194
    v_accvgpr_write_b32 a251, v195
    v_accvgpr_write_b32 a252, v196
    v_accvgpr_write_b32 a253, v197
    v_accvgpr_write_b32 a254, v198
    v_accvgpr_write_b32 a255, v199
    v_mov_b32 v0, 0
    v_mov_b32 v1, 0
    v_mov_b32 v2, 0
    v_mov_b32 v3, 0
    v_mov_b32 v4, 0
    v_mov_b32 v5, 0
    v_mov_b32 v6, 0
    v_mov_b32 v7, 0
    v_mov_b32 v8, 0
    v_mov_b32 v9, 0
    v_mov_b32 v10, 0
    v_mov_b32 v11, 0
    v_mov_b32 v12, 0
    v_mov_b32 v13, 0
    v_mov_b32 v14, 0
    v_mov_b32 v15, 0
    v_mov_b32 v16, 0
    v_mov_b32 v17, 0
    v_mov_b32 v18, 0
    v_mov_b32 v19, 0
    v_mov_b32 v20, 0
    v_mov_b32 v21, 0
    v_mov_b32 v22, 0
    v_mov_b32 v23, 0
    v_mov_b32 v24, 0
    v_mov_b32 v25, 0
    v_mov_b32 v26, 0
    v_mov_b32 v27, 0
    v_mov_b32 v28, 0
    v_mov_b32 v29, 0
    v_mov_b32 v30, 0
    v_mov_b32 v31, 0
    v_mov_b32 v32, 0
    v_mov_b32 v33, 0
    v_mov_b32 v34, 0
    v_mov_b32 v35, 0
    v_mov_b32 v36, 0
    v_mov_b32 v37, 0
    v_mov_b32 v38, 0
    v_mov_b32 v39, 0
    v_mov_b32 v40, 0
    v_mov_b32 v41, 0
    v_mov_b32 v42, 0
    v_mov_b32 v43, 0
    v_mov_b32 v44, 0
    v_mov_b32 v45, 0
    v_mov_b32 v46, 0
    v_mov_b32 v47, 0
    v_mov_b32 v48, 0
    v_mov_b32 v49, 0
    v_mov_b32 v50, 0
    v_mov_b32 v51, 0
    v_mov_b32 v52, 0
    v_mov_b32 v53, 0
    v_mov_b32 v54, 0
    v_mov_b32 v55, 0
    v_mov_b32 v56, 0
    v_mov_b32 v57, 0
    v_mov_b32 v58, 0
    v_mov_b32 v59, 0
    v_mov_b32 v60, 0
    v_mov_b32 v61, 0
    v_mov_b32 v62, 0
    v_mov_b32 v63, 0
    v_mov_b32 v64, 0
    v_mov_b32 v65, 0
    v_mov_b32 v66, 0
    v_mov_b32 v67, 0
    v_mov_b32 v68, 0
    v_mov_b32 v69, 0
    v_mov_b32 v70, 0
    v_mov_b32 v71, 0
    v_mov_b32 v72, 0
    v_mov_b32 v73, 0
    v_mov_b32 v74, 0
    v_mov_b32 v75, 0
    v_mov_b32 v76, 0
    v_mov_b32 v77, 0
    v_mov_b32 v78, 0
    v_mov_b32 v79, 0
    v_mov_b32 v80, 0
    v_mov_b32 v81, 0
    v_mov_b32 v82, 0
    v_mov_b32 v83, 0
    v_mov_b32 v84, 0
    v_mov_b32 v85, 0
    v_mov_b32 v86, 0
    v_mov_b32 v87, 0
    v_mov_b32 v88, 0
    v_mov_b32 v89, 0
    v_mov_b32 v90, 0
    v_mov_b32 v91, 0
    v_mov_b32 v92, 0
    v_mov_b32 v93, 0
    v_mov_b32 v94, 0
    v_mov_b32 v95, 0
    v_mov_b32 v96, 0
    v_mov_b32 v97, 0
    v_mov_b32 v98, 0
    v_mov_b32 v99, 0
    v_mov_b32 v100, 0
    v_mov_b32 v101, 0
    v_mov_b32 v102, 0
    v_mov_b32 v103, 0
    v_mov_b32 v104, 0
    v_mov_b32 v105, 0
    v_mov_b32 v106, 0
    v_mov_b32 v107, 0
    v_mov_b32 v108, 0
    v_mov_b32 v109, 0
    v_mov_b32 v110, 0
    v_mov_b32 v111, 0
    v_mov_b32 v112, 0
    v_mov_b32 v113, 0
    v_mov_b32 v114, 0
    v_mov_b32 v115, 0
    v_mov_b32 v116, 0
    v_mov_b32 v117, 0
    v_mov_b32 v118, 0
    v_mov_b32 v119, 0
    v_mov_b32 v120, 0
    v_mov_b32 v121, 0
    v_mov_b32 v122, 0
    v_mov_b32 v123, 0
    v_mov_b32 v124, 0
    v_mov_b32 v125, 0
    v_mov_b32 v126, 0
    v_mov_b32 v127, 0
    s_waitcnt vmcnt(16)
    v_accvgpr_mov_b32 a0, a128
    v_accvgpr_mov_b32 a1, a129
    v_accvgpr_mov_b32 a2, a130
    v_accvgpr_mov_b32 a3, a131
    v_accvgpr_mov_b32 a4, a132
    v_accvgpr_mov_b32 a5, a133
    v_accvgpr_mov_b32 a6, a134
    v_accvgpr_mov_b32 a7, a135
    v_accvgpr_mov_b32 a8, a136
    v_accvgpr_mov_b32 a9, a137
    v_accvgpr_mov_b32 a10, a138
    v_accvgpr_mov_b32 a11, a139
    v_accvgpr_mov_b32 a12, a140
    v_accvgpr_mov_b32 a13, a141
    v_accvgpr_mov_b32 a14, a142
    v_accvgpr_mov_b32 a15, a143
    v_accvgpr_mov_b32 a16, a144
    v_accvgpr_mov_b32 a17, a145
    v_accvgpr_mov_b32 a18, a146
    v_accvgpr_mov_b32 a19, a147
    v_accvgpr_mov_b32 a20, a148
    v_accvgpr_mov_b32 a21, a149
    v_accvgpr_mov_b32 a22, a150
    v_accvgpr_mov_b32 a23, a151
    v_accvgpr_mov_b32 a24, a152
    v_accvgpr_mov_b32 a25, a153
    v_accvgpr_mov_b32 a26, a154
    v_accvgpr_mov_b32 a27, a155
    v_accvgpr_mov_b32 a28, a156
    v_accvgpr_mov_b32 a29, a157
    v_accvgpr_mov_b32 a30, a158
    v_accvgpr_mov_b32 a31, a159
    v_accvgpr_mov_b32 a32, a160
    v_accvgpr_mov_b32 a33, a161
    v_accvgpr_mov_b32 a34, a162
    v_accvgpr_mov_b32 a35, a163
    v_accvgpr_mov_b32 a36, a164
    v_accvgpr_mov_b32 a37, a165
    v_accvgpr_mov_b32 a38, a166
    v_accvgpr_mov_b32 a39, a167
    v_accvgpr_mov_b32 a40, a168
    v_accvgpr_mov_b32 a41, a169
    v_accvgpr_mov_b32 a42, a170
    v_accvgpr_mov_b32 a43, a171
    v_accvgpr_mov_b32 a44, a172
    v_accvgpr_mov_b32 a45, a173
    v_accvgpr_mov_b32 a46, a174
    v_accvgpr_mov_b32 a47, a175
    v_accvgpr_mov_b32 a48, a176
    v_accvgpr_mov_b32 a49, a177
    v_accvgpr_mov_b32 a50, a178
    v_accvgpr_mov_b32 a51, a179
    v_accvgpr_mov_b32 a52, a180
    v_accvgpr_mov_b32 a53, a181
    v_accvgpr_mov_b32 a54, a182
    v_accvgpr_mov_b32 a55, a183
    v_accvgpr_mov_b32 a56, a184
    v_accvgpr_mov_b32 a57, a185
    v_accvgpr_mov_b32 a58, a186
    v_accvgpr_mov_b32 a59, a187
    v_accvgpr_mov_b32 a60, a188
    v_accvgpr_mov_b32 a61, a189
    v_accvgpr_mov_b32 a62, a190
    v_accvgpr_mov_b32 a63, a191
    s_add_u32 s24, s24, 1
    s_mov_b32 s25, s26
    s_mov_b32 s26, 0
    s_mov_b32 s33, 0
    s_branch K2_SEG
K2_SLOW:
    s_waitcnt vmcnt(0)
    s_add_u32 s12, s4, 0x278000
    s_addc_u32 s13, s5, 0
    s_mov_b32 s14, 0x274000
    s_mov_b32 s15, 0x00020000
    s_lshl_b32 s37, s24, 16
    s_lshl_b32 s38, s3, 14
    s_add_u32 s37, s37, s38
    v_add_u32 v224, s37, v222
    buffer_load_dwordx4 a[0:3], v224, s[12:15], 0 offen offset:0
    buffer_load_dwordx4 a[4:7], v224, s[12:15], 0 offen offset:1024
    buffer_load_dwordx4 a[8:11], v224, s[12:15], 0 offen offset:2048
    buffer_load_dwordx4 a[12:15], v224, s[12:15], 0 offen offset:3072
    v_add_u32 v224, 4096, v224
    buffer_load_dwordx4 a[16:19], v224, s[12:15], 0 offen offset:0
    buffer_load_dwordx4 a[20:23], v224, s[12:15], 0 offen offset:1024
    buffer_load_dwordx4 a[24:27], v224, s[12:15], 0 offen offset:2048
    buffer_load_dwordx4 a[28:31], v224, s[12:15], 0 offen offset:3072
    v_add_u32 v224, 4096, v224
    buffer_load_dwordx4 a[32:35], v224, s[12:15], 0 offen offset:0
    buffer_load_dwordx4 a[36:39], v224, s[12:15], 0 offen offset:1024
    buffer_load_dwordx4 a[40:43], v224, s[12:15], 0 offen offset:2048
    buffer_load_dwordx4 a[44:47], v224, s[12:15], 0 offen offset:3072
    v_add_u32 v224, 4096, v224
    buffer_load_dwordx4 a[48:51], v224, s[12:15], 0 offen offset:0
    buffer_load_dwordx4 a[52:55], v224, s[12:15], 0 offen offset:1024
    buffer_load_dwordx4 a[56:59], v224, s[12:15], 0 offen offset:2048
    buffer_load_dwordx4 a[60:63], v224, s[12:15], 0 offen offset:3072
    v_mov_b32 v0, 0
    v_mov_b32 v1, 0
    v_mov_b32 v2, 0
    v_mov_b32 v3, 0
    v_mov_b32 v4, 0
    v_mov_b32 v5, 0
    v_mov_b32 v6, 0
    v_mov_b32 v7, 0
    v_mov_b32 v8, 0
    v_mov_b32 v9, 0
    v_mov_b32 v10, 0
    v_mov_b32 v11, 0
    v_mov_b32 v12, 0
    v_mov_b32 v13, 0
    v_mov_b32 v14, 0
    v_mov_b32 v15, 0
    v_mov_b32 v16, 0
    v_mov_b32 v17, 0
    v_mov_b32 v18, 0
    v_mov_b32 v19, 0
    v_mov_b32 v20, 0
    v_mov_b32 v21, 0
    v_mov_b32 v22, 0
    v_mov_b32 v23, 0
    v_mov_b32 v24, 0
    v_mov_b32 v25, 0
    v_mov_b32 v26, 0
    v_mov_b32 v27, 0
    v_mov_b32 v28, 0
    v_mov_b32 v29, 0
    v_mov_b32 v30, 0
    v_mov_b32 v31, 0
    v_mov_b32 v32, 0
    v_mov_b32 v33, 0
    v_mov_b32 v34, 0
    v_mov_b32 v35, 0
    v_mov_b32 v36, 0
    v_mov_b32 v37, 0
    v_mov_b32 v38, 0
    v_mov_b32 v39, 0
    v_mov_b32 v40, 0
    v_mov_b32 v41, 0
    v_mov_b32 v42, 0
    v_mov_b32 v43, 0
    v_mov_b32 v44, 0
    v_mov_b32 v45, 0
    v_mov_b32 v46, 0
    v_mov_b32 v47, 0
    v_mov_b32 v48, 0
    v_mov_b32 v49, 0
    v_mov_b32 v50, 0
    v_mov_b32 v51, 0
    v_mov_b32 v52, 0
    v_mov_b32 v53, 0
    v_mov_b32 v54, 0
    v_mov_b32 v55, 0
    v_mov_b32 v56, 0
    v_mov_b32 v57, 0
    v_mov_b32 v58, 0
    v_mov_b32 v59, 0
    v_mov_b32 v60, 0
    v_mov_b32 v61, 0
    v_mov_b32 v62, 0
    v_mov_b32 v63, 0
    v_mov_b32 v64, 0
    v_mov_b32 v65, 0
    v_mov_b32 v66, 0
    v_mov_b32 v67, 0
    v_mov_b32 v68, 0
    v_mov_b32 v69, 0
    v_mov_b32 v70, 0
    v_mov_b32 v71, 0
    v_mov_b32 v72, 0
    v_mov_b32 v73, 0
    v_mov_b32 v74, 0
    v_mov_b32 v75, 0
    v_mov_b32 v76, 0
    v_mov_b32 v77, 0
    v_mov_b32 v78, 0
    v_mov_b32 v79, 0
    v_mov_b32 v80, 0
    v_mov_b32 v81, 0
    v_mov_b32 v82, 0
    v_mov_b32 v83, 0
    v_mov_b32 v84, 0
    v_mov_b32 v85, 0
    v_mov_b32 v86, 0
    v_mov_b32 v87, 0
    v_mov_b32 v88, 0
    v_mov_b32 v89, 0
    v_mov_b32 v90, 0
    v_mov_b32 v91, 0
    v_mov_b32 v92, 0
    v_mov_b32 v93, 0
    v_mov_b32 v94, 0
    v_mov_b32 v95, 0
    v_mov_b32 v96, 0
    v_mov_b32 v97, 0
    v_mov_b32 v98, 0
    v_mov_b32 v99, 0
    v_mov_b32 v100, 0
    v_mov_b32 v101, 0
    v_mov_b32 v102, 0
    v_mov_b32 v103, 0
    v_mov_b32 v104, 0
    v_mov_b32 v105, 0
    v_mov_b32 v106, 0
    v_mov_b32 v107, 0
    v_mov_b32 v108, 0
    v_mov_b32 v109, 0
    v_mov_b32 v110, 0
    v_mov_b32 v111, 0
    v_mov_b32 v112, 0
    v_mov_b32 v113, 0
    v_mov_b32 v114, 0
    v_mov_b32 v115, 0
    v_mov_b32 v116, 0
    v_mov_b32 v117, 0
    v_mov_b32 v118, 0
    v_mov_b32 v119, 0
    v_mov_b32 v120, 0
    v_mov_b32 v121, 0
    v_mov_b32 v122, 0
    v_mov_b32 v123, 0
    v_mov_b32 v124, 0
    v_mov_b32 v125, 0
    v_mov_b32 v126, 0
    v_mov_b32 v127, 0
    s_waitcnt vmcnt(0)
    v_accvgpr_read_b32 v235, a15
    v_and_b32 v236, 0xffff, v235
    v_or_b32 v236, v236, v240
    v_cndmask_b32 v235, v235, v236, s[34:35]
    v_accvgpr_write_b32 a15, v235
    v_mov_b32 v160, 0xff800000
    v_accvgpr_read_b32 v235, a31
    v_and_b32 v236, 0xffff, v235
    v_or_b32 v236, v236, v241
    v_cndmask_b32 v235, v235, v236, s[34:35]
    v_accvgpr_write_b32 a31, v235
    v_mov_b32 v161, 0xff800000
    v_accvgpr_read_b32 v235, a47
    v_and_b32 v236, 0xffff, v235
    v_or_b32 v236, v236, v242
    v_cndmask_b32 v235, v235, v236, s[34:35]
    v_accvgpr_write_b32 a47, v235
    v_mov_b32 v162, 0xff800000
    v_accvgpr_read_b32 v235, a63
    v_and_b32 v236, 0xffff, v235
    v_or_b32 v236, v236, v243
    v_cndmask_b32 v235, v235, v236, s[34:35]
    v_accvgpr_write_b32 a63, v235
    v_mov_b32 v163, 0xff800000
    s_mul_i32 s42, s3, 8448
    s_add_u32 s42, s42, 125184
    v_add_u32 v212, s42, v204
    v_add_u32 v216, s42, v208
    v_add_u32 v213, s42, v205
    v_add_u32 v217, s42, v209
    v_add_u32 v214, s42, v206
    v_add_u32 v218, s42, v210
    v_add_u32 v215, s42, v207
    v_add_u32 v219, s42, v211
    s_lshl_b32 s36, s3, 11
    v_subrev_u32 v227, s36, v220
    s_lshl_b32 s40, s33, 14
    s_lshl_b32 s41, s25, 14
    s_add_u32 s41, s41, s40
K2_SLOW_LOOP:
    s_mov_b32 m0, s42
    s_nop 0
    buffer_load_dwordx4 v227, s[8:11], s40 offen lds
    s_add_u32 m0, m0, 1056
    s_add_u32 s40, s40, 1024
    s_nop 0
    buffer_load_dwordx4 v227, s[8:11], s40 offen lds
    s_add_u32 m0, m0, 1056
    s_add_u32 s40, s40, 1024
    s_nop 0
    buffer_load_dwordx4 v227, s[8:11], s40 offen lds
    s_add_u32 m0, m0, 1056
    s_add_u32 s40, s40, 1024
    s_nop 0
    buffer_load_dwordx4 v227, s[8:11], s40 offen lds
    s_add_u32 m0, m0, 1056
    s_add_u32 s40, s40, 1024
    s_nop 0
    buffer_load_dwordx4 v227, s[8:11], s40 offen lds
    s_add_u32 m0, m0, 1056
    s_add_u32 s40, s40, 1024
    s_nop 0
    buffer_load_dwordx4 v227, s[8:11], s40 offen lds
    s_add_u32 m0, m0, 1056
    s_add_u32 s40, s40, 1024
    s_nop 0
    buffer_load_dwordx4 v227, s[8:11], s40 offen lds
    s_add_u32 m0, m0, 1056
    s_add_u32 s40, s40, 1024
    s_nop 0
    buffer_load_dwordx4 v227, s[8:11], s40 offen lds
    s_add_u32 m0, m0, 1056
    s_add_u32 s40, s40, 1024
    s_waitcnt vmcnt(0)
    ds_read_b128 a[64:67], v212 offset:0
    ds_read_b128 a[68:71], v213 offset:0
    ds_read_b128 a[72:75], v214 offset:0
    ds_read_b128 a[76:79], v215 offset:0
    ds_read_b128 a[80:83], v212 offset:4224
    ds_read_b128 a[84:87], v213 offset:4224
    ds_read_b128 a[88:91], v214 offset:4224
    ds_read_b128 a[92:95], v215 offset:4224
    s_waitcnt lgkmcnt(0)
    v_mfma_f32_16x16x32_bf16 v[128:131], a[64:67], a[0:3], 0
    v_mfma_f32_16x16x32_bf16 v[136:139], a[64:67], a[16:19], 0
    v_mfma_f32_16x16x32_bf16 v[128:131], a[68:71], a[4:7], v[128:131]
    v_mfma_f32_16x16x32_bf16 v[136:139], a[68:71], a[20:23], v[136:139]
    v_mfma_f32_16x16x32_bf16 v[128:131], a[72:75], a[8:11], v[128:131]
    v_mfma_f32_16x16x32_bf16 v[136:139], a[72:75], a[24:27], v[136:139]
    v_mfma_f32_16x16x32_bf16 v[128:131], a[76:79], a[12:15], v[128:131]
    v_mfma_f32_16x16x32_bf16 v[136:139], a[76:79], a[28:31], v[136:139]
    v_mfma_f32_16x16x32_bf16 v[132:135], a[80:83], a[0:3], 0
    v_mfma_f32_16x16x32_bf16 v[140:143], a[80:83], a[16:19], 0
    v_mfma_f32_16x16x32_bf16 v[132:135], a[84:87], a[4:7], v[132:135]
    v_mfma_f32_16x16x32_bf16 v[140:143], a[84:87], a[20:23], v[140:143]
    v_mfma_f32_16x16x32_bf16 v[132:135], a[88:91], a[8:11], v[132:135]
    v_mfma_f32_16x16x32_bf16 v[140:143], a[88:91], a[24:27], v[140:143]
    v_mfma_f32_16x16x32_bf16 v[132:135], a[92:95], a[12:15], v[132:135]
    v_mfma_f32_16x16x32_bf16 v[140:143], a[92:95], a[28:31], v[140:143]
    v_mfma_f32_16x16x32_bf16 v[144:147], a[64:67], a[32:35], 0
    v_mfma_f32_16x16x32_bf16 v[152:155], a[64:67], a[48:51], 0
    v_mfma_f32_16x16x32_bf16 v[144:147], a[68:71], a[36:39], v[144:147]
    v_mfma_f32_16x16x32_bf16 v[152:155], a[68:71], a[52:55], v[152:155]
    v_mfma_f32_16x16x32_bf16 v[144:147], a[72:75], a[40:43], v[144:147]
    v_mfma_f32_16x16x32_bf16 v[152:155], a[72:75], a[56:59], v[152:155]
    v_mfma_f32_16x16x32_bf16 v[144:147], a[76:79], a[44:47], v[144:147]
    v_mfma_f32_16x16x32_bf16 v[152:155], a[76:79], a[60:63], v[152:155]
    v_mfma_f32_16x16x32_bf16 v[148:151], a[80:83], a[32:35], 0
    v_mfma_f32_16x16x32_bf16 v[156:159], a[80:83], a[48:51], 0
    v_mfma_f32_16x16x32_bf16 v[148:151], a[84:87], a[36:39], v[148:151]
    v_mfma_f32_16x16x32_bf16 v[156:159], a[84:87], a[52:55], v[156:159]
    v_mfma_f32_16x16x32_bf16 v[148:151], a[88:91], a[40:43], v[148:151]
    v_mfma_f32_16x16x32_bf16 v[156:159], a[88:91], a[56:59], v[156:159]
    v_mfma_f32_16x16x32_bf16 v[148:151], a[92:95], a[44:47], v[148:151]
    v_mfma_f32_16x16x32_bf16 v[156:159], a[92:95], a[60:63], v[156:159]
    ds_read_b64_tr_b16 a[96:97], v216 offset:0
    ds_read_b64_tr_b16 a[98:99], v216 offset:4224
    ds_read_b64_tr_b16 a[100:101], v216 offset:32
    ds_read_b64_tr_b16 a[102:103], v216 offset:4256
    ds_read_b64_tr_b16 a[104:105], v217 offset:0
    ds_read_b64_tr_b16 a[106:107], v217 offset:4224
    ds_read_b64_tr_b16 a[108:109], v217 offset:32
    ds_read_b64_tr_b16 a[110:111], v217 offset:4256
    s_waitcnt lgkmcnt(0)
    ds_read_b64_tr_b16 a[112:113], v218 offset:0
    ds_read_b64_tr_b16 a[114:115], v218 offset:4224
    ds_read_b64_tr_b16 a[116:117], v218 offset:32
    ds_read_b64_tr_b16 a[118:119], v218 offset:4256
    ds_read_b64_tr_b16 a[120:121], v219 offset:0
    ds_read_b64_tr_b16 a[122:123], v219 offset:4224
    ds_read_b64_tr_b16 a[124:125], v219 offset:32
    ds_read_b64_tr_b16 a[126:127], v219 offset:4256
    s_waitcnt lgkmcnt(0)
    s_nop 7
    v_max3_f32 v168, v128, v129, v130
    v_max3_f32 v168, v168, v131, v132
    v_max3_f32 v168, v168, v133, v134
    v_max3_f32 v168, v168, v135, v160
    v_max3_f32 v169, v136, v137, v138
    v_max3_f32 v169, v169, v139, v140
    v_max3_f32 v169, v169, v141, v142
    v_max3_f32 v169, v169, v143, v161
    v_max3_f32 v170, v144, v145, v146
    v_max3_f32 v170, v170, v147, v148
    v_max3_f32 v170, v170, v149, v150
    v_max3_f32 v170, v170, v151, v162
    v_max3_f32 v171, v152, v153, v154
    v_max3_f32 v171, v171, v155, v156
    v_max3_f32 v171, v171, v157, v158
    v_max3_f32 v171, v171, v159, v163
    v_mov_b32 v172, v168
    v_mov_b32 v173, v169
    v_mov_b32 v174, v170
    v_mov_b32 v175, v171
    s_nop 1
    v_permlane32_swap_b32 v168, v172
    v_permlane32_swap_b32 v169, v173
    v_permlane32_swap_b32 v170, v174
    v_permlane32_swap_b32 v171, v175
    s_nop 1
    v_max_f32 v168, v168, v172
    v_max_f32 v169, v169, v173
    v_max_f32 v170, v170, v174
    v_max_f32 v171, v171, v175
    v_mov_b32 v172, v168
    v_mov_b32 v173, v169
    v_mov_b32 v174, v170
    v_mov_b32 v175, v171
    s_nop 1
    v_permlane16_swap_b32 v168, v172
    v_permlane16_swap_b32 v169, v173
    v_permlane16_swap_b32 v170, v174
    v_permlane16_swap_b32 v171, v175
    s_nop 1
    v_max_f32 v168, v168, v172
    v_max_f32 v169, v169, v173
    v_max_f32 v170, v170, v174
    v_max_f32 v171, v171, v175
    v_sub_f32 v164, v160, v168
    v_exp_f32 v164, v164
    v_mov_b32 v160, v168
    v_sub_f32 v128, v128, v168
    v_sub_f32 v129, v129, v168
    v_sub_f32 v130, v130, v168
    v_sub_f32 v131, v131, v168
    v_sub_f32 v132, v132, v168
    v_sub_f32 v133, v133, v168
    v_sub_f32 v134, v134, v168
    v_sub_f32 v135, v135, v168
    v_mul_f32 v0, v0, v164
    v_mul_f32 v1, v1, v164
    v_mul_f32 v2, v2, v164
    v_mul_f32 v3, v3, v164
    v_mul_f32 v4, v4, v164
    v_mul_f32 v5, v5, v164
    v_mul_f32 v6, v6, v164
    v_mul_f32 v7, v7, v164
    v_mul_f32 v8, v8, v164
    v_mul_f32 v9, v9, v164
    v_mul_f32 v10, v10, v164
    v_mul_f32 v11, v11, v164
    v_mul_f32 v12, v12, v164
    v_mul_f32 v13, v13, v164
    v_mul_f32 v14, v14, v164
    v_mul_f32 v15, v15, v164
    v_mul_f32 v16, v16, v164
    v_mul_f32 v17, v17, v164
    v_mul_f32 v18, v18, v164
    v_mul_f32 v19, v19, v164
    v_mul_f32 v20, v20, v164
    v_mul_f32 v21, v21, v164
    v_mul_f32 v22, v22, v164
    v_mul_f32 v23, v23, v164
    v_mul_f32 v24, v24, v164
    v_mul_f32 v25, v25, v164
    v_mul_f32 v26, v26, v164
    v_mul_f32 v27, v27, v164
    v_mul_f32 v28, v28, v164
    v_mul_f32 v29, v29, v164
    v_mul_f32 v30, v30, v164
    v_mul_f32 v31, v31, v164
    v_sub_f32 v165, v161, v169
    v_exp_f32 v165, v165
    v_mov_b32 v161, v169
    v_sub_f32 v136, v136, v169
    v_sub_f32 v137, v137, v169
    v_sub_f32 v138, v138, v169
    v_sub_f32 v139, v139, v169
    v_sub_f32 v140, v140, v169
    v_sub_f32 v141, v141, v169
    v_sub_f32 v142, v142, v169
    v_sub_f32 v143, v143, v169
    v_mul_f32 v32, v32, v165
    v_mul_f32 v33, v33, v165
    v_mul_f32 v34, v34, v165
    v_mul_f32 v35, v35, v165
    v_mul_f32 v36, v36, v165
    v_mul_f32 v37, v37, v165
    v_mul_f32 v38, v38, v165
    v_mul_f32 v39, v39, v165
    v_mul_f32 v40, v40, v165
    v_mul_f32 v41, v41, v165
    v_mul_f32 v42, v42, v165
    v_mul_f32 v43, v43, v165
    v_mul_f32 v44, v44, v165
    v_mul_f32 v45, v45, v165
    v_mul_f32 v46, v46, v165
    v_mul_f32 v47, v47, v165
    v_mul_f32 v48, v48, v165
    v_mul_f32 v49, v49, v165
    v_mul_f32 v50, v50, v165
    v_mul_f32 v51, v51, v165
    v_mul_f32 v52, v52, v165
    v_mul_f32 v53, v53, v165
    v_mul_f32 v54, v54, v165
    v_mul_f32 v55, v55, v165
    v_mul_f32 v56, v56, v165
    v_mul_f32 v57, v57, v165
    v_mul_f32 v58, v58, v165
    v_mul_f32 v59, v59, v165
    v_mul_f32 v60, v60, v165
    v_mul_f32 v61, v61, v165
    v_mul_f32 v62, v62, v165
    v_mul_f32 v63, v63, v165
    v_sub_f32 v166, v162, v170
    v_exp_f32 v166, v166
    v_mov_b32 v162, v170
    v_sub_f32 v144, v144, v170
    v_sub_f32 v145, v145, v170
    v_sub_f32 v146, v146, v170
    v_sub_f32 v147, v147, v170
    v_sub_f32 v148, v148, v170
    v_sub_f32 v149, v149, v170
    v_sub_f32 v150, v150, v170
    v_sub_f32 v151, v151, v170
    v_mul_f32 v64, v64, v166
    v_mul_f32 v65, v65, v166
    v_mul_f32 v66, v66, v166
    v_mul_f32 v67, v67, v166
    v_mul_f32 v68, v68, v166
    v_mul_f32 v69, v69, v166
    v_mul_f32 v70, v70, v166
    v_mul_f32 v71, v71, v166
    v_mul_f32 v72, v72, v166
    v_mul_f32 v73, v73, v166
    v_mul_f32 v74, v74, v166
    v_mul_f32 v75, v75, v166
    v_mul_f32 v76, v76, v166
    v_mul_f32 v77, v77, v166
    v_mul_f32 v78, v78, v166
    v_mul_f32 v79, v79, v166
    v_mul_f32 v80, v80, v166
    v_mul_f32 v81, v81, v166
    v_mul_f32 v82, v82, v166
    v_mul_f32 v83, v83, v166
    v_mul_f32 v84, v84, v166
    v_mul_f32 v85, v85, v166
    v_mul_f32 v86, v86, v166
    v_mul_f32 v87, v87, v166
    v_mul_f32 v88, v88, v166
    v_mul_f32 v89, v89, v166
    v_mul_f32 v90, v90, v166
    v_mul_f32 v91, v91, v166
    v_mul_f32 v92, v92, v166
    v_mul_f32 v93, v93, v166
    v_mul_f32 v94, v94, v166
    v_mul_f32 v95, v95, v166
    v_sub_f32 v167, v163, v171
    v_exp_f32 v167, v167
    v_mov_b32 v163, v171
    v_sub_f32 v152, v152, v171
    v_sub_f32 v153, v153, v171
    v_sub_f32 v154, v154, v171
    v_sub_f32 v155, v155, v171
    v_sub_f32 v156, v156, v171
    v_sub_f32 v157, v157, v171
    v_sub_f32 v158, v158, v171
    v_sub_f32 v159, v159, v171
    v_mul_f32 v96, v96, v167
    v_mul_f32 v97, v97, v167
    v_mul_f32 v98, v98, v167
    v_mul_f32 v99, v99, v167
    v_mul_f32 v100, v100, v167
    v_mul_f32 v101, v101, v167
    v_mul_f32 v102, v102, v167
    v_mul_f32 v103, v103, v167
    v_mul_f32 v104, v104, v167
    v_mul_f32 v105, v105, v167
    v_mul_f32 v106, v106, v167
    v_mul_f32 v107, v107, v167
    v_mul_f32 v108, v108, v167
    v_mul_f32 v109, v109, v167
    v_mul_f32 v110, v110, v167
    v_mul_f32 v111, v111, v167
    v_mul_f32 v112, v112, v167
    v_mul_f32 v113, v113, v167
    v_mul_f32 v114, v114, v167
    v_mul_f32 v115, v115, v167
    v_mul_f32 v116, v116, v167
    v_mul_f32 v117, v117, v167
    v_mul_f32 v118, v118, v167
    v_mul_f32 v119, v119, v167
    v_mul_f32 v120, v120, v167
    v_mul_f32 v121, v121, v167
    v_mul_f32 v122, v122, v167
    v_mul_f32 v123, v123, v167
    v_mul_f32 v124, v124, v167
    v_mul_f32 v125, v125, v167
    v_mul_f32 v126, v126, v167
    v_mul_f32 v127, v127, v167
    v_exp_f32_e64 v200, v128
    v_exp_f32_e64 v201, v129
    v_exp_f32_e64 v202, v130
    v_cvt_pk_bf16_f32 v176, v200, v201
    v_exp_f32_e64 v203, v131
    v_exp_f32_e64 v200, v132
    v_cvt_pk_bf16_f32 v177, v202, v203
    v_exp_f32_e64 v201, v133
    v_exp_f32_e64 v202, v134
    v_cvt_pk_bf16_f32 v178, v200, v201
    v_exp_f32_e64 v203, v135
    v_exp_f32_e64 v200, v136
    v_cvt_pk_bf16_f32 v179, v202, v203
    v_exp_f32_e64 v201, v137
    v_exp_f32_e64 v202, v138
    v_cvt_pk_bf16_f32 v180, v200, v201
    v_exp_f32_e64 v203, v139
    v_exp_f32_e64 v200, v140
    v_cvt_pk_bf16_f32 v181, v202, v203
    v_exp_f32_e64 v201, v141
    v_exp_f32_e64 v202, v142
    v_cvt_pk_bf16_f32 v182, v200, v201
    v_exp_f32_e64 v203, v143
    s_nop 0
    v_cvt_pk_bf16_f32 v183, v202, v203
    v_exp_f32_e64 v200, v144
    v_exp_f32_e64 v201, v145
    v_exp_f32_e64 v202, v146
    v_cvt_pk_bf16_f32 v192, v200, v201
    v_exp_f32_e64 v203, v147
    v_exp_f32_e64 v200, v148
    v_cvt_pk_bf16_f32 v193, v202, v203
    v_exp_f32_e64 v201, v149
    v_exp_f32_e64 v202, v150
    v_cvt_pk_bf16_f32 v194, v200, v201
    v_exp_f32_e64 v203, v151
    v_exp_f32_e64 v200, v152
    v_cvt_pk_bf16_f32 v195, v202, v203
    v_exp_f32_e64 v201, v153
    v_exp_f32_e64 v202, v154
    v_cvt_pk_bf16_f32 v196, v200, v201
    v_exp_f32_e64 v203, v155
    v_exp_f32_e64 v200, v156
    v_cvt_pk_bf16_f32 v197, v202, v203
    v_exp_f32_e64 v201, v157
    v_exp_f32_e64 v202, v158
    v_cvt_pk_bf16_f32 v198, v200, v201
    v_exp_f32_e64 v203, v159
    s_nop 0
    v_cvt_pk_bf16_f32 v199, v202, v203
    s_nop 1
    v_mfma_f32_16x16x32_bf16 v[0:3], a[96:99], v[176:179], v[0:3]
    v_mfma_f32_16x16x32_bf16 v[32:35], a[96:99], v[180:183], v[32:35]
    v_mfma_f32_16x16x32_bf16 v[4:7], a[100:103], v[176:179], v[4:7]
    v_mfma_f32_16x16x32_bf16 v[36:39], a[100:103], v[180:183], v[36:39]
    v_mfma_f32_16x16x32_bf16 v[8:11], a[104:107], v[176:179], v[8:11]
    v_mfma_f32_16x16x32_bf16 v[40:43], a[104:107], v[180:183], v[40:43]
    v_mfma_f32_16x16x32_bf16 v[12:15], a[108:111], v[176:179], v[12:15]
    v_mfma_f32_16x16x32_bf16 v[44:47], a[108:111], v[180:183], v[44:47]
    v_mfma_f32_16x16x32_bf16 v[16:19], a[112:115], v[176:179], v[16:19]
    v_mfma_f32_16x16x32_bf16 v[48:51], a[112:115], v[180:183], v[48:51]
    v_mfma_f32_16x16x32_bf16 v[20:23], a[116:119], v[176:179], v[20:23]
    v_mfma_f32_16x16x32_bf16 v[52:55], a[116:119], v[180:183], v[52:55]
    v_mfma_f32_16x16x32_bf16 v[24:27], a[120:123], v[176:179], v[24:27]
    v_mfma_f32_16x16x32_bf16 v[56:59], a[120:123], v[180:183], v[56:59]
    v_mfma_f32_16x16x32_bf16 v[28:31], a[124:127], v[176:179], v[28:31]
    v_mfma_f32_16x16x32_bf16 v[60:63], a[124:127], v[180:183], v[60:63]
    v_mfma_f32_16x16x32_bf16 v[64:67], a[96:99], v[192:195], v[64:67]
    v_mfma_f32_16x16x32_bf16 v[96:99], a[96:99], v[196:199], v[96:99]
    v_mfma_f32_16x16x32_bf16 v[68:71], a[100:103], v[192:195], v[68:71]
    v_mfma_f32_16x16x32_bf16 v[100:103], a[100:103], v[196:199], v[100:103]
    v_mfma_f32_16x16x32_bf16 v[72:75], a[104:107], v[192:195], v[72:75]
    v_mfma_f32_16x16x32_bf16 v[104:107], a[104:107], v[196:199], v[104:107]
    v_mfma_f32_16x16x32_bf16 v[76:79], a[108:111], v[192:195], v[76:79]
    v_mfma_f32_16x16x32_bf16 v[108:111], a[108:111], v[196:199], v[108:111]
    v_mfma_f32_16x16x32_bf16 v[80:83], a[112:115], v[192:195], v[80:83]
    v_mfma_f32_16x16x32_bf16 v[112:115], a[112:115], v[196:199], v[112:115]
    v_mfma_f32_16x16x32_bf16 v[84:87], a[116:119], v[192:195], v[84:87]
    v_mfma_f32_16x16x32_bf16 v[116:119], a[116:119], v[196:199], v[116:119]
    v_mfma_f32_16x16x32_bf16 v[88:91], a[120:123], v[192:195], v[88:91]
    v_mfma_f32_16x16x32_bf16 v[120:123], a[120:123], v[196:199], v[120:123]
    v_mfma_f32_16x16x32_bf16 v[92:95], a[124:127], v[192:195], v[92:95]
    v_mfma_f32_16x16x32_bf16 v[124:127], a[124:127], v[196:199], v[124:127]
    s_nop 15
    s_cmp_lt_u32 s40, s41
    s_cbranch_scc1 K2_SLOW_LOOP
    v_sub_f32 v240, v240, v160
    v_sub_f32 v241, v241, v161
    v_sub_f32 v242, v242, v162
    v_sub_f32 v243, v243, v163
    s_add_u32 s37, s2, s24
    s_mul_i32 s38, s37, 65536
    s_lshl_b32 s39, s3, 14
    s_add_u32 s38, s38, s39
    v_add_u32 v236, s38, v222
    v_add_u32 v237, 8192, v236
    v_cvt_pk_bf16_f32 v128, v0, v1
    v_cvt_pk_bf16_f32 v129, v2, v3
    v_cvt_pk_bf16_f32 v130, v4, v5
    v_cvt_pk_bf16_f32 v131, v6, v7
    buffer_store_dwordx4 v[128:131], v236, s[16:19], 0 offen offset:0 sc1
    v_cvt_pk_bf16_f32 v132, v8, v9
    v_cvt_pk_bf16_f32 v133, v10, v11
    v_cvt_pk_bf16_f32 v134, v12, v13
    v_cvt_pk_bf16_f32 v135, v14, v15
    buffer_store_dwordx4 v[132:135], v236, s[16:19], 0 offen offset:1024 sc1
    v_cvt_pk_bf16_f32 v136, v16, v17
    v_cvt_pk_bf16_f32 v137, v18, v19
    v_cvt_pk_bf16_f32 v138, v20, v21
    v_cvt_pk_bf16_f32 v139, v22, v23
    buffer_store_dwordx4 v[136:139], v236, s[16:19], 0 offen offset:2048 sc1
    v_cvt_pk_bf16_f32 v140, v24, v25
    v_cvt_pk_bf16_f32 v141, v26, v27
    v_cvt_pk_bf16_f32 v142, v28, v29
    v_cvt_pk_bf16_f32 v143, v30, v31
    buffer_store_dwordx4 v[140:143], v236, s[16:19], 0 offen offset:3072 sc1
    v_cvt_pk_bf16_f32 v128, v32, v33
    v_cvt_pk_bf16_f32 v129, v34, v35
    v_cvt_pk_bf16_f32 v130, v36, v37
    v_cvt_pk_bf16_f32 v131, v38, v39
    v_add_u32 v236, 4096, v236
    buffer_store_dwordx4 v[128:131], v236, s[16:19], 0 offen offset:0 sc1
    v_cvt_pk_bf16_f32 v132, v40, v41
    v_cvt_pk_bf16_f32 v133, v42, v43
    v_cvt_pk_bf16_f32 v134, v44, v45
    v_cvt_pk_bf16_f32 v135, v46, v47
    buffer_store_dwordx4 v[132:135], v236, s[16:19], 0 offen offset:1024 sc1
    v_cvt_pk_bf16_f32 v136, v48, v49
    v_cvt_pk_bf16_f32 v137, v50, v51
    v_cvt_pk_bf16_f32 v138, v52, v53
    v_cvt_pk_bf16_f32 v139, v54, v55
    buffer_store_dwordx4 v[136:139], v236, s[16:19], 0 offen offset:2048 sc1
    v_cvt_pk_bf16_f32 v140, v56, v57
    v_cvt_pk_bf16_f32 v141, v58, v59
    v_cvt_pk_bf16_f32 v142, v60, v61
    v_cvt_pk_bf16_f32 v143, v62, v63
    buffer_store_dwordx4 v[140:143], v236, s[16:19], 0 offen offset:3072 sc1
    s_branch K2_STORE
K2_PFN:
    s_mov_b32 s71, 0
    s_add_u32 s39, s24, 1
    s_cmp_eq_u32 s26, 0
    s_cbranch_scc0 K2_NOQN
    s_add_u32 s12, s4, 0x4f0000
    s_addc_u32 s13, s5, 0
    s_mov_b32 s14, 0x10000
    s_mov_b32 s15, 0x00020000
    s_mov_b32 s39, 0
K2_NOQN:
    s_lshl_b32 s37, s39, 16
    s_lshl_b32 s38, s3, 14
    s_add_u32 s37, s37, s38
    v_add_u32 v224, s37, v222
    buffer_load_dwordx4 a[128:131], v224, s[12:15], 0 offen offset:0
    buffer_load_dwordx4 a[132:135], v224, s[12:15], 0 offen offset:1024
    buffer_load_dwordx4 a[136:139], v224, s[12:15], 0 offen offset:2048
    buffer_load_dwordx4 a[140:143], v224, s[12:15], 0 offen offset:3072
    v_add_u32 v224, 4096, v224
    buffer_load_dwordx4 a[144:147], v224, s[12:15], 0 offen offset:0
    buffer_load_dwordx4 a[148:151], v224, s[12:15], 0 offen offset:1024
    buffer_load_dwordx4 a[152:155], v224, s[12:15], 0 offen offset:2048
    buffer_load_dwordx4 a[156:159], v224, s[12:15], 0 offen offset:3072
    v_add_u32 v224, 4096, v224
    buffer_load_dwordx4 a[160:163], v224, s[12:15], 0 offen offset:0
    buffer_load_dwordx4 a[164:167], v224, s[12:15], 0 offen offset:1024
    buffer_load_dwordx4 a[168:171], v224, s[12:15], 0 offen offset:2048
    buffer_load_dwordx4 a[172:175], v224, s[12:15], 0 offen offset:3072
    v_add_u32 v224, 4096, v224
    buffer_load_dwordx4 a[176:179], v224, s[12:15], 0 offen offset:0
    buffer_load_dwordx4 a[180:183], v224, s[12:15], 0 offen offset:1024
    buffer_load_dwordx4 a[184:187], v224, s[12:15], 0 offen offset:2048
    buffer_load_dwordx4 a[188:191], v224, s[12:15], 0 offen offset:3072
    s_branch K2_PFRN
K2_PFT:
    s_mov_b32 s71, 0
    s_add_u32 s39, s24, 1
    s_cmp_eq_u32 s26, 0
    s_cbranch_scc0 K2_NOQT
    s_add_u32 s12, s4, 0x4f0000
    s_addc_u32 s13, s5, 0
    s_mov_b32 s14, 0x10000
    s_mov_b32 s15, 0x00020000
    s_mov_b32 s39, 0
K2_NOQT:
    s_lshl_b32 s37, s39, 16
    s_lshl_b32 s38, s3, 14
    s_add_u32 s37, s37, s38
    v_add_u32 v224, s37, v222
    buffer_load_dwordx4 a[128:131], v224, s[12:15], 0 offen offset:0
    buffer_load_dwordx4 a[132:135], v224, s[12:15], 0 offen offset:1024
    buffer_load_dwordx4 a[136:139], v224, s[12:15], 0 offen offset:2048
    buffer_load_dwordx4 a[140:143], v224, s[12:15], 0 offen offset:3072
    v_add_u32 v224, 4096, v224
    buffer_load_dwordx4 a[144:147], v224, s[12:15], 0 offen offset:0
    buffer_load_dwordx4 a[148:151], v224, s[12:15], 0 offen offset:1024
    buffer_load_dwordx4 a[152:155], v224, s[12:15], 0 offen offset:2048
    buffer_load_dwordx4 a[156:159], v224, s[12:15], 0 offen offset:3072
    v_add_u32 v224, 4096, v224
    buffer_load_dwordx4 a[160:163], v224, s[12:15], 0 offen offset:0
    buffer_load_dwordx4 a[164:167], v224, s[12:15], 0 offen offset:1024
    buffer_load_dwordx4 a[168:171], v224, s[12:15], 0 offen offset:2048
    buffer_load_dwordx4 a[172:175], v224, s[12:15], 0 offen offset:3072
    v_add_u32 v224, 4096, v224
    buffer_load_dwordx4 a[176:179], v224, s[12:15], 0 offen offset:0
    buffer_load_dwordx4 a[180:183], v224, s[12:15], 0 offen offset:1024
    buffer_load_dwordx4 a[184:187], v224, s[12:15], 0 offen offset:2048
    buffer_load_dwordx4 a[188:191], v224, s[12:15], 0 offen offset:3072
    s_branch K2_PFRT
K2_DONE:
    s_add_u32 s37, s2, s24
    s_lshl_b32 s38, s37, 11
    s_lshl_b32 s39, s3, 9
    s_add_u32 s38, s38, s39
    s_sub_u32 s38, s38, 384
    v_lshrrev_b32 v202, 1, v222
    v_add_u32 v202, s38, v202
    v_subrev_u32 v203, 2048, v202
    s_mul_i32 s36, s3, 2560
    v_add_u32 v254, s36, v253
    v_mfma_f32_16x16x32_bf16 v[248:251], a[212:215], a[216:219], v[248:251]
    v_mfma_f32_16x16x32_bf16 v[248:251], a[212:215], a[220:223], v[248:251]
    v_mfma_f32_16x16x32_bf16 v[248:251], a[212:215], a[224:227], v[248:251]
    v_mfma_f32_16x16x32_bf16 v[248:251], a[212:215], a[228:231], v[248:251]
    s_nop 7
    v_mov_b32 v92, v248
    v_mov_b32 v93, v249
    v_mov_b32 v94, v250
    v_mov_b32 v95, v251
    v_subrev_u32 v255, 10240, v255
    ds_read_b128 v[56:59], v255 offset:1024
    ds_read_b128 v[60:63], v255 offset:2048
    ds_read_b128 v[64:67], v255 offset:3072
    ds_read_b128 v[68:71], v255 offset:4096
    ds_read_b128 v[72:75], v255 offset:5120
    ds_read_b128 v[76:79], v255 offset:6144
    ds_read_b128 v[80:83], v255 offset:7168
    ds_read_b128 v[84:87], v255 offset:8192
    ds_read_b128 v[88:91], v255 offset:9216
    s_mul_i32 s36, s3, 40
    v_lshrrev_b32 v237, 2, v222
    v_add_u32 v237, s36, v237
    ds_read_b32 v237, v237 offset:12288
    s_mov_b32 s60, s76
    s_mov_b32 s61, s77
    s_mov_b32 s62, 0x271000
    s_mov_b32 s63, 0x00020000
    v_lshrrev_b32 v236, 4, v222
    v_and_b32 v236, 15, v236
    v_lshrrev_b32 v235, 1, v253
    v_lshl_add_u32 v230, v236, 4, v235
    s_mul_i32 s36, s3, 5280
    s_add_u32 s36, s36, 125440
    v_add_u32 v230, s36, v230
    v_lshl_add_u32 v232, v236, 8, v235
    s_mul_i32 s36, s2, 10240
    s_lshl_b32 s37, s3, 6
    s_add_u32 s36, s36, s37
    v_cmp_gt_u32 vcc, 8, v236
    v_add_u32 v232, s36, v232
    v_add_u32 v233, 4096, v232
    v_add_u32 v234, 8192, v232
    v_mov_b32 v239, 0x7f000000
    v_cndmask_b32 v234, v239, v234, vcc
    v_mul_u32_u24 v238, 528, v236
    v_add_u32 v238, v238, v253
    v_add_u32 v238, 125184, v238
    v_mul_u32_u24 v224, 1639, v223
    v_lshrrev_b32 v224, 16, v224
    v_mul_u32_u24 v225, 40, v224
    v_sub_u32 v225, v223, v225
    s_mul_i32 s43, s2, 40
    v_add_u32 v226, s43, v225
    s_lshr_b32 s48, s43, 8
    s_add_u32 s45, s48, 0
    s_mul_i32 s46, s45, 2528
    s_add_u32 s47, s46, 31
    s_mul_hi_u32 s47, s47, 0xa5e9f7
    s_add_u32 s46, s46, 2527
    s_mul_hi_u32 s46, s46, 0xa5e9f7
    s_sub_u32 s49, s46, s47
    s_add_u32 s36, s47, s45
    s_add_u32 s45, s48, 1
    s_mul_i32 s46, s45, 2528
    s_add_u32 s47, s46, 31
    s_mul_hi_u32 s47, s47, 0xa5e9f7
    s_add_u32 s46, s46, 2527
    s_mul_hi_u32 s46, s46, 0xa5e9f7
    s_sub_u32 s50, s46, s47
    s_add_u32 s37, s47, s45
    v_lshrrev_b32 v235, 8, v226
    v_cmp_eq_u32 vcc, s48, v235
    v_mov_b32 v235, s37
    v_mov_b32 v231, s36
    v_cndmask_b32 v235, v235, v231, vcc
    v_mov_b32 v231, s50
    v_mov_b32 v236, s49
    v_cndmask_b32 v231, v231, v236, vcc
    v_cmp_eq_u32 s[56:57], 7, v231
    v_and_b32 v231, 255, v226
    v_lshlrev_b32 v228, 6, v225
    v_add_u32 v228, 150528, v228
    v_lshrrev_b32 v246, 4, v222
    v_add_u32 v247, s43, v246
    v_lshrrev_b32 v244, 8, v247
    v_cmp_eq_u32 vcc, s48, v244
    v_mov_b32 v244, s37
    v_mov_b32 v245, s36
    v_cndmask_b32 v244, v244, v245, vcc
    v_mov_b32 v245, s50
    v_mov_b32 v236, s49
    v_cndmask_b32 v245, v245, v236, vcc
    s_lshl_b32 s45, s3, 1
    v_cmp_gt_u32 s[54:55], 40, v246
    v_cmp_lt_u32 s[52:53], s45, v245
    v_add_u32 v244, s45, v244
    v_and_b32 v247, 255, v247
    v_lshlrev_b32 v247, 3, v247
    v_lshl_add_u32 v244, v244, 11, v247
    s_and_b64 s[52:53], s[52:53], s[54:55]
    v_add_u32 v245, 2048, v244
    v_cndmask_b32 v244, v239, v244, s[54:55]
    v_cndmask_b32 v245, v239, v245, s[52:53]
    s_lshl_b32 s45, s3, 4
    s_add_u32 s45, s45, 150528
    v_lshl_add_u32 v246, v246, 6, s45
    v_lshrrev_b32 v227, 4, v231
    v_lshlrev_b32 v227, 12, v227
    s_mov_b32 s45, 65536
    v_mad_u32_u24 v227, v235, s45, v227
    v_lshl_add_u32 v227, v224, 8, v227
    v_and_b32 v231, 15, v231
    v_lshl_add_u32 v227, v231, 4, v227
    v_mul_u32_u24 v229, 528, v225
    v_lshl_add_u32 v229, v224, 4, v229
    v_add_u32 v229, 125184, v229
    v_cmp_gt_u32 s[58:59], 6, v224
    v_cmp_gt_u32 s[12:13], 4, v224
    v_accvgpr_read_b32 v200, a208
    v_accvgpr_read_b32 v201, a209
    v_cndmask_b32 v227, v239, v227, s[58:59]
    v_accvgpr_read_b32 v8, a204
    v_accvgpr_read_b32 v9, a205
    v_accvgpr_read_b32 v10, a206
    v_accvgpr_read_b32 v11, a207
    v_or3_b32 v231, v8, v9, v10
    v_or_b32 v231, v231, v11
    v_mov_b32 v226, 12480
    v_mov_b32 v225, 1
    v_cmpx_ne_u32 vcc, 0, v231
    ds_write_b32 v226, v225
    s_mov_b64 exec, -1
    s_cmp_ge_u32 s2, 250
    s_cbranch_scc1 K2_SIG
    s_waitcnt lgkmcnt(0)
    s_barrier
    ds_read_b32 v231, v226
    v_cmp_lt_u32 s[40:41], 48, v237
    v_or_b32 v236, v200, v201
    s_waitcnt lgkmcnt(0)
    s_and_b32 s40, s40, 0x3ff
    s_cbranch_scc0 K2_NOEXT
    s_bitcmp1_b32 s40, 0
    s_cbranch_scc0 L_ext_17
    ds_read_b128 v[32:35], v254 offset:192
    s_waitcnt lgkmcnt(0)
    v_add_u32 v32, v32, v252
    buffer_load_dwordx4 v[96:99], v32, s[8:11], 0 offen
    v_add_u32 v33, v33, v252
    buffer_load_dwordx4 v[100:103], v33, s[8:11], 0 offen
    v_add_u32 v34, v34, v252
    buffer_load_dwordx4 v[104:107], v34, s[8:11], 0 offen
    v_add_u32 v35, v35, v252
    buffer_load_dwordx4 v[108:111], v35, s[8:11], 0 offen
    s_waitcnt vmcnt(0)
    v_mfma_f32_16x16x32_bf16 v[56:59], a[212:215], v[96:99], v[56:59]
    v_mfma_f32_16x16x32_bf16 v[56:59], a[212:215], v[100:103], v[56:59]
    v_mfma_f32_16x16x32_bf16 v[56:59], a[212:215], v[104:107], v[56:59]
    v_mfma_f32_16x16x32_bf16 v[56:59], a[212:215], v[108:111], v[56:59]
L_ext_17:
    s_bitcmp1_b32 s40, 1
    s_cbranch_scc0 L_ext_18
    ds_read_b128 v[32:35], v254 offset:448
    s_waitcnt lgkmcnt(0)
    v_add_u32 v32, v32, v252
    buffer_load_dwordx4 v[96:99], v32, s[8:11], 0 offen
    v_add_u32 v33, v33, v252
    buffer_load_dwordx4 v[100:103], v33, s[8:11], 0 offen
    v_add_u32 v34, v34, v252
    buffer_load_dwordx4 v[104:107], v34, s[8:11], 0 offen
    v_add_u32 v35, v35, v252
    buffer_load_dwordx4 v[108:111], v35, s[8:11], 0 offen
    s_waitcnt vmcnt(0)
    v_mfma_f32_16x16x32_bf16 v[60:63], a[212:215], v[96:99], v[60:63]
    v_mfma_f32_16x16x32_bf16 v[60:63], a[212:215], v[100:103], v[60:63]
    v_mfma_f32_16x16x32_bf16 v[60:63], a[212:215], v[104:107], v[60:63]
    v_mfma_f32_16x16x32_bf16 v[60:63], a[212:215], v[108:111], v[60:63]
L_ext_18:
    s_bitcmp1_b32 s40, 2
    s_cbranch_scc0 L_ext_19
    ds_read_b128 v[32:35], v254 offset:704
    s_waitcnt lgkmcnt(0)
    v_add_u32 v32, v32, v252
    buffer_load_dwordx4 v[96:99], v32, s[8:11], 0 offen
    v_add_u32 v33, v33, v252
    buffer_load_dwordx4 v[100:103], v33, s[8:11], 0 offen
    v_add_u32 v34, v34, v252
    buffer_load_dwordx4 v[104:107], v34, s[8:11], 0 offen
    v_add_u32 v35, v35, v252
    buffer_load_dwordx4 v[108:111], v35, s[8:11], 0 offen
    s_waitcnt vmcnt(0)
    v_mfma_f32_16x16x32_bf16 v[64:67], a[212:215], v[96:99], v[64:67]
    v_mfma_f32_16x16x32_bf16 v[64:67], a[212:215], v[100:103], v[64:67]
    v_mfma_f32_16x16x32_bf16 v[64:67], a[212:215], v[104:107], v[64:67]
    v_mfma_f32_16x16x32_bf16 v[64:67], a[212:215], v[108:111], v[64:67]
L_ext_19:
    s_bitcmp1_b32 s40, 3
    s_cbranch_scc0 L_ext_20
    ds_read_b128 v[32:35], v254 offset:960
    s_waitcnt lgkmcnt(0)
    v_add_u32 v32, v32, v252
    buffer_load_dwordx4 v[96:99], v32, s[8:11], 0 offen
    v_add_u32 v33, v33, v252
    buffer_load_dwordx4 v[100:103], v33, s[8:11], 0 offen
    v_add_u32 v34, v34, v252
    buffer_load_dwordx4 v[104:107], v34, s[8:11], 0 offen
    v_add_u32 v35, v35, v252
    buffer_load_dwordx4 v[108:111], v35, s[8:11], 0 offen
    s_waitcnt vmcnt(0)
    v_mfma_f32_16x16x32_bf16 v[68:71], a[212:215], v[96:99], v[68:71]
    v_mfma_f32_16x16x32_bf16 v[68:71], a[212:215], v[100:103], v[68:71]
    v_mfma_f32_16x16x32_bf16 v[68:71], a[212:215], v[104:107], v[68:71]
    v_mfma_f32_16x16x32_bf16 v[68:71], a[212:215], v[108:111], v[68:71]
L_ext_20:
    s_bitcmp1_b32 s40, 4
    s_cbranch_scc0 L_ext_21
    ds_read_b128 v[32:35], v254 offset:1216
    s_waitcnt lgkmcnt(0)
    v_add_u32 v32, v32, v252
    buffer_load_dwordx4 v[96:99], v32, s[8:11], 0 offen
    v_add_u32 v33, v33, v252
    buffer_load_dwordx4 v[100:103], v33, s[8:11], 0 offen
    v_add_u32 v34, v34, v252
    buffer_load_dwordx4 v[104:107], v34, s[8:11], 0 offen
    v_add_u32 v35, v35, v252
    buffer_load_dwordx4 v[108:111], v35, s[8:11], 0 offen
    s_waitcnt vmcnt(0)
    v_mfma_f32_16x16x32_bf16 v[72:75], a[212:215], v[96:99], v[72:75]
    v_mfma_f32_16x16x32_bf16 v[72:75], a[212:215], v[100:103], v[72:75]
    v_mfma_f32_16x16x32_bf16 v[72:75], a[212:215], v[104:107], v[72:75]
    v_mfma_f32_16x16x32_bf16 v[72:75], a[212:215], v[108:111], v[72:75]
L_ext_21:
    s_bitcmp1_b32 s40, 5
    s_cbranch_scc0 L_ext_22
    ds_read_b128 v[32:35], v254 offset:1472
    s_waitcnt lgkmcnt(0)
    v_add_u32 v32, v32, v252
    buffer_load_dwordx4 v[96:99], v32, s[8:11], 0 offen
    v_add_u32 v33, v33, v252
    buffer_load_dwordx4 v[100:103], v33, s[8:11], 0 offen
    v_add_u32 v34, v34, v252
    buffer_load_dwordx4 v[104:107], v34, s[8:11], 0 offen
    v_add_u32 v35, v35, v252
    buffer_load_dwordx4 v[108:111], v35, s[8:11], 0 offen
    s_waitcnt vmcnt(0)
    v_mfma_f32_16x16x32_bf16 v[76:79], a[212:215], v[96:99], v[76:79]
    v_mfma_f32_16x16x32_bf16 v[76:79], a[212:215], v[100:103], v[76:79]
    v_mfma_f32_16x16x32_bf16 v[76:79], a[212:215], v[104:107], v[76:79]
    v_mfma_f32_16x16x32_bf16 v[76:79], a[212:215], v[108:111], v[76:79]
L_ext_22:
    s_bitcmp1_b32 s40, 6
    s_cbranch_scc0 L_ext_23
    ds_read_b128 v[32:35], v254 offset:1728
    s_waitcnt lgkmcnt(0)
    v_add_u32 v32, v32, v252
    buffer_load_dwordx4 v[96:99], v32, s[8:11], 0 offen
    v_add_u32 v33, v33, v252
    buffer_load_dwordx4 v[100:103], v33, s[8:11], 0 offen
    v_add_u32 v34, v34, v252
    buffer_load_dwordx4 v[104:107], v34, s[8:11], 0 offen
    v_add_u32 v35, v35, v252
    buffer_load_dwordx4 v[108:111], v35, s[8:11], 0 offen
    s_waitcnt vmcnt(0)
    v_mfma_f32_16x16x32_bf16 v[80:83], a[212:215], v[96:99], v[80:83]
    v_mfma_f32_16x16x32_bf16 v[80:83], a[212:215], v[100:103], v[80:83]
    v_mfma_f32_16x16x32_bf16 v[80:83], a[212:215], v[104:107], v[80:83]
    v_mfma_f32_16x16x32_bf16 v[80:83], a[212:215], v[108:111], v[80:83]
L_ext_23:
    s_bitcmp1_b32 s40, 7
    s_cbranch_scc0 L_ext_24
    ds_read_b128 v[32:35], v254 offset:1984
    s_waitcnt lgkmcnt(0)
    v_add_u32 v32, v32, v252
    buffer_load_dwordx4 v[96:99], v32, s[8:11], 0 offen
    v_add_u32 v33, v33, v252
    buffer_load_dwordx4 v[100:103], v33, s[8:11], 0 offen
    v_add_u32 v34, v34, v252
    buffer_load_dwordx4 v[104:107], v34, s[8:11], 0 offen
    v_add_u32 v35, v35, v252
    buffer_load_dwordx4 v[108:111], v35, s[8:11], 0 offen
    s_waitcnt vmcnt(0)
    v_mfma_f32_16x16x32_bf16 v[84:87], a[212:215], v[96:99], v[84:87]
    v_mfma_f32_16x16x32_bf16 v[84:87], a[212:215], v[100:103], v[84:87]
    v_mfma_f32_16x16x32_bf16 v[84:87], a[212:215], v[104:107], v[84:87]
    v_mfma_f32_16x16x32_bf16 v[84:87], a[212:215], v[108:111], v[84:87]
L_ext_24:
    s_bitcmp1_b32 s40, 8
    s_cbranch_scc0 L_ext_25
    ds_read_b128 v[32:35], v254 offset:2240
    s_waitcnt lgkmcnt(0)
    v_add_u32 v32, v32, v252
    buffer_load_dwordx4 v[96:99], v32, s[8:11], 0 offen
    v_add_u32 v33, v33, v252
    buffer_load_dwordx4 v[100:103], v33, s[8:11], 0 offen
    v_add_u32 v34, v34, v252
    buffer_load_dwordx4 v[104:107], v34, s[8:11], 0 offen
    v_add_u32 v35, v35, v252
    buffer_load_dwordx4 v[108:111], v35, s[8:11], 0 offen
    s_waitcnt vmcnt(0)
    v_mfma_f32_16x16x32_bf16 v[88:91], a[212:215], v[96:99], v[88:91]
    v_mfma_f32_16x16x32_bf16 v[88:91], a[212:215], v[100:103], v[88:91]
    v_mfma_f32_16x16x32_bf16 v[88:91], a[212:215], v[104:107], v[88:91]
    v_mfma_f32_16x16x32_bf16 v[88:91], a[212:215], v[108:111], v[88:91]
L_ext_25:
    s_bitcmp1_b32 s40, 9
    s_cbranch_scc0 L_ext_26
    ds_read_b128 v[32:35], v254 offset:2496
    s_waitcnt lgkmcnt(0)
    v_add_u32 v32, v32, v252
    buffer_load_dwordx4 v[96:99], v32, s[8:11], 0 offen
    v_add_u32 v33, v33, v252
    buffer_load_dwordx4 v[100:103], v33, s[8:11], 0 offen
    v_add_u32 v34, v34, v252
    buffer_load_dwordx4 v[104:107], v34, s[8:11], 0 offen
    v_add_u32 v35, v35, v252
    buffer_load_dwordx4 v[108:111], v35, s[8:11], 0 offen
    s_waitcnt vmcnt(0)
    v_mfma_f32_16x16x32_bf16 v[92:95], a[212:215], v[96:99], v[92:95]
    v_mfma_f32_16x16x32_bf16 v[92:95], a[212:215], v[100:103], v[92:95]
    v_mfma_f32_16x16x32_bf16 v[92:95], a[212:215], v[104:107], v[92:95]
    v_mfma_f32_16x16x32_bf16 v[92:95], a[212:215], v[108:111], v[92:95]
L_ext_26:
K2_NOEXT:
    v_or_b32 v236, v236, v231
    v_cmp_ne_u32 vcc, 0, v236
    v_readfirstlane_b32 s43, v231
    s_nop 3
    s_cbranch_vccz K2_GFIN
    s_waitcnt vmcnt(0)
    v_accvgpr_read_b32 v0, a192
    v_accvgpr_read_b32 v1, a193
    v_accvgpr_read_b32 v2, a194
    v_accvgpr_read_b32 v3, a195
    v_accvgpr_read_b32 v4, a196
    v_accvgpr_read_b32 v5, a197
    v_accvgpr_read_b32 v6, a198
    v_accvgpr_read_b32 v7, a199
    v_accvgpr_read_b32 v8, a200
    v_accvgpr_read_b32 v9, a201
    v_accvgpr_read_b32 v10, a202
    v_accvgpr_read_b32 v11, a203
    v_accvgpr_read_b32 v12, a204
    v_accvgpr_read_b32 v13, a205
    v_accvgpr_read_b32 v14, a206
    v_accvgpr_read_b32 v15, a207
    s_mov_b32 s42, 0
K2_MORE:
    s_cmp_lg_u32 s43, 0
    s_cbranch_scc1 K2_AGAIN
K2_SCAN:
    s_cmp_ge_u32 s42, 79
    s_cbranch_scc1 K2_GFIN
    s_and_b32 s36, s42, 63
    v_readlane_b32 s37, v200, s36
    v_readlane_b32 s38, v201, s36
    s_cmp_ge_u32 s42, 64
    s_cselect_b32 s37, s38, s37
    s_add_u32 s42, s42, 1
    s_cmp_eq_u32 s37, 0
    s_cbranch_scc1 K2_SCAN
    s_add_u32 s44, s4, 0x2400000
    s_addc_u32 s45, s5, 0
    s_mov_b32 s46, 0x278000
    s_mov_b32 s47, 0x00020000
    s_sub_u32 s38, s42, 1
    s_lshl_b32 s38, s38, 15
    s_mul_i32 s39, s2, 40
    v_lshl_add_u32 v236, v223, 3, s38
    buffer_load_dwordx2 v[96:97], v236, s[44:47], 0 offen
    v_add_u32 v236, 2048, v236
    buffer_load_dwordx2 v[98:99], v236, s[44:47], 0 offen
    v_add_u32 v236, 2048, v236
    buffer_load_dwordx2 v[100:101], v236, s[44:47], 0 offen
    v_add_u32 v236, 2048, v236
    buffer_load_dwordx2 v[102:103], v236, s[44:47], 0 offen
    v_add_u32 v236, 2048, v236
    buffer_load_dwordx2 v[104:105], v236, s[44:47], 0 offen
    v_add_u32 v236, 2048, v236
    buffer_load_dwordx2 v[106:107], v236, s[44:47], 0 offen
    v_add_u32 v236, 2048, v236
    buffer_load_dwordx2 v[108:109], v236, s[44:47], 0 offen
    v_add_u32 v236, 2048, v236
    buffer_load_dwordx2 v[110:111], v236, s[44:47], 0 offen
    v_add_u32 v236, 2048, v236
    buffer_load_dwordx2 v[112:113], v236, s[44:47], 0 offen
    v_add_u32 v236, 2048, v236
    buffer_load_dwordx2 v[114:115], v236, s[44:47], 0 offen
    v_add_u32 v236, 2048, v236
    buffer_load_dwordx2 v[116:117], v236, s[44:47], 0 offen
    v_add_u32 v236, 2048, v236
    buffer_load_dwordx2 v[118:119], v236, s[44:47], 0 offen
    v_add_u32 v236, 2048, v236
    buffer_load_dwordx2 v[120:121], v236, s[44:47], 0 offen
    v_add_u32 v236, 2048, v236
    buffer_load_dwordx2 v[122:123], v236, s[44:47], 0 offen
    v_add_u32 v236, 2048, v236
    buffer_load_dwordx2 v[124:125], v236, s[44:47], 0 offen
    v_add_u32 v236, 2048, v236
    buffer_load_dwordx2 v[126:127], v236, s[44:47], 0 offen
    v_add_u32 v236, 2048, v236
    s_waitcnt vmcnt(0)
    v_subrev_u32 v236, s39, v97
    v_add_u32 v235, 0, v223
    v_cmp_gt_u32 vcc, 40, v236
    v_cmp_gt_u32 s[44:45], s37, v235
    v_and_b32 v235, 0x3fffff, v96
    v_or_b32 v236, 0x80, v236
    s_and_b64 vcc, vcc, s[44:45]
    v_lshl_or_b32 v235, v236, 24, v235
    v_cndmask_b32 v0, 0, v235, vcc
    v_subrev_u32 v236, s39, v99
    v_add_u32 v235, 256, v223
    v_cmp_gt_u32 vcc, 40, v236
    v_cmp_gt_u32 s[44:45], s37, v235
    v_and_b32 v235, 0x3fffff, v98
    v_or_b32 v236, 0x80, v236
    s_and_b64 vcc, vcc, s[44:45]
    v_lshl_or_b32 v235, v236, 24, v235
    v_cndmask_b32 v1, 0, v235, vcc
    v_subrev_u32 v236, s39, v101
    v_add_u32 v235, 512, v223
    v_cmp_gt_u32 vcc, 40, v236
    v_cmp_gt_u32 s[44:45], s37, v235
    v_and_b32 v235, 0x3fffff, v100
    v_or_b32 v236, 0x80, v236
    s_and_b64 vcc, vcc, s[44:45]
    v_lshl_or_b32 v235, v236, 24, v235
    v_cndmask_b32 v2, 0, v235, vcc
    v_subrev_u32 v236, s39, v103
    v_add_u32 v235, 768, v223
    v_cmp_gt_u32 vcc, 40, v236
    v_cmp_gt_u32 s[44:45], s37, v235
    v_and_b32 v235, 0x3fffff, v102
    v_or_b32 v236, 0x80, v236
    s_and_b64 vcc, vcc, s[44:45]
    v_lshl_or_b32 v235, v236, 24, v235
    v_cndmask_b32 v3, 0, v235, vcc
    v_subrev_u32 v236, s39, v105
    v_add_u32 v235, 1024, v223
    v_cmp_gt_u32 vcc, 40, v236
    v_cmp_gt_u32 s[44:45], s37, v235
    v_and_b32 v235, 0x3fffff, v104
    v_or_b32 v236, 0x80, v236
    s_and_b64 vcc, vcc, s[44:45]
    v_lshl_or_b32 v235, v236, 24, v235
    v_cndmask_b32 v4, 0, v235, vcc
    v_subrev_u32 v236, s39, v107
    v_add_u32 v235, 1280, v223
    v_cmp_gt_u32 vcc, 40, v236
    v_cmp_gt_u32 s[44:45], s37, v235
    v_and_b32 v235, 0x3fffff, v106
    v_or_b32 v236, 0x80, v236
    s_and_b64 vcc, vcc, s[44:45]
    v_lshl_or_b32 v235, v236, 24, v235
    v_cndmask_b32 v5, 0, v235, vcc
    v_subrev_u32 v236, s39, v109
    v_add_u32 v235, 1536, v223
    v_cmp_gt_u32 vcc, 40, v236
    v_cmp_gt_u32 s[44:45], s37, v235
    v_and_b32 v235, 0x3fffff, v108
    v_or_b32 v236, 0x80, v236
    s_and_b64 vcc, vcc, s[44:45]
    v_lshl_or_b32 v235, v236, 24, v235
    v_cndmask_b32 v6, 0, v235, vcc
    v_subrev_u32 v236, s39, v111
    v_add_u32 v235, 1792, v223
    v_cmp_gt_u32 vcc, 40, v236
    v_cmp_gt_u32 s[44:45], s37, v235
    v_and_b32 v235, 0x3fffff, v110
    v_or_b32 v236, 0x80, v236
    s_and_b64 vcc, vcc, s[44:45]
    v_lshl_or_b32 v235, v236, 24, v235
    v_cndmask_b32 v7, 0, v235, vcc
    v_subrev_u32 v236, s39, v113
    v_add_u32 v235, 2048, v223
    v_cmp_gt_u32 vcc, 40, v236
    v_cmp_gt_u32 s[44:45], s37, v235
    v_and_b32 v235, 0x3fffff, v112
    v_or_b32 v236, 0x80, v236
    s_and_b64 vcc, vcc, s[44:45]
    v_lshl_or_b32 v235, v236, 24, v235
    v_cndmask_b32 v8, 0, v235, vcc
    v_subrev_u32 v236, s39, v115
    v_add_u32 v235, 2304, v223
    v_cmp_gt_u32 vcc, 40, v236
    v_cmp_gt_u32 s[44:45], s37, v235
    v_and_b32 v235, 0x3fffff, v114
    v_or_b32 v236, 0x80, v236
    s_and_b64 vcc, vcc, s[44:45]
    v_lshl_or_b32 v235, v236, 24, v235
    v_cndmask_b32 v9, 0, v235, vcc
    v_subrev_u32 v236, s39, v117
    v_add_u32 v235, 2560, v223
    v_cmp_gt_u32 vcc, 40, v236
    v_cmp_gt_u32 s[44:45], s37, v235
    v_and_b32 v235, 0x3fffff, v116
    v_or_b32 v236, 0x80, v236
    s_and_b64 vcc, vcc, s[44:45]
    v_lshl_or_b32 v235, v236, 24, v235
    v_cndmask_b32 v10, 0, v235, vcc
    v_subrev_u32 v236, s39, v119
    v_add_u32 v235, 2816, v223
    v_cmp_gt_u32 vcc, 40, v236
    v_cmp_gt_u32 s[44:45], s37, v235
    v_and_b32 v235, 0x3fffff, v118
    v_or_b32 v236, 0x80, v236
    s_and_b64 vcc, vcc, s[44:45]
    v_lshl_or_b32 v235, v236, 24, v235
    v_cndmask_b32 v11, 0, v235, vcc
    v_subrev_u32 v236, s39, v121
    v_add_u32 v235, 3072, v223
    v_cmp_gt_u32 vcc, 40, v236
    v_cmp_gt_u32 s[44:45], s37, v235
    v_and_b32 v235, 0x3fffff, v120
    v_or_b32 v236, 0x80, v236
    s_and_b64 vcc, vcc, s[44:45]
    v_lshl_or_b32 v235, v236, 24, v235
    v_cndmask_b32 v12, 0, v235, vcc
    v_subrev_u32 v236, s39, v123
    v_add_u32 v235, 3328, v223
    v_cmp_gt_u32 vcc, 40, v236
    v_cmp_gt_u32 s[44:45], s37, v235
    v_and_b32 v235, 0x3fffff, v122
    v_or_b32 v236, 0x80, v236
    s_and_b64 vcc, vcc, s[44:45]
    v_lshl_or_b32 v235, v236, 24, v235
    v_cndmask_b32 v13, 0, v235, vcc
    v_subrev_u32 v236, s39, v125
    v_add_u32 v235, 3584, v223
    v_cmp_gt_u32 vcc, 40, v236
    v_cmp_gt_u32 s[44:45], s37, v235
    v_and_b32 v235, 0x3fffff, v124
    v_or_b32 v236, 0x80, v236
    s_and_b64 vcc, vcc, s[44:45]
    v_lshl_or_b32 v235, v236, 24, v235
    v_cndmask_b32 v14, 0, v235, vcc
    v_subrev_u32 v236, s39, v127
    v_add_u32 v235, 3840, v223
    v_cmp_gt_u32 vcc, 40, v236
    v_cmp_gt_u32 s[44:45], s37, v235
    v_and_b32 v235, 0x3fffff, v126
    v_or_b32 v236, 0x80, v236
    s_and_b64 vcc, vcc, s[44:45]
    v_lshl_or_b32 v235, v236, 24, v235
    v_cndmask_b32 v15, 0, v235, vcc
K2_AGAIN:
    s_barrier
    v_mov_b32 v96, 0x7f000000
    v_mov_b32 v97, 0x7f000000
    v_mov_b32 v98, 0x7f000000
    v_mov_b32 v99, 0x7f000000
    v_lshlrev_b32 v100, 4, v223
    ds_write_b128 v100, v[96:99] offset:0
    ds_write_b128 v100, v[96:99] offset:4096
    ds_write_b128 v100, v[96:99] offset:8192
    v_and_b32 v101, 63, v223
    v_lshlrev_b32 v101, 2, v101
    v_mov_b32 v102, 0
    ds_write_b32 v101, v102 offset:12288
    s_waitcnt lgkmcnt(0)
    s_barrier
    v_mov_b32 v225, 1
    v_bfe_u32 v32, v0, 22, 8
    v_cmpx_ne_u32 vcc, 0, v0
    ds_add_rtn_u32 v16, v32, v225 offset:12288
    s_mov_b64 exec, -1
    v_bfe_u32 v33, v1, 22, 8
    v_cmpx_ne_u32 vcc, 0, v1
    ds_add_rtn_u32 v17, v33, v225 offset:12288
    s_mov_b64 exec, -1
    v_bfe_u32 v34, v2, 22, 8
    v_cmpx_ne_u32 vcc, 0, v2
    ds_add_rtn_u32 v18, v34, v225 offset:12288
    s_mov_b64 exec, -1
    v_bfe_u32 v35, v3, 22, 8
    v_cmpx_ne_u32 vcc, 0, v3
    ds_add_rtn_u32 v19, v35, v225 offset:12288
    s_mov_b64 exec, -1
    v_bfe_u32 v36, v4, 22, 8
    v_cmpx_ne_u32 vcc, 0, v4
    ds_add_rtn_u32 v20, v36, v225 offset:12288
    s_mov_b64 exec, -1
    v_bfe_u32 v37, v5, 22, 8
    v_cmpx_ne_u32 vcc, 0, v5
    ds_add_rtn_u32 v21, v37, v225 offset:12288
    s_mov_b64 exec, -1
    v_bfe_u32 v38, v6, 22, 8
    v_cmpx_ne_u32 vcc, 0, v6
    ds_add_rtn_u32 v22, v38, v225 offset:12288
    s_mov_b64 exec, -1
    v_bfe_u32 v39, v7, 22, 8
    v_cmpx_ne_u32 vcc, 0, v7
    ds_add_rtn_u32 v23, v39, v225 offset:12288
    s_mov_b64 exec, -1
    s_waitcnt lgkmcnt(0)
    v_lshlrev_b32 v32, 6, v32
    v_lshl_add_u32 v32, v16, 2, v32
    v_and_b32 v224, 0x3fffff, v0
    v_cmpx_ne_u32 vcc, 0, v0
    v_cmpx_gt_u32 vcc, 64, v16
    ds_write_b32 v32, v224
    v_mov_b32 v0, 0
    s_mov_b64 exec, -1
    v_lshlrev_b32 v33, 6, v33
    v_lshl_add_u32 v33, v17, 2, v33
    v_and_b32 v224, 0x3fffff, v1
    v_cmpx_ne_u32 vcc, 0, v1
    v_cmpx_gt_u32 vcc, 64, v17
    ds_write_b32 v33, v224
    v_mov_b32 v1, 0
    s_mov_b64 exec, -1
    v_lshlrev_b32 v34, 6, v34
    v_lshl_add_u32 v34, v18, 2, v34
    v_and_b32 v224, 0x3fffff, v2
    v_cmpx_ne_u32 vcc, 0, v2
    v_cmpx_gt_u32 vcc, 64, v18
    ds_write_b32 v34, v224
    v_mov_b32 v2, 0
    s_mov_b64 exec, -1
    v_lshlrev_b32 v35, 6, v35
    v_lshl_add_u32 v35, v19, 2, v35
    v_and_b32 v224, 0x3fffff, v3
    v_cmpx_ne_u32 vcc, 0, v3
    v_cmpx_gt_u32 vcc, 64, v19
    ds_write_b32 v35, v224
    v_mov_b32 v3, 0
    s_mov_b64 exec, -1
    v_lshlrev_b32 v36, 6, v36
    v_lshl_add_u32 v36, v20, 2, v36
    v_and_b32 v224, 0x3fffff, v4
    v_cmpx_ne_u32 vcc, 0, v4
    v_cmpx_gt_u32 vcc, 64, v20
    ds_write_b32 v36, v224
    v_mov_b32 v4, 0
    s_mov_b64 exec, -1
    v_lshlrev_b32 v37, 6, v37
    v_lshl_add_u32 v37, v21, 2, v37
    v_and_b32 v224, 0x3fffff, v5
    v_cmpx_ne_u32 vcc, 0, v5
    v_cmpx_gt_u32 vcc, 64, v21
    ds_write_b32 v37, v224
    v_mov_b32 v5, 0
    s_mov_b64 exec, -1
    v_lshlrev_b32 v38, 6, v38
    v_lshl_add_u32 v38, v22, 2, v38
    v_and_b32 v224, 0x3fffff, v6
    v_cmpx_ne_u32 vcc, 0, v6
    v_cmpx_gt_u32 vcc, 64, v22
    ds_write_b32 v38, v224
    v_mov_b32 v6, 0
    s_mov_b64 exec, -1
    v_lshlrev_b32 v39, 6, v39
    v_lshl_add_u32 v39, v23, 2, v39
    v_and_b32 v224, 0x3fffff, v7
    v_cmpx_ne_u32 vcc, 0, v7
    v_cmpx_gt_u32 vcc, 64, v23
    ds_write_b32 v39, v224
    v_mov_b32 v7, 0
    s_mov_b64 exec, -1
    v_bfe_u32 v40, v8, 22, 8
    v_cmpx_ne_u32 vcc, 0, v8
    ds_add_rtn_u32 v24, v40, v225 offset:12288
    s_mov_b64 exec, -1
    v_bfe_u32 v41, v9, 22, 8
    v_cmpx_ne_u32 vcc, 0, v9
    ds_add_rtn_u32 v25, v41, v225 offset:12288
    s_mov_b64 exec, -1
    v_bfe_u32 v42, v10, 22, 8
    v_cmpx_ne_u32 vcc, 0, v10
    ds_add_rtn_u32 v26, v42, v225 offset:12288
    s_mov_b64 exec, -1
    v_bfe_u32 v43, v11, 22, 8
    v_cmpx_ne_u32 vcc, 0, v11
    ds_add_rtn_u32 v27, v43, v225 offset:12288
    s_mov_b64 exec, -1
    v_bfe_u32 v44, v12, 22, 8
    v_cmpx_ne_u32 vcc, 0, v12
    ds_add_rtn_u32 v28, v44, v225 offset:12288
    s_mov_b64 exec, -1
    v_bfe_u32 v45, v13, 22, 8
    v_cmpx_ne_u32 vcc, 0, v13
    ds_add_rtn_u32 v29, v45, v225 offset:12288
    s_mov_b64 exec, -1
    v_bfe_u32 v46, v14, 22, 8
    v_cmpx_ne_u32 vcc, 0, v14
    ds_add_rtn_u32 v30, v46, v225 offset:12288
    s_mov_b64 exec, -1
    v_bfe_u32 v47, v15, 22, 8
    v_cmpx_ne_u32 vcc, 0, v15
    ds_add_rtn_u32 v31, v47, v225 offset:12288
    s_mov_b64 exec, -1
    s_waitcnt lgkmcnt(0)
    v_lshlrev_b32 v40, 6, v40
    v_lshl_add_u32 v40, v24, 2, v40
    v_and_b32 v224, 0x3fffff, v8
    v_cmpx_ne_u32 vcc, 0, v8
    v_cmpx_gt_u32 vcc, 64, v24
    ds_write_b32 v40, v224
    v_mov_b32 v8, 0
    s_mov_b64 exec, -1
    v_lshlrev_b32 v41, 6, v41
    v_lshl_add_u32 v41, v25, 2, v41
    v_and_b32 v224, 0x3fffff, v9
    v_cmpx_ne_u32 vcc, 0, v9
    v_cmpx_gt_u32 vcc, 64, v25
    ds_write_b32 v41, v224
    v_mov_b32 v9, 0
    s_mov_b64 exec, -1
    v_lshlrev_b32 v42, 6, v42
    v_lshl_add_u32 v42, v26, 2, v42
    v_and_b32 v224, 0x3fffff, v10
    v_cmpx_ne_u32 vcc, 0, v10
    v_cmpx_gt_u32 vcc, 64, v26
    ds_write_b32 v42, v224
    v_mov_b32 v10, 0
    s_mov_b64 exec, -1
    v_lshlrev_b32 v43, 6, v43
    v_lshl_add_u32 v43, v27, 2, v43
    v_and_b32 v224, 0x3fffff, v11
    v_cmpx_ne_u32 vcc, 0, v11
    v_cmpx_gt_u32 vcc, 64, v27
    ds_write_b32 v43, v224
    v_mov_b32 v11, 0
    s_mov_b64 exec, -1
    v_lshlrev_b32 v44, 6, v44
    v_lshl_add_u32 v44, v28, 2, v44
    v_and_b32 v224, 0x3fffff, v12
    v_cmpx_ne_u32 vcc, 0, v12
    v_cmpx_gt_u32 vcc, 64, v28
    ds_write_b32 v44, v224
    v_mov_b32 v12, 0
    s_mov_b64 exec, -1
    v_lshlrev_b32 v45, 6, v45
    v_lshl_add_u32 v45, v29, 2, v45
    v_and_b32 v224, 0x3fffff, v13
    v_cmpx_ne_u32 vcc, 0, v13
    v_cmpx_gt_u32 vcc, 64, v29
    ds_write_b32 v45, v224
    v_mov_b32 v13, 0
    s_mov_b64 exec, -1
    v_lshlrev_b32 v46, 6, v46
    v_lshl_add_u32 v46, v30, 2, v46
    v_and_b32 v224, 0x3fffff, v14
    v_cmpx_ne_u32 vcc, 0, v14
    v_cmpx_gt_u32 vcc, 64, v30
    ds_write_b32 v46, v224
    v_mov_b32 v14, 0
    s_mov_b64 exec, -1
    v_lshlrev_b32 v47, 6, v47
    v_lshl_add_u32 v47, v31, 2, v47
    v_and_b32 v224, 0x3fffff, v15
    v_cmpx_ne_u32 vcc, 0, v15
    v_cmpx_gt_u32 vcc, 64, v31
    ds_write_b32 v47, v224
    v_mov_b32 v15, 0
    s_mov_b64 exec, -1
    v_or3_b32 v224, v0, v1, v2
    v_or3_b32 v224, v224, v3, v4
    v_or3_b32 v224, v224, v5, v6
    v_or3_b32 v224, v224, v7, v8
    v_or3_b32 v224, v224, v9, v10
    v_or3_b32 v224, v224, v11, v12
    v_or3_b32 v224, v224, v13, v14
    v_or_b32 v224, v224, v15
    v_mov_b32 v226, 12480
    v_cmpx_ne_u32 vcc, 0, v224
    ds_write_b32 v226, v225
    s_mov_b64 exec, -1
    s_waitcnt lgkmcnt(0)
    s_barrier
    ds_read_b32 v231, v226
    ds_read_b128 v[32:35], v254 offset:0
    ds_read_b128 v[36:39], v254 offset:64
    ds_read_b128 v[40:43], v254 offset:128
    ds_read_b128 v[44:47], v254 offset:192
    s_waitcnt lgkmcnt(0)
    v_add_u32 v32, v32, v252
    buffer_load_dwordx4 v[96:99], v32, s[8:11], 0 offen
    v_add_u32 v33, v33, v252
    buffer_load_dwordx4 v[100:103], v33, s[8:11], 0 offen
    v_add_u32 v34, v34, v252
    buffer_load_dwordx4 v[104:107], v34, s[8:11], 0 offen
    v_add_u32 v35, v35, v252
    buffer_load_dwordx4 v[108:111], v35, s[8:11], 0 offen
    v_add_u32 v36, v36, v252
    buffer_load_dwordx4 v[112:115], v36, s[8:11], 0 offen
    v_add_u32 v37, v37, v252
    buffer_load_dwordx4 v[116:119], v37, s[8:11], 0 offen
    v_add_u32 v38, v38, v252
    buffer_load_dwordx4 v[120:123], v38, s[8:11], 0 offen
    v_add_u32 v39, v39, v252
    buffer_load_dwordx4 v[124:127], v39, s[8:11], 0 offen
    v_add_u32 v40, v40, v252
    buffer_load_dwordx4 v[128:131], v40, s[8:11], 0 offen
    v_add_u32 v41, v41, v252
    buffer_load_dwordx4 v[132:135], v41, s[8:11], 0 offen
    v_add_u32 v42, v42, v252
    buffer_load_dwordx4 v[136:139], v42, s[8:11], 0 offen
    v_add_u32 v43, v43, v252
    buffer_load_dwordx4 v[140:143], v43, s[8:11], 0 offen
    v_add_u32 v44, v44, v252
    buffer_load_dwordx4 v[144:147], v44, s[8:11], 0 offen
    v_add_u32 v45, v45, v252
    buffer_load_dwordx4 v[148:151], v45, s[8:11], 0 offen
    v_add_u32 v46, v46, v252
    buffer_load_dwordx4 v[152:155], v46, s[8:11], 0 offen
    v_add_u32 v47, v47, v252
    buffer_load_dwordx4 v[156:159], v47, s[8:11], 0 offen
    s_waitcnt vmcnt(0)
    v_mfma_f32_16x16x32_bf16 v[56:59], a[212:215], v[96:99], v[56:59]
    v_mfma_f32_16x16x32_bf16 v[56:59], a[212:215], v[100:103], v[56:59]
    v_mfma_f32_16x16x32_bf16 v[56:59], a[212:215], v[104:107], v[56:59]
    v_mfma_f32_16x16x32_bf16 v[56:59], a[212:215], v[108:111], v[56:59]
    v_mfma_f32_16x16x32_bf16 v[56:59], a[212:215], v[112:115], v[56:59]
    v_mfma_f32_16x16x32_bf16 v[56:59], a[212:215], v[116:119], v[56:59]
    v_mfma_f32_16x16x32_bf16 v[56:59], a[212:215], v[120:123], v[56:59]
    v_mfma_f32_16x16x32_bf16 v[56:59], a[212:215], v[124:127], v[56:59]
    v_mfma_f32_16x16x32_bf16 v[56:59], a[212:215], v[128:131], v[56:59]
    v_mfma_f32_16x16x32_bf16 v[56:59], a[212:215], v[132:135], v[56:59]
    v_mfma_f32_16x16x32_bf16 v[56:59], a[212:215], v[136:139], v[56:59]
    v_mfma_f32_16x16x32_bf16 v[56:59], a[212:215], v[140:143], v[56:59]
    v_mfma_f32_16x16x32_bf16 v[56:59], a[212:215], v[144:147], v[56:59]
    v_mfma_f32_16x16x32_bf16 v[56:59], a[212:215], v[148:151], v[56:59]
    v_mfma_f32_16x16x32_bf16 v[56:59], a[212:215], v[152:155], v[56:59]
    v_mfma_f32_16x16x32_bf16 v[56:59], a[212:215], v[156:159], v[56:59]
    ds_read_b128 v[32:35], v254 offset:256
    ds_read_b128 v[36:39], v254 offset:320
    ds_read_b128 v[40:43], v254 offset:384
    ds_read_b128 v[44:47], v254 offset:448
    s_waitcnt lgkmcnt(0)
    v_add_u32 v32, v32, v252
    buffer_load_dwordx4 v[96:99], v32, s[8:11], 0 offen
    v_add_u32 v33, v33, v252
    buffer_load_dwordx4 v[100:103], v33, s[8:11], 0 offen
    v_add_u32 v34, v34, v252
    buffer_load_dwordx4 v[104:107], v34, s[8:11], 0 offen
    v_add_u32 v35, v35, v252
    buffer_load_dwordx4 v[108:111], v35, s[8:11], 0 offen
    v_add_u32 v36, v36, v252
    buffer_load_dwordx4 v[112:115], v36, s[8:11], 0 offen
    v_add_u32 v37, v37, v252
    buffer_load_dwordx4 v[116:119], v37, s[8:11], 0 offen
    v_add_u32 v38, v38, v252
    buffer_load_dwordx4 v[120:123], v38, s[8:11], 0 offen
    v_add_u32 v39, v39, v252
    buffer_load_dwordx4 v[124:127], v39, s[8:11], 0 offen
    v_add_u32 v40, v40, v252
    buffer_load_dwordx4 v[128:131], v40, s[8:11], 0 offen
    v_add_u32 v41, v41, v252
    buffer_load_dwordx4 v[132:135], v41, s[8:11], 0 offen
    v_add_u32 v42, v42, v252
    buffer_load_dwordx4 v[136:139], v42, s[8:11], 0 offen
    v_add_u32 v43, v43, v252
    buffer_load_dwordx4 v[140:143], v43, s[8:11], 0 offen
    v_add_u32 v44, v44, v252
    buffer_load_dwordx4 v[144:147], v44, s[8:11], 0 offen
    v_add_u32 v45, v45, v252
    buffer_load_dwordx4 v[148:151], v45, s[8:11], 0 offen
    v_add_u32 v46, v46, v252
    buffer_load_dwordx4 v[152:155], v46, s[8:11], 0 offen
    v_add_u32 v47, v47, v252
    buffer_load_dwordx4 v[156:159], v47, s[8:11], 0 offen
    s_waitcnt vmcnt(0)
    v_mfma_f32_16x16x32_bf16 v[60:63], a[212:215], v[96:99], v[60:63]
    v_mfma_f32_16x16x32_bf16 v[60:63], a[212:215], v[100:103], v[60:63]
    v_mfma_f32_16x16x32_bf16 v[60:63], a[212:215], v[104:107], v[60:63]
    v_mfma_f32_16x16x32_bf16 v[60:63], a[212:215], v[108:111], v[60:63]
    v_mfma_f32_16x16x32_bf16 v[60:63], a[212:215], v[112:115], v[60:63]
    v_mfma_f32_16x16x32_bf16 v[60:63], a[212:215], v[116:119], v[60:63]
    v_mfma_f32_16x16x32_bf16 v[60:63], a[212:215], v[120:123], v[60:63]
    v_mfma_f32_16x16x32_bf16 v[60:63], a[212:215], v[124:127], v[60:63]
    v_mfma_f32_16x16x32_bf16 v[60:63], a[212:215], v[128:131], v[60:63]
    v_mfma_f32_16x16x32_bf16 v[60:63], a[212:215], v[132:135], v[60:63]
    v_mfma_f32_16x16x32_bf16 v[60:63], a[212:215], v[136:139], v[60:63]
    v_mfma_f32_16x16x32_bf16 v[60:63], a[212:215], v[140:143], v[60:63]
    v_mfma_f32_16x16x32_bf16 v[60:63], a[212:215], v[144:147], v[60:63]
    v_mfma_f32_16x16x32_bf16 v[60:63], a[212:215], v[148:151], v[60:63]
    v_mfma_f32_16x16x32_bf16 v[60:63], a[212:215], v[152:155], v[60:63]
    v_mfma_f32_16x16x32_bf16 v[60:63], a[212:215], v[156:159], v[60:63]
    ds_read_b128 v[32:35], v254 offset:512
    ds_read_b128 v[36:39], v254 offset:576
    ds_read_b128 v[40:43], v254 offset:640
    ds_read_b128 v[44:47], v254 offset:704
    s_waitcnt lgkmcnt(0)
    v_add_u32 v32, v32, v252
    buffer_load_dwordx4 v[96:99], v32, s[8:11], 0 offen
    v_add_u32 v33, v33, v252
    buffer_load_dwordx4 v[100:103], v33, s[8:11], 0 offen
    v_add_u32 v34, v34, v252
    buffer_load_dwordx4 v[104:107], v34, s[8:11], 0 offen
    v_add_u32 v35, v35, v252
    buffer_load_dwordx4 v[108:111], v35, s[8:11], 0 offen
    v_add_u32 v36, v36, v252
    buffer_load_dwordx4 v[112:115], v36, s[8:11], 0 offen
    v_add_u32 v37, v37, v252
    buffer_load_dwordx4 v[116:119], v37, s[8:11], 0 offen
    v_add_u32 v38, v38, v252
    buffer_load_dwordx4 v[120:123], v38, s[8:11], 0 offen
    v_add_u32 v39, v39, v252
    buffer_load_dwordx4 v[124:127], v39, s[8:11], 0 offen
    v_add_u32 v40, v40, v252
    buffer_load_dwordx4 v[128:131], v40, s[8:11], 0 offen
    v_add_u32 v41, v41, v252
    buffer_load_dwordx4 v[132:135], v41, s[8:11], 0 offen
    v_add_u32 v42, v42, v252
    buffer_load_dwordx4 v[136:139], v42, s[8:11], 0 offen
    v_add_u32 v43, v43, v252
    buffer_load_dwordx4 v[140:143], v43, s[8:11], 0 offen
    v_add_u32 v44, v44, v252
    buffer_load_dwordx4 v[144:147], v44, s[8:11], 0 offen
    v_add_u32 v45, v45, v252
    buffer_load_dwordx4 v[148:151], v45, s[8:11], 0 offen
    v_add_u32 v46, v46, v252
    buffer_load_dwordx4 v[152:155], v46, s[8:11], 0 offen
    v_add_u32 v47, v47, v252
    buffer_load_dwordx4 v[156:159], v47, s[8:11], 0 offen
    s_waitcnt vmcnt(0)
    v_mfma_f32_16x16x32_bf16 v[64:67], a[212:215], v[96:99], v[64:67]
    v_mfma_f32_16x16x32_bf16 v[64:67], a[212:215], v[100:103], v[64:67]
    v_mfma_f32_16x16x32_bf16 v[64:67], a[212:215], v[104:107], v[64:67]
    v_mfma_f32_16x16x32_bf16 v[64:67], a[212:215], v[108:111], v[64:67]
    v_mfma_f32_16x16x32_bf16 v[64:67], a[212:215], v[112:115], v[64:67]
    v_mfma_f32_16x16x32_bf16 v[64:67], a[212:215], v[116:119], v[64:67]
    v_mfma_f32_16x16x32_bf16 v[64:67], a[212:215], v[120:123], v[64:67]
    v_mfma_f32_16x16x32_bf16 v[64:67], a[212:215], v[124:127], v[64:67]
    v_mfma_f32_16x16x32_bf16 v[64:67], a[212:215], v[128:131], v[64:67]
    v_mfma_f32_16x16x32_bf16 v[64:67], a[212:215], v[132:135], v[64:67]
    v_mfma_f32_16x16x32_bf16 v[64:67], a[212:215], v[136:139], v[64:67]
    v_mfma_f32_16x16x32_bf16 v[64:67], a[212:215], v[140:143], v[64:67]
    v_mfma_f32_16x16x32_bf16 v[64:67], a[212:215], v[144:147], v[64:67]
    v_mfma_f32_16x16x32_bf16 v[64:67], a[212:215], v[148:151], v[64:67]
    v_mfma_f32_16x16x32_bf16 v[64:67], a[212:215], v[152:155], v[64:67]
    v_mfma_f32_16x16x32_bf16 v[64:67], a[212:215], v[156:159], v[64:67]
    ds_read_b128 v[32:35], v254 offset:768
    ds_read_b128 v[36:39], v254 offset:832
    ds_read_b128 v[40:43], v254 offset:896
    ds_read_b128 v[44:47], v254 offset:960
    s_waitcnt lgkmcnt(0)
    v_add_u32 v32, v32, v252
    buffer_load_dwordx4 v[96:99], v32, s[8:11], 0 offen
    v_add_u32 v33, v33, v252
    buffer_load_dwordx4 v[100:103], v33, s[8:11], 0 offen
    v_add_u32 v34, v34, v252
    buffer_load_dwordx4 v[104:107], v34, s[8:11], 0 offen
    v_add_u32 v35, v35, v252
    buffer_load_dwordx4 v[108:111], v35, s[8:11], 0 offen
    v_add_u32 v36, v36, v252
    buffer_load_dwordx4 v[112:115], v36, s[8:11], 0 offen
    v_add_u32 v37, v37, v252
    buffer_load_dwordx4 v[116:119], v37, s[8:11], 0 offen
    v_add_u32 v38, v38, v252
    buffer_load_dwordx4 v[120:123], v38, s[8:11], 0 offen
    v_add_u32 v39, v39, v252
    buffer_load_dwordx4 v[124:127], v39, s[8:11], 0 offen
    v_add_u32 v40, v40, v252
    buffer_load_dwordx4 v[128:131], v40, s[8:11], 0 offen
    v_add_u32 v41, v41, v252
    buffer_load_dwordx4 v[132:135], v41, s[8:11], 0 offen
    v_add_u32 v42, v42, v252
    buffer_load_dwordx4 v[136:139], v42, s[8:11], 0 offen
    v_add_u32 v43, v43, v252
    buffer_load_dwordx4 v[140:143], v43, s[8:11], 0 offen
    v_add_u32 v44, v44, v252
    buffer_load_dwordx4 v[144:147], v44, s[8:11], 0 offen
    v_add_u32 v45, v45, v252
    buffer_load_dwordx4 v[148:151], v45, s[8:11], 0 offen
    v_add_u32 v46, v46, v252
    buffer_load_dwordx4 v[152:155], v46, s[8:11], 0 offen
    v_add_u32 v47, v47, v252
    buffer_load_dwordx4 v[156:159], v47, s[8:11], 0 offen
    s_waitcnt vmcnt(0)
    v_mfma_f32_16x16x32_bf16 v[68:71], a[212:215], v[96:99], v[68:71]
    v_mfma_f32_16x16x32_bf16 v[68:71], a[212:215], v[100:103], v[68:71]
    v_mfma_f32_16x16x32_bf16 v[68:71], a[212:215], v[104:107], v[68:71]
    v_mfma_f32_16x16x32_bf16 v[68:71], a[212:215], v[108:111], v[68:71]
    v_mfma_f32_16x16x32_bf16 v[68:71], a[212:215], v[112:115], v[68:71]
    v_mfma_f32_16x16x32_bf16 v[68:71], a[212:215], v[116:119], v[68:71]
    v_mfma_f32_16x16x32_bf16 v[68:71], a[212:215], v[120:123], v[68:71]
    v_mfma_f32_16x16x32_bf16 v[68:71], a[212:215], v[124:127], v[68:71]
    v_mfma_f32_16x16x32_bf16 v[68:71], a[212:215], v[128:131], v[68:71]
    v_mfma_f32_16x16x32_bf16 v[68:71], a[212:215], v[132:135], v[68:71]
    v_mfma_f32_16x16x32_bf16 v[68:71], a[212:215], v[136:139], v[68:71]
    v_mfma_f32_16x16x32_bf16 v[68:71], a[212:215], v[140:143], v[68:71]
    v_mfma_f32_16x16x32_bf16 v[68:71], a[212:215], v[144:147], v[68:71]
    v_mfma_f32_16x16x32_bf16 v[68:71], a[212:215], v[148:151], v[68:71]
    v_mfma_f32_16x16x32_bf16 v[68:71], a[212:215], v[152:155], v[68:71]
    v_mfma_f32_16x16x32_bf16 v[68:71], a[212:215], v[156:159], v[68:71]
    ds_read_b128 v[32:35], v254 offset:1024
    ds_read_b128 v[36:39], v254 offset:1088
    ds_read_b128 v[40:43], v254 offset:1152
    ds_read_b128 v[44:47], v254 offset:1216
    s_waitcnt lgkmcnt(0)
    v_add_u32 v32, v32, v252
    buffer_load_dwordx4 v[96:99], v32, s[8:11], 0 offen
    v_add_u32 v33, v33, v252
    buffer_load_dwordx4 v[100:103], v33, s[8:11], 0 offen
    v_add_u32 v34, v34, v252
    buffer_load_dwordx4 v[104:107], v34, s[8:11], 0 offen
    v_add_u32 v35, v35, v252
    buffer_load_dwordx4 v[108:111], v35, s[8:11], 0 offen
    v_add_u32 v36, v36, v252
    buffer_load_dwordx4 v[112:115], v36, s[8:11], 0 offen
    v_add_u32 v37, v37, v252
    buffer_load_dwordx4 v[116:119], v37, s[8:11], 0 offen
    v_add_u32 v38, v38, v252
    buffer_load_dwordx4 v[120:123], v38, s[8:11], 0 offen
    v_add_u32 v39, v39, v252
    buffer_load_dwordx4 v[124:127], v39, s[8:11], 0 offen
    v_add_u32 v40, v40, v252
    buffer_load_dwordx4 v[128:131], v40, s[8:11], 0 offen
    v_add_u32 v41, v41, v252
    buffer_load_dwordx4 v[132:135], v41, s[8:11], 0 offen
    v_add_u32 v42, v42, v252
    buffer_load_dwordx4 v[136:139], v42, s[8:11], 0 offen
    v_add_u32 v43, v43, v252
    buffer_load_dwordx4 v[140:143], v43, s[8:11], 0 offen
    v_add_u32 v44, v44, v252
    buffer_load_dwordx4 v[144:147], v44, s[8:11], 0 offen
    v_add_u32 v45, v45, v252
    buffer_load_dwordx4 v[148:151], v45, s[8:11], 0 offen
    v_add_u32 v46, v46, v252
    buffer_load_dwordx4 v[152:155], v46, s[8:11], 0 offen
    v_add_u32 v47, v47, v252
    buffer_load_dwordx4 v[156:159], v47, s[8:11], 0 offen
    s_waitcnt vmcnt(0)
    v_mfma_f32_16x16x32_bf16 v[72:75], a[212:215], v[96:99], v[72:75]
    v_mfma_f32_16x16x32_bf16 v[72:75], a[212:215], v[100:103], v[72:75]
    v_mfma_f32_16x16x32_bf16 v[72:75], a[212:215], v[104:107], v[72:75]
    v_mfma_f32_16x16x32_bf16 v[72:75], a[212:215], v[108:111], v[72:75]
    v_mfma_f32_16x16x32_bf16 v[72:75], a[212:215], v[112:115], v[72:75]
    v_mfma_f32_16x16x32_bf16 v[72:75], a[212:215], v[116:119], v[72:75]
    v_mfma_f32_16x16x32_bf16 v[72:75], a[212:215], v[120:123], v[72:75]
    v_mfma_f32_16x16x32_bf16 v[72:75], a[212:215], v[124:127], v[72:75]
    v_mfma_f32_16x16x32_bf16 v[72:75], a[212:215], v[128:131], v[72:75]
    v_mfma_f32_16x16x32_bf16 v[72:75], a[212:215], v[132:135], v[72:75]
    v_mfma_f32_16x16x32_bf16 v[72:75], a[212:215], v[136:139], v[72:75]
    v_mfma_f32_16x16x32_bf16 v[72:75], a[212:215], v[140:143], v[72:75]
    v_mfma_f32_16x16x32_bf16 v[72:75], a[212:215], v[144:147], v[72:75]
    v_mfma_f32_16x16x32_bf16 v[72:75], a[212:215], v[148:151], v[72:75]
    v_mfma_f32_16x16x32_bf16 v[72:75], a[212:215], v[152:155], v[72:75]
    v_mfma_f32_16x16x32_bf16 v[72:75], a[212:215], v[156:159], v[72:75]
    ds_read_b128 v[32:35], v254 offset:1280
    ds_read_b128 v[36:39], v254 offset:1344
    ds_read_b128 v[40:43], v254 offset:1408
    ds_read_b128 v[44:47], v254 offset:1472
    s_waitcnt lgkmcnt(0)
    v_add_u32 v32, v32, v252
    buffer_load_dwordx4 v[96:99], v32, s[8:11], 0 offen
    v_add_u32 v33, v33, v252
    buffer_load_dwordx4 v[100:103], v33, s[8:11], 0 offen
    v_add_u32 v34, v34, v252
    buffer_load_dwordx4 v[104:107], v34, s[8:11], 0 offen
    v_add_u32 v35, v35, v252
    buffer_load_dwordx4 v[108:111], v35, s[8:11], 0 offen
    v_add_u32 v36, v36, v252
    buffer_load_dwordx4 v[112:115], v36, s[8:11], 0 offen
    v_add_u32 v37, v37, v252
    buffer_load_dwordx4 v[116:119], v37, s[8:11], 0 offen
    v_add_u32 v38, v38, v252
    buffer_load_dwordx4 v[120:123], v38, s[8:11], 0 offen
    v_add_u32 v39, v39, v252
    buffer_load_dwordx4 v[124:127], v39, s[8:11], 0 offen
    v_add_u32 v40, v40, v252
    buffer_load_dwordx4 v[128:131], v40, s[8:11], 0 offen
    v_add_u32 v41, v41, v252
    buffer_load_dwordx4 v[132:135], v41, s[8:11], 0 offen
    v_add_u32 v42, v42, v252
    buffer_load_dwordx4 v[136:139], v42, s[8:11], 0 offen
    v_add_u32 v43, v43, v252
    buffer_load_dwordx4 v[140:143], v43, s[8:11], 0 offen
    v_add_u32 v44, v44, v252
    buffer_load_dwordx4 v[144:147], v44, s[8:11], 0 offen
    v_add_u32 v45, v45, v252
    buffer_load_dwordx4 v[148:151], v45, s[8:11], 0 offen
    v_add_u32 v46, v46, v252
    buffer_load_dwordx4 v[152:155], v46, s[8:11], 0 offen
    v_add_u32 v47, v47, v252
    buffer_load_dwordx4 v[156:159], v47, s[8:11], 0 offen
    s_waitcnt vmcnt(0)
    v_mfma_f32_16x16x32_bf16 v[76:79], a[212:215], v[96:99], v[76:79]
    v_mfma_f32_16x16x32_bf16 v[76:79], a[212:215], v[100:103], v[76:79]
    v_mfma_f32_16x16x32_bf16 v[76:79], a[212:215], v[104:107], v[76:79]
    v_mfma_f32_16x16x32_bf16 v[76:79], a[212:215], v[108:111], v[76:79]
    v_mfma_f32_16x16x32_bf16 v[76:79], a[212:215], v[112:115], v[76:79]
    v_mfma_f32_16x16x32_bf16 v[76:79], a[212:215], v[116:119], v[76:79]
    v_mfma_f32_16x16x32_bf16 v[76:79], a[212:215], v[120:123], v[76:79]
    v_mfma_f32_16x16x32_bf16 v[76:79], a[212:215], v[124:127], v[76:79]
    v_mfma_f32_16x16x32_bf16 v[76:79], a[212:215], v[128:131], v[76:79]
    v_mfma_f32_16x16x32_bf16 v[76:79], a[212:215], v[132:135], v[76:79]
    v_mfma_f32_16x16x32_bf16 v[76:79], a[212:215], v[136:139], v[76:79]
    v_mfma_f32_16x16x32_bf16 v[76:79], a[212:215], v[140:143], v[76:79]
    v_mfma_f32_16x16x32_bf16 v[76:79], a[212:215], v[144:147], v[76:79]
    v_mfma_f32_16x16x32_bf16 v[76:79], a[212:215], v[148:151], v[76:79]
    v_mfma_f32_16x16x32_bf16 v[76:79], a[212:215], v[152:155], v[76:79]
    v_mfma_f32_16x16x32_bf16 v[76:79], a[212:215], v[156:159], v[76:79]
    ds_read_b128 v[32:35], v254 offset:1536
    ds_read_b128 v[36:39], v254 offset:1600
    ds_read_b128 v[40:43], v254 offset:1664
    ds_read_b128 v[44:47], v254 offset:1728
    s_waitcnt lgkmcnt(0)
    v_add_u32 v32, v32, v252
    buffer_load_dwordx4 v[96:99], v32, s[8:11], 0 offen
    v_add_u32 v33, v33, v252
    buffer_load_dwordx4 v[100:103], v33, s[8:11], 0 offen
    v_add_u32 v34, v34, v252
    buffer_load_dwordx4 v[104:107], v34, s[8:11], 0 offen
    v_add_u32 v35, v35, v252
    buffer_load_dwordx4 v[108:111], v35, s[8:11], 0 offen
    v_add_u32 v36, v36, v252
    buffer_load_dwordx4 v[112:115], v36, s[8:11], 0 offen
    v_add_u32 v37, v37, v252
    buffer_load_dwordx4 v[116:119], v37, s[8:11], 0 offen
    v_add_u32 v38, v38, v252
    buffer_load_dwordx4 v[120:123], v38, s[8:11], 0 offen
    v_add_u32 v39, v39, v252
    buffer_load_dwordx4 v[124:127], v39, s[8:11], 0 offen
    v_add_u32 v40, v40, v252
    buffer_load_dwordx4 v[128:131], v40, s[8:11], 0 offen
    v_add_u32 v41, v41, v252
    buffer_load_dwordx4 v[132:135], v41, s[8:11], 0 offen
    v_add_u32 v42, v42, v252
    buffer_load_dwordx4 v[136:139], v42, s[8:11], 0 offen
    v_add_u32 v43, v43, v252
    buffer_load_dwordx4 v[140:143], v43, s[8:11], 0 offen
    v_add_u32 v44, v44, v252
    buffer_load_dwordx4 v[144:147], v44, s[8:11], 0 offen
    v_add_u32 v45, v45, v252
    buffer_load_dwordx4 v[148:151], v45, s[8:11], 0 offen
    v_add_u32 v46, v46, v252
    buffer_load_dwordx4 v[152:155], v46, s[8:11], 0 offen
    v_add_u32 v47, v47, v252
    buffer_load_dwordx4 v[156:159], v47, s[8:11], 0 offen
    s_waitcnt vmcnt(0)
    v_mfma_f32_16x16x32_bf16 v[80:83], a[212:215], v[96:99], v[80:83]
    v_mfma_f32_16x16x32_bf16 v[80:83], a[212:215], v[100:103], v[80:83]
    v_mfma_f32_16x16x32_bf16 v[80:83], a[212:215], v[104:107], v[80:83]
    v_mfma_f32_16x16x32_bf16 v[80:83], a[212:215], v[108:111], v[80:83]
    v_mfma_f32_16x16x32_bf16 v[80:83], a[212:215], v[112:115], v[80:83]
    v_mfma_f32_16x16x32_bf16 v[80:83], a[212:215], v[116:119], v[80:83]
    v_mfma_f32_16x16x32_bf16 v[80:83], a[212:215], v[120:123], v[80:83]
    v_mfma_f32_16x16x32_bf16 v[80:83], a[212:215], v[124:127], v[80:83]
    v_mfma_f32_16x16x32_bf16 v[80:83], a[212:215], v[128:131], v[80:83]
    v_mfma_f32_16x16x32_bf16 v[80:83], a[212:215], v[132:135], v[80:83]
    v_mfma_f32_16x16x32_bf16 v[80:83], a[212:215], v[136:139], v[80:83]
    v_mfma_f32_16x16x32_bf16 v[80:83], a[212:215], v[140:143], v[80:83]
    v_mfma_f32_16x16x32_bf16 v[80:83], a[212:215], v[144:147], v[80:83]
    v_mfma_f32_16x16x32_bf16 v[80:83], a[212:215], v[148:151], v[80:83]
    v_mfma_f32_16x16x32_bf16 v[80:83], a[212:215], v[152:155], v[80:83]
    v_mfma_f32_16x16x32_bf16 v[80:83], a[212:215], v[156:159], v[80:83]
    ds_read_b128 v[32:35], v254 offset:1792
    ds_read_b128 v[36:39], v254 offset:1856
    ds_read_b128 v[40:43], v254 offset:1920
    ds_read_b128 v[44:47], v254 offset:1984
    s_waitcnt lgkmcnt(0)
    v_add_u32 v32, v32, v252
    buffer_load_dwordx4 v[96:99], v32, s[8:11], 0 offen
    v_add_u32 v33, v33, v252
    buffer_load_dwordx4 v[100:103], v33, s[8:11], 0 offen
    v_add_u32 v34, v34, v252
    buffer_load_dwordx4 v[104:107], v34, s[8:11], 0 offen
    v_add_u32 v35, v35, v252
    buffer_load_dwordx4 v[108:111], v35, s[8:11], 0 offen
    v_add_u32 v36, v36, v252
    buffer_load_dwordx4 v[112:115], v36, s[8:11], 0 offen
    v_add_u32 v37, v37, v252
    buffer_load_dwordx4 v[116:119], v37, s[8:11], 0 offen
    v_add_u32 v38, v38, v252
    buffer_load_dwordx4 v[120:123], v38, s[8:11], 0 offen
    v_add_u32 v39, v39, v252
    buffer_load_dwordx4 v[124:127], v39, s[8:11], 0 offen
    v_add_u32 v40, v40, v252
    buffer_load_dwordx4 v[128:131], v40, s[8:11], 0 offen
    v_add_u32 v41, v41, v252
    buffer_load_dwordx4 v[132:135], v41, s[8:11], 0 offen
    v_add_u32 v42, v42, v252
    buffer_load_dwordx4 v[136:139], v42, s[8:11], 0 offen
    v_add_u32 v43, v43, v252
    buffer_load_dwordx4 v[140:143], v43, s[8:11], 0 offen
    v_add_u32 v44, v44, v252
    buffer_load_dwordx4 v[144:147], v44, s[8:11], 0 offen
    v_add_u32 v45, v45, v252
    buffer_load_dwordx4 v[148:151], v45, s[8:11], 0 offen
    v_add_u32 v46, v46, v252
    buffer_load_dwordx4 v[152:155], v46, s[8:11], 0 offen
    v_add_u32 v47, v47, v252
    buffer_load_dwordx4 v[156:159], v47, s[8:11], 0 offen
    s_waitcnt vmcnt(0)
    v_mfma_f32_16x16x32_bf16 v[84:87], a[212:215], v[96:99], v[84:87]
    v_mfma_f32_16x16x32_bf16 v[84:87], a[212:215], v[100:103], v[84:87]
    v_mfma_f32_16x16x32_bf16 v[84:87], a[212:215], v[104:107], v[84:87]
    v_mfma_f32_16x16x32_bf16 v[84:87], a[212:215], v[108:111], v[84:87]
    v_mfma_f32_16x16x32_bf16 v[84:87], a[212:215], v[112:115], v[84:87]
    v_mfma_f32_16x16x32_bf16 v[84:87], a[212:215], v[116:119], v[84:87]
    v_mfma_f32_16x16x32_bf16 v[84:87], a[212:215], v[120:123], v[84:87]
    v_mfma_f32_16x16x32_bf16 v[84:87], a[212:215], v[124:127], v[84:87]
    v_mfma_f32_16x16x32_bf16 v[84:87], a[212:215], v[128:131], v[84:87]
    v_mfma_f32_16x16x32_bf16 v[84:87], a[212:215], v[132:135], v[84:87]
    v_mfma_f32_16x16x32_bf16 v[84:87], a[212:215], v[136:139], v[84:87]
    v_mfma_f32_16x16x32_bf16 v[84:87], a[212:215], v[140:143], v[84:87]
    v_mfma_f32_16x16x32_bf16 v[84:87], a[212:215], v[144:147], v[84:87]
    v_mfma_f32_16x16x32_bf16 v[84:87], a[212:215], v[148:151], v[84:87]
    v_mfma_f32_16x16x32_bf16 v[84:87], a[212:215], v[152:155], v[84:87]
    v_mfma_f32_16x16x32_bf16 v[84:87], a[212:215], v[156:159], v[84:87]
    ds_read_b128 v[32:35], v254 offset:2048
    ds_read_b128 v[36:39], v254 offset:2112
    ds_read_b128 v[40:43], v254 offset:2176
    ds_read_b128 v[44:47], v254 offset:2240
    s_waitcnt lgkmcnt(0)
    v_add_u32 v32, v32, v252
    buffer_load_dwordx4 v[96:99], v32, s[8:11], 0 offen
    v_add_u32 v33, v33, v252
    buffer_load_dwordx4 v[100:103], v33, s[8:11], 0 offen
    v_add_u32 v34, v34, v252
    buffer_load_dwordx4 v[104:107], v34, s[8:11], 0 offen
    v_add_u32 v35, v35, v252
    buffer_load_dwordx4 v[108:111], v35, s[8:11], 0 offen
    v_add_u32 v36, v36, v252
    buffer_load_dwordx4 v[112:115], v36, s[8:11], 0 offen
    v_add_u32 v37, v37, v252
    buffer_load_dwordx4 v[116:119], v37, s[8:11], 0 offen
    v_add_u32 v38, v38, v252
    buffer_load_dwordx4 v[120:123], v38, s[8:11], 0 offen
    v_add_u32 v39, v39, v252
    buffer_load_dwordx4 v[124:127], v39, s[8:11], 0 offen
    v_add_u32 v40, v40, v252
    buffer_load_dwordx4 v[128:131], v40, s[8:11], 0 offen
    v_add_u32 v41, v41, v252
    buffer_load_dwordx4 v[132:135], v41, s[8:11], 0 offen
    v_add_u32 v42, v42, v252
    buffer_load_dwordx4 v[136:139], v42, s[8:11], 0 offen
    v_add_u32 v43, v43, v252
    buffer_load_dwordx4 v[140:143], v43, s[8:11], 0 offen
    v_add_u32 v44, v44, v252
    buffer_load_dwordx4 v[144:147], v44, s[8:11], 0 offen
    v_add_u32 v45, v45, v252
    buffer_load_dwordx4 v[148:151], v45, s[8:11], 0 offen
    v_add_u32 v46, v46, v252
    buffer_load_dwordx4 v[152:155], v46, s[8:11], 0 offen
    v_add_u32 v47, v47, v252
    buffer_load_dwordx4 v[156:159], v47, s[8:11], 0 offen
    s_waitcnt vmcnt(0)
    v_mfma_f32_16x16x32_bf16 v[88:91], a[212:215], v[96:99], v[88:91]
    v_mfma_f32_16x16x32_bf16 v[88:91], a[212:215], v[100:103], v[88:91]
    v_mfma_f32_16x16x32_bf16 v[88:91], a[212:215], v[104:107], v[88:91]
    v_mfma_f32_16x16x32_bf16 v[88:91], a[212:215], v[108:111], v[88:91]
    v_mfma_f32_16x16x32_bf16 v[88:91], a[212:215], v[112:115], v[88:91]
    v_mfma_f32_16x16x32_bf16 v[88:91], a[212:215], v[116:119], v[88:91]
    v_mfma_f32_16x16x32_bf16 v[88:91], a[212:215], v[120:123], v[88:91]
    v_mfma_f32_16x16x32_bf16 v[88:91], a[212:215], v[124:127], v[88:91]
    v_mfma_f32_16x16x32_bf16 v[88:91], a[212:215], v[128:131], v[88:91]
    v_mfma_f32_16x16x32_bf16 v[88:91], a[212:215], v[132:135], v[88:91]
    v_mfma_f32_16x16x32_bf16 v[88:91], a[212:215], v[136:139], v[88:91]
    v_mfma_f32_16x16x32_bf16 v[88:91], a[212:215], v[140:143], v[88:91]
    v_mfma_f32_16x16x32_bf16 v[88:91], a[212:215], v[144:147], v[88:91]
    v_mfma_f32_16x16x32_bf16 v[88:91], a[212:215], v[148:151], v[88:91]
    v_mfma_f32_16x16x32_bf16 v[88:91], a[212:215], v[152:155], v[88:91]
    v_mfma_f32_16x16x32_bf16 v[88:91], a[212:215], v[156:159], v[88:91]
    ds_read_b128 v[32:35], v254 offset:2304
    ds_read_b128 v[36:39], v254 offset:2368
    ds_read_b128 v[40:43], v254 offset:2432
    ds_read_b128 v[44:47], v254 offset:2496
    s_waitcnt lgkmcnt(0)
    v_add_u32 v32, v32, v252
    buffer_load_dwordx4 v[96:99], v32, s[8:11], 0 offen
    v_add_u32 v33, v33, v252
    buffer_load_dwordx4 v[100:103], v33, s[8:11], 0 offen
    v_add_u32 v34, v34, v252
    buffer_load_dwordx4 v[104:107], v34, s[8:11], 0 offen
    v_add_u32 v35, v35, v252
    buffer_load_dwordx4 v[108:111], v35, s[8:11], 0 offen
    v_add_u32 v36, v36, v252
    buffer_load_dwordx4 v[112:115], v36, s[8:11], 0 offen
    v_add_u32 v37, v37, v252
    buffer_load_dwordx4 v[116:119], v37, s[8:11], 0 offen
    v_add_u32 v38, v38, v252
    buffer_load_dwordx4 v[120:123], v38, s[8:11], 0 offen
    v_add_u32 v39, v39, v252
    buffer_load_dwordx4 v[124:127], v39, s[8:11], 0 offen
    v_add_u32 v40, v40, v252
    buffer_load_dwordx4 v[128:131], v40, s[8:11], 0 offen
    v_add_u32 v41, v41, v252
    buffer_load_dwordx4 v[132:135], v41, s[8:11], 0 offen
    v_add_u32 v42, v42, v252
    buffer_load_dwordx4 v[136:139], v42, s[8:11], 0 offen
    v_add_u32 v43, v43, v252
    buffer_load_dwordx4 v[140:143], v43, s[8:11], 0 offen
    v_add_u32 v44, v44, v252
    buffer_load_dwordx4 v[144:147], v44, s[8:11], 0 offen
    v_add_u32 v45, v45, v252
    buffer_load_dwordx4 v[148:151], v45, s[8:11], 0 offen
    v_add_u32 v46, v46, v252
    buffer_load_dwordx4 v[152:155], v46, s[8:11], 0 offen
    v_add_u32 v47, v47, v252
    buffer_load_dwordx4 v[156:159], v47, s[8:11], 0 offen
    s_waitcnt vmcnt(0)
    v_mfma_f32_16x16x32_bf16 v[92:95], a[212:215], v[96:99], v[92:95]
    v_mfma_f32_16x16x32_bf16 v[92:95], a[212:215], v[100:103], v[92:95]
    v_mfma_f32_16x16x32_bf16 v[92:95], a[212:215], v[104:107], v[92:95]
    v_mfma_f32_16x16x32_bf16 v[92:95], a[212:215], v[108:111], v[92:95]
    v_mfma_f32_16x16x32_bf16 v[92:95], a[212:215], v[112:115], v[92:95]
    v_mfma_f32_16x16x32_bf16 v[92:95], a[212:215], v[116:119], v[92:95]
    v_mfma_f32_16x16x32_bf16 v[92:95], a[212:215], v[120:123], v[92:95]
    v_mfma_f32_16x16x32_bf16 v[92:95], a[212:215], v[124:127], v[92:95]
    v_mfma_f32_16x16x32_bf16 v[92:95], a[212:215], v[128:131], v[92:95]
    v_mfma_f32_16x16x32_bf16 v[92:95], a[212:215], v[132:135], v[92:95]
    v_mfma_f32_16x16x32_bf16 v[92:95], a[212:215], v[136:139], v[92:95]
    v_mfma_f32_16x16x32_bf16 v[92:95], a[212:215], v[140:143], v[92:95]
    v_mfma_f32_16x16x32_bf16 v[92:95], a[212:215], v[144:147], v[92:95]
    v_mfma_f32_16x16x32_bf16 v[92:95], a[212:215], v[148:151], v[92:95]
    v_mfma_f32_16x16x32_bf16 v[92:95], a[212:215], v[152:155], v[92:95]
    v_mfma_f32_16x16x32_bf16 v[92:95], a[212:215], v[156:159], v[92:95]
    v_readfirstlane_b32 s43, v231
    s_nop 7
    s_branch K2_MORE
K2_GFIN:
    v_accvgpr_read_b32 v237, a210
    s_mov_b32 s44, s72
    s_mov_b32 s45, s73
    s_mov_b32 s46, 0x271000
    s_mov_b32 s47, 0x00020000
    v_lshlrev_b32 v237, 16, v237
    s_mov_b32 exec_hi, 0
    v_readlane_b32 s38, v237, 0
    s_nop 1
    v_mul_f32 v56, s38, v56
    v_mul_f32 v57, s38, v57
    v_mul_f32 v58, s38, v58
    v_mul_f32 v59, s38, v59
    v_cvt_pk_bf16_f32 v56, v56, v57
    v_cvt_pk_bf16_f32 v57, v58, v59
    ds_write_b64 v230, v[56:57] offset:0
    v_readlane_b32 s38, v237, 1
    s_nop 1
    v_mul_f32 v60, s38, v60
    v_mul_f32 v61, s38, v61
    v_mul_f32 v62, s38, v62
    v_mul_f32 v63, s38, v63
    v_cvt_pk_bf16_f32 v60, v60, v61
    v_cvt_pk_bf16_f32 v61, v62, v63
    ds_write_b64 v230, v[60:61] offset:528
    v_readlane_b32 s38, v237, 2
    s_nop 1
    v_mul_f32 v64, s38, v64
    v_mul_f32 v65, s38, v65
    v_mul_f32 v66, s38, v66
    v_mul_f32 v67, s38, v67
    v_cvt_pk_bf16_f32 v64, v64, v65
    v_cvt_pk_bf16_f32 v65, v66, v67
    ds_write_b64 v230, v[64:65] offset:1056
    v_readlane_b32 s38, v237, 3
    s_nop 1
    v_mul_f32 v68, s38, v68
    v_mul_f32 v69, s38, v69
    v_mul_f32 v70, s38, v70
    v_mul_f32 v71, s38, v71
    v_cvt_pk_bf16_f32 v68, v68, v69
    v_cvt_pk_bf16_f32 v69, v70, v71
    ds_write_b64 v230, v[68:69] offset:1584
    v_readlane_b32 s38, v237, 4
    s_nop 1
    v_mul_f32 v72, s38, v72
    v_mul_f32 v73, s38, v73
    v_mul_f32 v74, s38, v74
    v_mul_f32 v75, s38, v75
    v_cvt_pk_bf16_f32 v72, v72, v73
    v_cvt_pk_bf16_f32 v73, v74, v75
    ds_write_b64 v230, v[72:73] offset:2112
    v_readlane_b32 s38, v237, 5
    s_nop 1
    v_mul_f32 v76, s38, v76
    v_mul_f32 v77, s38, v77
    v_mul_f32 v78, s38, v78
    v_mul_f32 v79, s38, v79
    v_cvt_pk_bf16_f32 v76, v76, v77
    v_cvt_pk_bf16_f32 v77, v78, v79
    ds_write_b64 v230, v[76:77] offset:2640
    v_readlane_b32 s38, v237, 6
    s_nop 1
    v_mul_f32 v80, s38, v80
    v_mul_f32 v81, s38, v81
    v_mul_f32 v82, s38, v82
    v_mul_f32 v83, s38, v83
    v_cvt_pk_bf16_f32 v80, v80, v81
    v_cvt_pk_bf16_f32 v81, v82, v83
    ds_write_b64 v230, v[80:81] offset:3168
    v_readlane_b32 s38, v237, 7
    s_nop 1
    v_mul_f32 v84, s38, v84
    v_mul_f32 v85, s38, v85
    v_mul_f32 v86, s38, v86
    v_mul_f32 v87, s38, v87
    v_cvt_pk_bf16_f32 v84, v84, v85
    v_cvt_pk_bf16_f32 v85, v86, v87
    ds_write_b64 v230, v[84:85] offset:3696
    v_readlane_b32 s38, v237, 8
    s_nop 1
    v_mul_f32 v88, s38, v88
    v_mul_f32 v89, s38, v89
    v_mul_f32 v90, s38, v90
    v_mul_f32 v91, s38, v91
    v_cvt_pk_bf16_f32 v88, v88, v89
    v_cvt_pk_bf16_f32 v89, v90, v91
    ds_write_b64 v230, v[88:89] offset:4224
    v_readlane_b32 s38, v237, 9
    s_nop 1
    v_mul_f32 v92, s38, v92
    v_mul_f32 v93, s38, v93
    v_mul_f32 v94, s38, v94
    v_mul_f32 v95, s38, v95
    v_cvt_pk_bf16_f32 v92, v92, v93
    v_cvt_pk_bf16_f32 v93, v94, v95
    ds_write_b64 v230, v[92:93] offset:4752
    s_mov_b64 exec, -1
K2_SIG:
    s_waitcnt vmcnt(0)
    s_mov_b64 exec, s[34:35]
    buffer_store_dwordx2 v[192:193], v202, s[20:23], 0 offen offset:0 sc1
    buffer_store_dwordx2 v[194:195], v202, s[20:23], 0 offen offset:128 sc1
    buffer_store_dwordx2 v[196:197], v202, s[20:23], 0 offen offset:256 sc1
    buffer_store_dwordx2 v[198:199], v202, s[20:23], 0 offen offset:384 sc1
    s_cmp_eq_u32 s24, s70
    s_cbranch_scc1 K2_SIG1
    buffer_store_dwordx2 a[248:249], v203, s[20:23], 0 offen offset:0 sc1
    buffer_store_dwordx2 a[250:251], v203, s[20:23], 0 offen offset:128 sc1
    buffer_store_dwordx2 a[252:253], v203, s[20:23], 0 offen offset:256 sc1
    buffer_store_dwordx2 a[254:255], v203, s[20:23], 0 offen offset:384 sc1
K2_SIG1:
    s_mov_b64 exec, -1
    s_cmp_ge_u32 s2, 250
    s_cbranch_scc1 K2_FIN
    buffer_load_dwordx2 v[0:1], v244, s[20:23], 0 offen sc1
    buffer_load_dwordx2 v[2:3], v245, s[20:23], 0 offen sc1
    buffer_load_dwordx2 v[160:161], v232, s[60:63], 0 offen offset:0
    buffer_load_dwordx2 v[162:163], v232, s[60:63], 0 offen offset:32
    buffer_load_dwordx2 v[164:165], v233, s[60:63], 0 offen offset:0
    buffer_load_dwordx2 v[166:167], v233, s[60:63], 0 offen offset:32
    buffer_load_dwordx2 v[168:169], v234, s[60:63], 0 offen offset:0
    buffer_load_dwordx2 v[170:171], v234, s[60:63], 0 offen offset:32
    s_waitcnt lgkmcnt(0)
    s_barrier
    ds_read_b128 v[16:19], v238 offset:256
    ds_read_b128 v[20:23], v238 offset:8704
    ds_read_b128 v[24:27], v238 offset:17152
    ds_read_b128 v[28:31], v238 offset:320
    ds_read_b128 v[32:35], v238 offset:8768
    ds_read_b128 v[36:39], v238 offset:17216
    ds_read_b128 v[40:43], v238 offset:384
    ds_read_b128 v[44:47], v238 offset:8832
    ds_read_b128 v[48:51], v238 offset:17280
    ds_read_b128 v[52:55], v238 offset:448
    ds_read_b128 v[56:59], v238 offset:8896
    ds_read_b128 v[60:63], v238 offset:17344
    s_waitcnt lgkmcnt(11)
    v_mfma_f32_16x16x32_bf16 v[128:131], a[144:147], v[16:19], 0
    v_mfma_f32_16x16x32_bf16 v[132:135], a[176:179], v[16:19], 0
    s_waitcnt lgkmcnt(10)
    v_mfma_f32_16x16x32_bf16 v[136:139], a[144:147], v[20:23], 0
    v_mfma_f32_16x16x32_bf16 v[140:143], a[176:179], v[20:23], 0
    s_waitcnt lgkmcnt(9)
    v_mfma_f32_16x16x32_bf16 v[144:147], a[144:147], v[24:27], 0
    v_mfma_f32_16x16x32_bf16 v[148:151], a[176:179], v[24:27], 0
    s_waitcnt lgkmcnt(8)
    v_mfma_f32_16x16x32_bf16 v[128:131], a[148:151], v[28:31], v[128:131]
    v_mfma_f32_16x16x32_bf16 v[132:135], a[180:183], v[28:31], v[132:135]
    s_waitcnt lgkmcnt(7)
    v_mfma_f32_16x16x32_bf16 v[136:139], a[148:151], v[32:35], v[136:139]
    v_mfma_f32_16x16x32_bf16 v[140:143], a[180:183], v[32:35], v[140:143]
    s_waitcnt lgkmcnt(6)
    v_mfma_f32_16x16x32_bf16 v[144:147], a[148:151], v[36:39], v[144:147]
    v_mfma_f32_16x16x32_bf16 v[148:151], a[180:183], v[36:39], v[148:151]
    s_waitcnt lgkmcnt(5)
    v_mfma_f32_16x16x32_bf16 v[128:131], a[152:155], v[40:43], v[128:131]
    v_mfma_f32_16x16x32_bf16 v[132:135], a[184:187], v[40:43], v[132:135]
    s_waitcnt lgkmcnt(4)
    v_mfma_f32_16x16x32_bf16 v[136:139], a[152:155], v[44:47], v[136:139]
    v_mfma_f32_16x16x32_bf16 v[140:143], a[184:187], v[44:47], v[140:143]
    s_waitcnt lgkmcnt(3)
    v_mfma_f32_16x16x32_bf16 v[144:147], a[152:155], v[48:51], v[144:147]
    v_mfma_f32_16x16x32_bf16 v[148:151], a[184:187], v[48:51], v[148:151]
    s_waitcnt lgkmcnt(2)
    v_mfma_f32_16x16x32_bf16 v[128:131], a[156:159], v[52:55], v[128:131]
    v_mfma_f32_16x16x32_bf16 v[132:135], a[188:191], v[52:55], v[132:135]
    s_waitcnt lgkmcnt(1)
    v_mfma_f32_16x16x32_bf16 v[136:139], a[156:159], v[56:59], v[136:139]
    v_mfma_f32_16x16x32_bf16 v[140:143], a[188:191], v[56:59], v[140:143]
    s_waitcnt lgkmcnt(0)
    v_mfma_f32_16x16x32_bf16 v[144:147], a[156:159], v[60:63], v[144:147]
    v_mfma_f32_16x16x32_bf16 v[148:151], a[188:191], v[60:63], v[148:151]
    s_mov_b32 s38, 0x400000
    s_waitcnt vmcnt(6)
    s_branch K2_POLLC
K2_POLL:
    buffer_load_dwordx2 v[0:1], v244, s[20:23], 0 offen sc1
    buffer_load_dwordx2 v[2:3], v245, s[20:23], 0 offen sc1
K2_POLLW:
    s_sub_u32 s38, s38, 1
    s_waitcnt vmcnt(0) lgkmcnt(0)
    s_cbranch_scc1 K2_POLLED
K2_POLLC:
    v_cmp_eq_u32 vcc, 0, v1
    v_cmp_eq_u32 s[36:37], 0, v3
    s_nop 1
    s_and_b64 vcc, vcc, s[54:55]
    s_and_b64 s[36:37], s[36:37], s[52:53]
    s_or_b64 s[36:37], s[36:37], vcc
    s_cbranch_scc1 K2_POLL
K2_POLLED:
    v_mov_b32 v120, 0xff800000
    v_cndmask_b32 v2, v120, v2, s[52:53]
    s_mov_b64 exec, s[54:55]
    ds_write_b128 v246, v[0:3]
    s_mov_b64 exec, -1
    s_waitcnt lgkmcnt(0)
    s_barrier
    ds_read_b128 v[0:3], v228 offset:0
    ds_read_b128 v[4:7], v228 offset:16
    ds_read_b128 v[8:11], v228 offset:32
    ds_read_b128 v[12:15], v228 offset:48
    v_add_u32 v224, 3072, v227
    v_cndmask_b32 v224, v239, v224, s[12:13]
    v_add_u32 v225, 0x0, v227
    buffer_load_dwordx4 v[16:19], v225, s[16:19], 0 offen sc1
    v_add_u32 v225, 0x10000, v227
    buffer_load_dwordx4 v[20:23], v225, s[16:19], 0 offen sc1
    v_add_u32 v225, 0x20000, v227
    buffer_load_dwordx4 v[24:27], v225, s[16:19], 0 offen sc1
    v_add_u32 v225, 0x30000, v227
    buffer_load_dwordx4 v[28:31], v225, s[16:19], 0 offen sc1
    v_add_u32 v225, 0x40000, v227
    buffer_load_dwordx4 v[32:35], v225, s[16:19], 0 offen sc1
    v_add_u32 v225, 0x50000, v227
    buffer_load_dwordx4 v[36:39], v225, s[16:19], 0 offen sc1
    v_add_u32 v225, 0x60000, v227
    buffer_load_dwordx4 v[40:43], v225, s[16:19], 0 offen sc1
    v_add_u32 v225, 0x70000, v227
    v_cndmask_b32 v225, v239, v225, s[56:57]
    buffer_load_dwordx4 v[44:47], v225, s[16:19], 0 offen sc1
    v_add_u32 v225, 0x0, v227
    buffer_load_dwordx4 v[48:51], v225, s[16:19], 0 offen offset:1536 sc1
    v_add_u32 v225, 0x10000, v227
    buffer_load_dwordx4 v[52:55], v225, s[16:19], 0 offen offset:1536 sc1
    v_add_u32 v225, 0x20000, v227
    buffer_load_dwordx4 v[56:59], v225, s[16:19], 0 offen offset:1536 sc1
    v_add_u32 v225, 0x30000, v227
    buffer_load_dwordx4 v[60:63], v225, s[16:19], 0 offen offset:1536 sc1
    v_add_u32 v225, 0x40000, v227
    buffer_load_dwordx4 v[64:67], v225, s[16:19], 0 offen offset:1536 sc1
    v_add_u32 v225, 0x50000, v227
    buffer_load_dwordx4 v[68:71], v225, s[16:19], 0 offen offset:1536 sc1
    v_add_u32 v225, 0x60000, v227
    buffer_load_dwordx4 v[72:75], v225, s[16:19], 0 offen offset:1536 sc1
    v_add_u32 v225, 0x70000, v227
    v_cndmask_b32 v225, v239, v225, s[56:57]
    buffer_load_dwordx4 v[76:79], v225, s[16:19], 0 offen offset:1536 sc1
    v_add_u32 v225, 0x0, v224
    buffer_load_dwordx4 v[80:83], v225, s[16:19], 0 offen sc1
    v_add_u32 v225, 0x10000, v224
    buffer_load_dwordx4 v[84:87], v225, s[16:19], 0 offen sc1
    v_add_u32 v225, 0x20000, v224
    buffer_load_dwordx4 v[88:91], v225, s[16:19], 0 offen sc1
    v_add_u32 v225, 0x30000, v224
    buffer_load_dwordx4 v[92:95], v225, s[16:19], 0 offen sc1
    v_add_u32 v225, 0x40000, v224
    buffer_load_dwordx4 v[96:99], v225, s[16:19], 0 offen sc1
    v_add_u32 v225, 0x50000, v224
    buffer_load_dwordx4 v[100:103], v225, s[16:19], 0 offen sc1
    v_add_u32 v225, 0x60000, v224
    buffer_load_dwordx4 v[104:107], v225, s[16:19], 0 offen sc1
    v_add_u32 v225, 0x70000, v224
    v_cndmask_b32 v225, v239, v225, s[56:57]
    buffer_load_dwordx4 v[108:111], v225, s[16:19], 0 offen sc1
    s_waitcnt vmcnt(24)
    v_lshlrev_b32 v120, 16, v160
    v_and_b32 v121, 0xffff0000, v160
    v_pk_add_f32 v[128:129], v[128:129], v[120:121]
    v_lshlrev_b32 v120, 16, v161
    v_and_b32 v121, 0xffff0000, v161
    v_pk_add_f32 v[130:131], v[130:131], v[120:121]
    v_lshlrev_b32 v120, 16, v162
    v_and_b32 v121, 0xffff0000, v162
    v_pk_add_f32 v[132:133], v[132:133], v[120:121]
    v_lshlrev_b32 v120, 16, v163
    v_and_b32 v121, 0xffff0000, v163
    v_pk_add_f32 v[134:135], v[134:135], v[120:121]
    v_lshlrev_b32 v120, 16, v164
    v_and_b32 v121, 0xffff0000, v164
    v_pk_add_f32 v[136:137], v[136:137], v[120:121]
    v_lshlrev_b32 v120, 16, v165
    v_and_b32 v121, 0xffff0000, v165
    v_pk_add_f32 v[138:139], v[138:139], v[120:121]
    v_lshlrev_b32 v120, 16, v166
    v_and_b32 v121, 0xffff0000, v166
    v_pk_add_f32 v[140:141], v[140:141], v[120:121]
    v_lshlrev_b32 v120, 16, v167
    v_and_b32 v121, 0xffff0000, v167
    v_pk_add_f32 v[142:143], v[142:143], v[120:121]
    v_lshlrev_b32 v120, 16, v168
    v_and_b32 v121, 0xffff0000, v168
    v_pk_add_f32 v[144:145], v[144:145], v[120:121]
    v_lshlrev_b32 v120, 16, v169
    v_and_b32 v121, 0xffff0000, v169
    v_pk_add_f32 v[146:147], v[146:147], v[120:121]
    v_lshlrev_b32 v120, 16, v170
    v_and_b32 v121, 0xffff0000, v170
    v_pk_add_f32 v[148:149], v[148:149], v[120:121]
    v_lshlrev_b32 v120, 16, v171
    v_and_b32 v121, 0xffff0000, v171
    v_pk_add_f32 v[150:151], v[150:151], v[120:121]
    s_waitcnt lgkmcnt(0)
    v_max3_f32 v120, v0, v2, v4
    v_max3_f32 v120, v120, v6, v8
    v_max3_f32 v120, v120, v10, v12
    v_max_f32 v120, v120, v14
    v_sub_f32 v0, v0, v120
    v_sub_f32 v2, v2, v120
    v_sub_f32 v4, v4, v120
    v_sub_f32 v6, v6, v120
    v_sub_f32 v8, v8, v120
    v_sub_f32 v10, v10, v120
    v_sub_f32 v12, v12, v120
    v_sub_f32 v14, v14, v120
    v_exp_f32 v0, v0
    v_exp_f32 v2, v2
    v_exp_f32 v4, v4
    v_exp_f32 v6, v6
    v_exp_f32 v8, v8
    v_exp_f32 v10, v10
    v_exp_f32 v12, v12
    v_exp_f32 v14, v14
    s_nop 0
    v_mul_f32 v121, v0, v1
    v_fmac_f32 v121, v2, v3
    v_fmac_f32 v121, v4, v5
    v_fmac_f32 v121, v6, v7
    v_fmac_f32 v121, v8, v9
    v_fmac_f32 v121, v10, v11
    v_fmac_f32 v121, v12, v13
    v_fmac_f32 v121, v14, v15
    v_rcp_f32 v121, v121
    s_nop 0
    v_mul_f32 v0, v0, v121
    v_mul_f32 v2, v2, v121
    v_mul_f32 v4, v4, v121
    v_mul_f32 v6, v6, v121
    v_mul_f32 v8, v8, v121
    v_mul_f32 v10, v10, v121
    v_mul_f32 v12, v12, v121
    v_mul_f32 v14, v14, v121
    s_waitcnt vmcnt(23)
    v_lshlrev_b32 v124, 16, v16
    v_and_b32 v125, 0xffff0000, v16
    v_pk_mul_f32 v[112:113], v[124:125], v[0:1] op_sel_hi:[1,0]
    v_lshlrev_b32 v126, 16, v17
    v_and_b32 v127, 0xffff0000, v17
    v_pk_mul_f32 v[114:115], v[126:127], v[0:1] op_sel_hi:[1,0]
    v_lshlrev_b32 v124, 16, v18
    v_and_b32 v125, 0xffff0000, v18
    v_pk_mul_f32 v[116:117], v[124:125], v[0:1] op_sel_hi:[1,0]
    v_lshlrev_b32 v126, 16, v19
    v_and_b32 v127, 0xffff0000, v19
    v_pk_mul_f32 v[118:119], v[126:127], v[0:1] op_sel_hi:[1,0]
    s_waitcnt vmcnt(22)
    v_lshlrev_b32 v124, 16, v20
    v_and_b32 v125, 0xffff0000, v20
    v_pk_fma_f32 v[112:113], v[124:125], v[2:3], v[112:113] op_sel_hi:[1,0,1]
    v_lshlrev_b32 v126, 16, v21
    v_and_b32 v127, 0xffff0000, v21
    v_pk_fma_f32 v[114:115], v[126:127], v[2:3], v[114:115] op_sel_hi:[1,0,1]
    v_lshlrev_b32 v124, 16, v22
    v_and_b32 v125, 0xffff0000, v22
    v_pk_fma_f32 v[116:117], v[124:125], v[2:3], v[116:117] op_sel_hi:[1,0,1]
    v_lshlrev_b32 v126, 16, v23
    v_and_b32 v127, 0xffff0000, v23
    v_pk_fma_f32 v[118:119], v[126:127], v[2:3], v[118:119] op_sel_hi:[1,0,1]
    s_waitcnt vmcnt(21)
    v_lshlrev_b32 v124, 16, v24
    v_and_b32 v125, 0xffff0000, v24
    v_pk_fma_f32 v[112:113], v[124:125], v[4:5], v[112:113] op_sel_hi:[1,0,1]
    v_lshlrev_b32 v126, 16, v25
    v_and_b32 v127, 0xffff0000, v25
    v_pk_fma_f32 v[114:115], v[126:127], v[4:5], v[114:115] op_sel_hi:[1,0,1]
    v_lshlrev_b32 v124, 16, v26
    v_and_b32 v125, 0xffff0000, v26
    v_pk_fma_f32 v[116:117], v[124:125], v[4:5], v[116:117] op_sel_hi:[1,0,1]
    v_lshlrev_b32 v126, 16, v27
    v_and_b32 v127, 0xffff0000, v27
    v_pk_fma_f32 v[118:119], v[126:127], v[4:5], v[118:119] op_sel_hi:[1,0,1]
    s_waitcnt vmcnt(20)
    v_lshlrev_b32 v124, 16, v28
    v_and_b32 v125, 0xffff0000, v28
    v_pk_fma_f32 v[112:113], v[124:125], v[6:7], v[112:113] op_sel_hi:[1,0,1]
    v_lshlrev_b32 v126, 16, v29
    v_and_b32 v127, 0xffff0000, v29
    v_pk_fma_f32 v[114:115], v[126:127], v[6:7], v[114:115] op_sel_hi:[1,0,1]
    v_lshlrev_b32 v124, 16, v30
    v_and_b32 v125, 0xffff0000, v30
    v_pk_fma_f32 v[116:117], v[124:125], v[6:7], v[116:117] op_sel_hi:[1,0,1]
    v_lshlrev_b32 v126, 16, v31
    v_and_b32 v127, 0xffff0000, v31
    v_pk_fma_f32 v[118:119], v[126:127], v[6:7], v[118:119] op_sel_hi:[1,0,1]
    s_waitcnt vmcnt(19)
    v_lshlrev_b32 v124, 16, v32
    v_and_b32 v125, 0xffff0000, v32
    v_pk_fma_f32 v[112:113], v[124:125], v[8:9], v[112:113] op_sel_hi:[1,0,1]
    v_lshlrev_b32 v126, 16, v33
    v_and_b32 v127, 0xffff0000, v33
    v_pk_fma_f32 v[114:115], v[126:127], v[8:9], v[114:115] op_sel_hi:[1,0,1]
    v_lshlrev_b32 v124, 16, v34
    v_and_b32 v125, 0xffff0000, v34
    v_pk_fma_f32 v[116:117], v[124:125], v[8:9], v[116:117] op_sel_hi:[1,0,1]
    v_lshlrev_b32 v126, 16, v35
    v_and_b32 v127, 0xffff0000, v35
    v_pk_fma_f32 v[118:119], v[126:127], v[8:9], v[118:119] op_sel_hi:[1,0,1]
    s_waitcnt vmcnt(18)
    v_lshlrev_b32 v124, 16, v36
    v_and_b32 v125, 0xffff0000, v36
    v_pk_fma_f32 v[112:113], v[124:125], v[10:11], v[112:113] op_sel_hi:[1,0,1]
    v_lshlrev_b32 v126, 16, v37
    v_and_b32 v127, 0xffff0000, v37
    v_pk_fma_f32 v[114:115], v[126:127], v[10:11], v[114:115] op_sel_hi:[1,0,1]
    v_lshlrev_b32 v124, 16, v38
    v_and_b32 v125, 0xffff0000, v38
    v_pk_fma_f32 v[116:117], v[124:125], v[10:11], v[116:117] op_sel_hi:[1,0,1]
    v_lshlrev_b32 v126, 16, v39
    v_and_b32 v127, 0xffff0000, v39
    v_pk_fma_f32 v[118:119], v[126:127], v[10:11], v[118:119] op_sel_hi:[1,0,1]
    s_waitcnt vmcnt(17)
    v_lshlrev_b32 v124, 16, v40
    v_and_b32 v125, 0xffff0000, v40
    v_pk_fma_f32 v[112:113], v[124:125], v[12:13], v[112:113] op_sel_hi:[1,0,1]
    v_lshlrev_b32 v126, 16, v41
    v_and_b32 v127, 0xffff0000, v41
    v_pk_fma_f32 v[114:115], v[126:127], v[12:13], v[114:115] op_sel_hi:[1,0,1]
    v_lshlrev_b32 v124, 16, v42
    v_and_b32 v125, 0xffff0000, v42
    v_pk_fma_f32 v[116:117], v[124:125], v[12:13], v[116:117] op_sel_hi:[1,0,1]
    v_lshlrev_b32 v126, 16, v43
    v_and_b32 v127, 0xffff0000, v43
    v_pk_fma_f32 v[118:119], v[126:127], v[12:13], v[118:119] op_sel_hi:[1,0,1]
    s_waitcnt vmcnt(16)
    v_lshlrev_b32 v124, 16, v44
    v_and_b32 v125, 0xffff0000, v44
    v_pk_fma_f32 v[112:113], v[124:125], v[14:15], v[112:113] op_sel_hi:[1,0,1]
    v_lshlrev_b32 v126, 16, v45
    v_and_b32 v127, 0xffff0000, v45
    v_pk_fma_f32 v[114:115], v[126:127], v[14:15], v[114:115] op_sel_hi:[1,0,1]
    v_lshlrev_b32 v124, 16, v46
    v_and_b32 v125, 0xffff0000, v46
    v_pk_fma_f32 v[116:117], v[124:125], v[14:15], v[116:117] op_sel_hi:[1,0,1]
    v_lshlrev_b32 v126, 16, v47
    v_and_b32 v127, 0xffff0000, v47
    v_pk_fma_f32 v[118:119], v[126:127], v[14:15], v[118:119] op_sel_hi:[1,0,1]
    v_cvt_pk_bf16_f32 v16, v112, v113
    v_cvt_pk_bf16_f32 v17, v114, v115
    v_cvt_pk_bf16_f32 v18, v116, v117
    v_cvt_pk_bf16_f32 v19, v118, v119
    s_mov_b64 exec, s[58:59]
    ds_write_b128 v229, v[16:19] offset:0
    s_mov_b64 exec, -1
    s_waitcnt vmcnt(15)
    v_lshlrev_b32 v124, 16, v48
    v_and_b32 v125, 0xffff0000, v48
    v_pk_mul_f32 v[112:113], v[124:125], v[0:1] op_sel_hi:[1,0]
    v_lshlrev_b32 v126, 16, v49
    v_and_b32 v127, 0xffff0000, v49
    v_pk_mul_f32 v[114:115], v[126:127], v[0:1] op_sel_hi:[1,0]
    v_lshlrev_b32 v124, 16, v50
    v_and_b32 v125, 0xffff0000, v50
    v_pk_mul_f32 v[116:117], v[124:125], v[0:1] op_sel_hi:[1,0]
    v_lshlrev_b32 v126, 16, v51
    v_and_b32 v127, 0xffff0000, v51
    v_pk_mul_f32 v[118:119], v[126:127], v[0:1] op_sel_hi:[1,0]
    s_waitcnt vmcnt(14)
    v_lshlrev_b32 v124, 16, v52
    v_and_b32 v125, 0xffff0000, v52
    v_pk_fma_f32 v[112:113], v[124:125], v[2:3], v[112:113] op_sel_hi:[1,0,1]
    v_lshlrev_b32 v126, 16, v53
    v_and_b32 v127, 0xffff0000, v53
    v_pk_fma_f32 v[114:115], v[126:127], v[2:3], v[114:115] op_sel_hi:[1,0,1]
    v_lshlrev_b32 v124, 16, v54
    v_and_b32 v125, 0xffff0000, v54
    v_pk_fma_f32 v[116:117], v[124:125], v[2:3], v[116:117] op_sel_hi:[1,0,1]
    v_lshlrev_b32 v126, 16, v55
    v_and_b32 v127, 0xffff0000, v55
    v_pk_fma_f32 v[118:119], v[126:127], v[2:3], v[118:119] op_sel_hi:[1,0,1]
    s_waitcnt vmcnt(13)
    v_lshlrev_b32 v124, 16, v56
    v_and_b32 v125, 0xffff0000, v56
    v_pk_fma_f32 v[112:113], v[124:125], v[4:5], v[112:113] op_sel_hi:[1,0,1]
    v_lshlrev_b32 v126, 16, v57
    v_and_b32 v127, 0xffff0000, v57
    v_pk_fma_f32 v[114:115], v[126:127], v[4:5], v[114:115] op_sel_hi:[1,0,1]
    v_lshlrev_b32 v124, 16, v58
    v_and_b32 v125, 0xffff0000, v58
    v_pk_fma_f32 v[116:117], v[124:125], v[4:5], v[116:117] op_sel_hi:[1,0,1]
    v_lshlrev_b32 v126, 16, v59
    v_and_b32 v127, 0xffff0000, v59
    v_pk_fma_f32 v[118:119], v[126:127], v[4:5], v[118:119] op_sel_hi:[1,0,1]
    s_waitcnt vmcnt(12)
    v_lshlrev_b32 v124, 16, v60
    v_and_b32 v125, 0xffff0000, v60
    v_pk_fma_f32 v[112:113], v[124:125], v[6:7], v[112:113] op_sel_hi:[1,0,1]
    v_lshlrev_b32 v126, 16, v61
    v_and_b32 v127, 0xffff0000, v61
    v_pk_fma_f32 v[114:115], v[126:127], v[6:7], v[114:115] op_sel_hi:[1,0,1]
    v_lshlrev_b32 v124, 16, v62
    v_and_b32 v125, 0xffff0000, v62
    v_pk_fma_f32 v[116:117], v[124:125], v[6:7], v[116:117] op_sel_hi:[1,0,1]
    v_lshlrev_b32 v126, 16, v63
    v_and_b32 v127, 0xffff0000, v63
    v_pk_fma_f32 v[118:119], v[126:127], v[6:7], v[118:119] op_sel_hi:[1,0,1]
    s_waitcnt vmcnt(11)
    v_lshlrev_b32 v124, 16, v64
    v_and_b32 v125, 0xffff0000, v64
    v_pk_fma_f32 v[112:113], v[124:125], v[8:9], v[112:113] op_sel_hi:[1,0,1]
    v_lshlrev_b32 v126, 16, v65
    v_and_b32 v127, 0xffff0000, v65
    v_pk_fma_f32 v[114:115], v[126:127], v[8:9], v[114:115] op_sel_hi:[1,0,1]
    v_lshlrev_b32 v124, 16, v66
    v_and_b32 v125, 0xffff0000, v66
    v_pk_fma_f32 v[116:117], v[124:125], v[8:9], v[116:117] op_sel_hi:[1,0,1]
    v_lshlrev_b32 v126, 16, v67
    v_and_b32 v127, 0xffff0000, v67
    v_pk_fma_f32 v[118:119], v[126:127], v[8:9], v[118:119] op_sel_hi:[1,0,1]
    s_waitcnt vmcnt(10)
    v_lshlrev_b32 v124, 16, v68
    v_and_b32 v125, 0xffff0000, v68
    v_pk_fma_f32 v[112:113], v[124:125], v[10:11], v[112:113] op_sel_hi:[1,0,1]
    v_lshlrev_b32 v126, 16, v69
    v_and_b32 v127, 0xffff0000, v69
    v_pk_fma_f32 v[114:115], v[126:127], v[10:11], v[114:115] op_sel_hi:[1,0,1]
    v_lshlrev_b32 v124, 16, v70
    v_and_b32 v125, 0xffff0000, v70
    v_pk_fma_f32 v[116:117], v[124:125], v[10:11], v[116:117] op_sel_hi:[1,0,1]
    v_lshlrev_b32 v126, 16, v71
    v_and_b32 v127, 0xffff0000, v71
    v_pk_fma_f32 v[118:119], v[126:127], v[10:11], v[118:119] op_sel_hi:[1,0,1]
    s_waitcnt vmcnt(9)
    v_lshlrev_b32 v124, 16, v72
    v_and_b32 v125, 0xffff0000, v72
    v_pk_fma_f32 v[112:113], v[124:125], v[12:13], v[112:113] op_sel_hi:[1,0,1]
    v_lshlrev_b32 v126, 16, v73
    v_and_b32 v127, 0xffff0000, v73
    v_pk_fma_f32 v[114:115], v[126:127], v[12:13], v[114:115] op_sel_hi:[1,0,1]
    v_lshlrev_b32 v124, 16, v74
    v_and_b32 v125, 0xffff0000, v74
    v_pk_fma_f32 v[116:117], v[124:125], v[12:13], v[116:117] op_sel_hi:[1,0,1]
    v_lshlrev_b32 v126, 16, v75
    v_and_b32 v127, 0xffff0000, v75
    v_pk_fma_f32 v[118:119], v[126:127], v[12:13], v[118:119] op_sel_hi:[1,0,1]
    s_waitcnt vmcnt(8)
    v_lshlrev_b32 v124, 16, v76
    v_and_b32 v125, 0xffff0000, v76
    v_pk_fma_f32 v[112:113], v[124:125], v[14:15], v[112:113] op_sel_hi:[1,0,1]
    v_lshlrev_b32 v126, 16, v77
    v_and_b32 v127, 0xffff0000, v77
    v_pk_fma_f32 v[114:115], v[126:127], v[14:15], v[114:115] op_sel_hi:[1,0,1]
    v_lshlrev_b32 v124, 16, v78
    v_and_b32 v125, 0xffff0000, v78
    v_pk_fma_f32 v[116:117], v[124:125], v[14:15], v[116:117] op_sel_hi:[1,0,1]
    v_lshlrev_b32 v126, 16, v79
    v_and_b32 v127, 0xffff0000, v79
    v_pk_fma_f32 v[118:119], v[126:127], v[14:15], v[118:119] op_sel_hi:[1,0,1]
    v_cvt_pk_bf16_f32 v48, v112, v113
    v_cvt_pk_bf16_f32 v49, v114, v115
    v_cvt_pk_bf16_f32 v50, v116, v117
    v_cvt_pk_bf16_f32 v51, v118, v119
    s_mov_b64 exec, s[58:59]
    ds_write_b128 v229, v[48:51] offset:96
    s_mov_b64 exec, -1
    s_waitcnt vmcnt(7)
    v_lshlrev_b32 v124, 16, v80
    v_and_b32 v125, 0xffff0000, v80
    v_pk_mul_f32 v[112:113], v[124:125], v[0:1] op_sel_hi:[1,0]
    v_lshlrev_b32 v126, 16, v81
    v_and_b32 v127, 0xffff0000, v81
    v_pk_mul_f32 v[114:115], v[126:127], v[0:1] op_sel_hi:[1,0]
    v_lshlrev_b32 v124, 16, v82
    v_and_b32 v125, 0xffff0000, v82
    v_pk_mul_f32 v[116:117], v[124:125], v[0:1] op_sel_hi:[1,0]
    v_lshlrev_b32 v126, 16, v83
    v_and_b32 v127, 0xffff0000, v83
    v_pk_mul_f32 v[118:119], v[126:127], v[0:1] op_sel_hi:[1,0]
    s_waitcnt vmcnt(6)
    v_lshlrev_b32 v124, 16, v84
    v_and_b32 v125, 0xffff0000, v84
    v_pk_fma_f32 v[112:113], v[124:125], v[2:3], v[112:113] op_sel_hi:[1,0,1]
    v_lshlrev_b32 v126, 16, v85
    v_and_b32 v127, 0xffff0000, v85
    v_pk_fma_f32 v[114:115], v[126:127], v[2:3], v[114:115] op_sel_hi:[1,0,1]
    v_lshlrev_b32 v124, 16, v86
    v_and_b32 v125, 0xffff0000, v86
    v_pk_fma_f32 v[116:117], v[124:125], v[2:3], v[116:117] op_sel_hi:[1,0,1]
    v_lshlrev_b32 v126, 16, v87
    v_and_b32 v127, 0xffff0000, v87
    v_pk_fma_f32 v[118:119], v[126:127], v[2:3], v[118:119] op_sel_hi:[1,0,1]
    s_waitcnt vmcnt(5)
    v_lshlrev_b32 v124, 16, v88
    v_and_b32 v125, 0xffff0000, v88
    v_pk_fma_f32 v[112:113], v[124:125], v[4:5], v[112:113] op_sel_hi:[1,0,1]
    v_lshlrev_b32 v126, 16, v89
    v_and_b32 v127, 0xffff0000, v89
    v_pk_fma_f32 v[114:115], v[126:127], v[4:5], v[114:115] op_sel_hi:[1,0,1]
    v_lshlrev_b32 v124, 16, v90
    v_and_b32 v125, 0xffff0000, v90
    v_pk_fma_f32 v[116:117], v[124:125], v[4:5], v[116:117] op_sel_hi:[1,0,1]
    v_lshlrev_b32 v126, 16, v91
    v_and_b32 v127, 0xffff0000, v91
    v_pk_fma_f32 v[118:119], v[126:127], v[4:5], v[118:119] op_sel_hi:[1,0,1]
    s_waitcnt vmcnt(4)
    v_lshlrev_b32 v124, 16, v92
    v_and_b32 v125, 0xffff0000, v92
    v_pk_fma_f32 v[112:113], v[124:125], v[6:7], v[112:113] op_sel_hi:[1,0,1]
    v_lshlrev_b32 v126, 16, v93
    v_and_b32 v127, 0xffff0000, v93
    v_pk_fma_f32 v[114:115], v[126:127], v[6:7], v[114:115] op_sel_hi:[1,0,1]
    v_lshlrev_b32 v124, 16, v94
    v_and_b32 v125, 0xffff0000, v94
    v_pk_fma_f32 v[116:117], v[124:125], v[6:7], v[116:117] op_sel_hi:[1,0,1]
    v_lshlrev_b32 v126, 16, v95
    v_and_b32 v127, 0xffff0000, v95
    v_pk_fma_f32 v[118:119], v[126:127], v[6:7], v[118:119] op_sel_hi:[1,0,1]
    s_waitcnt vmcnt(3)
    v_lshlrev_b32 v124, 16, v96
    v_and_b32 v125, 0xffff0000, v96
    v_pk_fma_f32 v[112:113], v[124:125], v[8:9], v[112:113] op_sel_hi:[1,0,1]
    v_lshlrev_b32 v126, 16, v97
    v_and_b32 v127, 0xffff0000, v97
    v_pk_fma_f32 v[114:115], v[126:127], v[8:9], v[114:115] op_sel_hi:[1,0,1]
    v_lshlrev_b32 v124, 16, v98
    v_and_b32 v125, 0xffff0000, v98
    v_pk_fma_f32 v[116:117], v[124:125], v[8:9], v[116:117] op_sel_hi:[1,0,1]
    v_lshlrev_b32 v126, 16, v99
    v_and_b32 v127, 0xffff0000, v99
    v_pk_fma_f32 v[118:119], v[126:127], v[8:9], v[118:119] op_sel_hi:[1,0,1]
    s_waitcnt vmcnt(2)
    v_lshlrev_b32 v124, 16, v100
    v_and_b32 v125, 0xffff0000, v100
    v_pk_fma_f32 v[112:113], v[124:125], v[10:11], v[112:113] op_sel_hi:[1,0,1]
    v_lshlrev_b32 v126, 16, v101
    v_and_b32 v127, 0xffff0000, v101
    v_pk_fma_f32 v[114:115], v[126:127], v[10:11], v[114:115] op_sel_hi:[1,0,1]
    v_lshlrev_b32 v124, 16, v102
    v_and_b32 v125, 0xffff0000, v102
    v_pk_fma_f32 v[116:117], v[124:125], v[10:11], v[116:117] op_sel_hi:[1,0,1]
    v_lshlrev_b32 v126, 16, v103
    v_and_b32 v127, 0xffff0000, v103
    v_pk_fma_f32 v[118:119], v[126:127], v[10:11], v[118:119] op_sel_hi:[1,0,1]
    s_waitcnt vmcnt(1)
    v_lshlrev_b32 v124, 16, v104
    v_and_b32 v125, 0xffff0000, v104
    v_pk_fma_f32 v[112:113], v[124:125], v[12:13], v[112:113] op_sel_hi:[1,0,1]
    v_lshlrev_b32 v126, 16, v105
    v_and_b32 v127, 0xffff0000, v105
    v_pk_fma_f32 v[114:115], v[126:127], v[12:13], v[114:115] op_sel_hi:[1,0,1]
    v_lshlrev_b32 v124, 16, v106
    v_and_b32 v125, 0xffff0000, v106
    v_pk_fma_f32 v[116:117], v[124:125], v[12:13], v[116:117] op_sel_hi:[1,0,1]
    v_lshlrev_b32 v126, 16, v107
    v_and_b32 v127, 0xffff0000, v107
    v_pk_fma_f32 v[118:119], v[126:127], v[12:13], v[118:119] op_sel_hi:[1,0,1]
    s_waitcnt vmcnt(0)
    v_lshlrev_b32 v124, 16, v108
    v_and_b32 v125, 0xffff0000, v108
    v_pk_fma_f32 v[112:113], v[124:125], v[14:15], v[112:113] op_sel_hi:[1,0,1]
    v_lshlrev_b32 v126, 16, v109
    v_and_b32 v127, 0xffff0000, v109
    v_pk_fma_f32 v[114:115], v[126:127], v[14:15], v[114:115] op_sel_hi:[1,0,1]
    v_lshlrev_b32 v124, 16, v110
    v_and_b32 v125, 0xffff0000, v110
    v_pk_fma_f32 v[116:117], v[124:125], v[14:15], v[116:117] op_sel_hi:[1,0,1]
    v_lshlrev_b32 v126, 16, v111
    v_and_b32 v127, 0xffff0000, v111
    v_pk_fma_f32 v[118:119], v[126:127], v[14:15], v[118:119] op_sel_hi:[1,0,1]
    v_cvt_pk_bf16_f32 v80, v112, v113
    v_cvt_pk_bf16_f32 v81, v114, v115
    v_cvt_pk_bf16_f32 v82, v116, v117
    v_cvt_pk_bf16_f32 v83, v118, v119
    s_mov_b64 exec, s[12:13]
    ds_write_b128 v229, v[80:83] offset:192
    s_mov_b64 exec, -1
    s_waitcnt lgkmcnt(0)
    s_barrier
    ds_read_b128 v[16:19], v238 offset:0
    ds_read_b128 v[20:23], v238 offset:64
    ds_read_b128 v[24:27], v238 offset:128
    ds_read_b128 v[28:31], v238 offset:192
    ds_read_b128 v[32:35], v238 offset:8448
    ds_read_b128 v[36:39], v238 offset:8512
    ds_read_b128 v[40:43], v238 offset:8576
    ds_read_b128 v[44:47], v238 offset:8640
    ds_read_b128 v[48:51], v238 offset:16896
    ds_read_b128 v[52:55], v238 offset:16960
    ds_read_b128 v[56:59], v238 offset:17024
    ds_read_b128 v[60:63], v238 offset:17088
    s_waitcnt lgkmcnt(11)
    v_mfma_f32_16x16x32_bf16 v[128:131], a[128:131], v[16:19], v[128:131]
    v_mfma_f32_16x16x32_bf16 v[132:135], a[160:163], v[16:19], v[132:135]
    s_waitcnt lgkmcnt(10)
    v_mfma_f32_16x16x32_bf16 v[128:131], a[132:135], v[20:23], v[128:131]
    v_mfma_f32_16x16x32_bf16 v[132:135], a[164:167], v[20:23], v[132:135]
    s_waitcnt lgkmcnt(9)
    v_mfma_f32_16x16x32_bf16 v[128:131], a[136:139], v[24:27], v[128:131]
    v_mfma_f32_16x16x32_bf16 v[132:135], a[168:171], v[24:27], v[132:135]
    s_waitcnt lgkmcnt(8)
    v_mfma_f32_16x16x32_bf16 v[128:131], a[140:143], v[28:31], v[128:131]
    v_mfma_f32_16x16x32_bf16 v[132:135], a[172:175], v[28:31], v[132:135]
    s_waitcnt lgkmcnt(7)
    v_mfma_f32_16x16x32_bf16 v[136:139], a[128:131], v[32:35], v[136:139]
    v_mfma_f32_16x16x32_bf16 v[140:143], a[160:163], v[32:35], v[140:143]
    s_waitcnt lgkmcnt(6)
    v_mfma_f32_16x16x32_bf16 v[136:139], a[132:135], v[36:39], v[136:139]
    v_mfma_f32_16x16x32_bf16 v[140:143], a[164:167], v[36:39], v[140:143]
    s_waitcnt lgkmcnt(5)
    v_mfma_f32_16x16x32_bf16 v[136:139], a[136:139], v[40:43], v[136:139]
    v_mfma_f32_16x16x32_bf16 v[140:143], a[168:171], v[40:43], v[140:143]
    s_waitcnt lgkmcnt(4)
    v_mfma_f32_16x16x32_bf16 v[136:139], a[140:143], v[44:47], v[136:139]
    v_mfma_f32_16x16x32_bf16 v[140:143], a[172:175], v[44:47], v[140:143]
    s_waitcnt lgkmcnt(3)
    v_mfma_f32_16x16x32_bf16 v[144:147], a[128:131], v[48:51], v[144:147]
    v_mfma_f32_16x16x32_bf16 v[148:151], a[160:163], v[48:51], v[148:151]
    s_waitcnt lgkmcnt(2)
    v_mfma_f32_16x16x32_bf16 v[144:147], a[132:135], v[52:55], v[144:147]
    v_mfma_f32_16x16x32_bf16 v[148:151], a[164:167], v[52:55], v[148:151]
    s_waitcnt lgkmcnt(1)
    v_mfma_f32_16x16x32_bf16 v[144:147], a[136:139], v[56:59], v[144:147]
    v_mfma_f32_16x16x32_bf16 v[148:151], a[168:171], v[56:59], v[148:151]
    s_waitcnt lgkmcnt(0)
    v_mfma_f32_16x16x32_bf16 v[144:147], a[140:143], v[60:63], v[144:147]
    v_mfma_f32_16x16x32_bf16 v[148:151], a[172:175], v[60:63], v[148:151]
    v_cvt_pk_bf16_f32 v160, v128, v129
    v_cvt_pk_bf16_f32 v161, v130, v131
    buffer_store_dwordx2 v[160:161], v232, s[44:47], 0 offen offset:0
    v_cvt_pk_bf16_f32 v162, v132, v133
    v_cvt_pk_bf16_f32 v163, v134, v135
    buffer_store_dwordx2 v[162:163], v232, s[44:47], 0 offen offset:32
    v_cvt_pk_bf16_f32 v164, v136, v137
    v_cvt_pk_bf16_f32 v165, v138, v139
    buffer_store_dwordx2 v[164:165], v233, s[44:47], 0 offen offset:0
    v_cvt_pk_bf16_f32 v166, v140, v141
    v_cvt_pk_bf16_f32 v167, v142, v143
    buffer_store_dwordx2 v[166:167], v233, s[44:47], 0 offen offset:32
    s_nop 2
    v_cvt_pk_bf16_f32 v168, v144, v145
    v_cvt_pk_bf16_f32 v169, v146, v147
    buffer_store_dwordx2 v[168:169], v234, s[44:47], 0 offen offset:0
    v_cvt_pk_bf16_f32 v170, v148, v149
    v_cvt_pk_bf16_f32 v171, v150, v151
    buffer_store_dwordx2 v[170:171], v234, s[44:47], 0 offen offset:32
K2_FIN:
    s_mov_b64 exec, -1
    s_waitcnt vmcnt(0)
K2_END:
    s_endpgm
.section .rodata,"a"
.p2align 6
.amdhsa_kernel gps_attn_kernel
  .amdhsa_next_free_vgpr 512
  .amdhsa_next_free_sgpr 102
  .amdhsa_accum_offset 256
  .amdhsa_group_segment_fixed_size 0
  .amdhsa_kernarg_size 96
  .amdhsa_user_sgpr_count 2
  .amdhsa_user_sgpr_kernarg_segment_ptr 1
  .amdhsa_system_sgpr_workgroup_id_x 1
.end_amdhsa_kernel
```
